```python
import torch

def _softmax(x, axis=-1):
    return torch.softmax(x, dim=axis)

def _gelu(x):
    return torch.nn.functional.gelu(x, approximate='tanh')

def _silu(x):
    return torch.nn.functional.silu(x)

def _sigmoid(x):
    return torch.sigmoid(x)

def _layernorm(x, axis=-1, eps=1e-05):
    m = x.mean(dim=axis, keepdim=True)
    v = x.var(dim=axis, keepdim=True, unbiased=False)
    return (x - m) / torch.sqrt(v + eps)

def _scatter_add(tgt, idx, src, axis=0):
    return tgt.clone().index_add_(axis, idx, src)

def _segment_sum(src, seg, n):
    out = torch.zeros((n,) + src.shape[1:], dtype=src.dtype)
    return out.index_add_(0, seg, src)

def _pad(x, pw):
    flat = tuple((v for pair in reversed(pw) for v in pair))
    return torch.nn.functional.pad(x, flat)
kernel_name = 'recurrent_scan__memory_aug_recurrent_mem_tr__geglu_ffn__prompt'

def setup_inputs():

    _w = lambda a: (lambda t: t.to(torch.bfloat16) if t.is_floating_point() else t)(torch.as_tensor(a))

    def _A_setup():
        B, S, Dm = (1, 2048, 576)
        H, Dh = (32, 128)
        M, seg = (8, 32)
        seg = min(seg, S)
        S = S // seg * seg
        return {'x': _w((lambda *s: torch.randn(*s, dtype=torch.bfloat16) * 0.05)(B, S, Dm)), 'mem0': _w((lambda *s: torch.randn(*s, dtype=torch.bfloat16) * 0.2)(B, M, Dm)), 'Wq': _w((lambda *s: torch.randn(*s, dtype=torch.bfloat16) * 0.8)(Dm, H, Dh) * Dm ** (-0.5)), 'Wk': _w((lambda *s: torch.randn(*s, dtype=torch.bfloat16) * 0.8)(Dm, H, Dh) * Dm ** (-0.5)), 'Wv': _w((lambda *s: torch.randn(*s, dtype=torch.bfloat16) * 0.2)(Dm, H, Dh) * Dm ** (-0.5)), 'Wo': _w((lambda *s: torch.randn(*s, dtype=torch.bfloat16) * 0.2)(H, Dh, Dm) * (H * Dh) ** (-0.5)), 'seg_len': seg}
    _A_in = _A_setup()

    def _B_setup():
        B, S, D, F = (1, 2048, 576, 4608)
        return {'x': _w((lambda *s: torch.randn(*s, dtype=torch.bfloat16) * 0.05)(B, S, D)), 'w_gate': _w((lambda *s: torch.randn(*s, dtype=torch.bfloat16) * 0.1)(D, F)), 'w_up': _w((lambda *s: torch.randn(*s, dtype=torch.bfloat16) * 0.1)(D, F)), 'w_down': _w((lambda *s: torch.randn(*s, dtype=torch.bfloat16) * 0.1)(F, D))}
    _B_in = _B_setup()
    return {'A_x': _A_in['x'], 'A_mem0': _A_in['mem0'], 'A_Wq': _A_in['Wq'], 'A_Wk': _A_in['Wk'], 'A_Wv': _A_in['Wv'], 'A_Wo': _A_in['Wo'], 'A_seg_len': _A_in['seg_len'], 'B_x': _B_in['x'], 'B_w_gate': _B_in['w_gate'], 'B_w_up': _B_in['w_up'], 'B_w_down': _B_in['w_down']}

def reference(A_x, A_mem0, A_Wq, A_Wk, A_Wv, A_Wo, A_seg_len, B_x, B_w_gate, B_w_up, B_w_down):

    def _A_ref(x, mem0, Wq, Wk, Wv, Wo, seg_len):
        B, S, Dm = x.shape
        H, Dh = (Wq.shape[1], Wq.shape[2])
        M = mem0.shape[1]
        scale = Dh ** (-0.5)
        n_seg = S // seg_len
        L = M + seg_len
        idx = torch.arange(L)
        mask = (idx[:, None] < M) | (idx[:, None] >= idx[None, :])
        mem = mem0
        outs = []
        for s in range(n_seg):
            xs = x[:, s * seg_len:(s + 1) * seg_len, :].clone()
            h = torch.concatenate([mem, xs], axis=1)
            q = torch.einsum('btd,dhe->bhte', h, Wq)
            k = torch.einsum('btd,dhe->bhte', h, Wk)
            v = torch.einsum('btd,dhe->bhte', h, Wv)
            scores = torch.einsum('bhqe,bhke->bhqk', q, k) * scale
            scores = torch.where(mask[None, None], scores, -1000000000.0)
            p = _softmax(scores, axis=-1)
            o = torch.einsum('bhqk,bhke->bhqe', p, v)
            o = torch.einsum('bhte,hed->btd', o, Wo)
            mem = o[:, :M, :].clone()
            outs.append(o[:, M:, :])
        return torch.concatenate(outs, axis=1)

    def _B_ref(x, w_gate, w_up, w_down):
        return _gelu(x @ w_gate) * (x @ w_up) @ w_down
    x = A_x
    xn = _layernorm(x, axis=-1)
    s = _A_ref(xn, A_mem0, A_Wq, A_Wk, A_Wv, A_Wo, A_seg_len)
    g = _silu(_B_ref(xn, B_w_gate, B_w_up, B_w_down))
    return x + s * g
```

```asm
; @launch grid=(256,1,1) block=(256,1,1) lds=163840
.amdgcn_target "amdgcn-amd-amdhsa--gfx950"
.text
.globl recurrent_scan__memory_aug_recurrent_mem_tr__geglu_ffn__prompt_kernel
.p2align 8
.type recurrent_scan__memory_aug_recurrent_mem_tr__geglu_ffn__prompt_kernel,@function
recurrent_scan__memory_aug_recurrent_mem_tr__geglu_ffn__prompt_kernel:
  s_cmp_ge_u32 s2, 256
  s_cbranch_scc1 L_end
  s_load_dwordx16 s[24:39], s[0:1], 0
  s_load_dwordx8 s[40:47], s[0:1], 64
  s_load_dwordx4 s[48:51], s[0:1], 96
  s_getreg_b32 s22, hwreg(HW_REG_XCC_ID)
  v_lshrrev_b32 v1, 6, v0
  v_and_b32 v0, 63, v0
  v_readfirstlane_b32 s20, v1
  s_and_b32 s22, s22, 7
  s_waitcnt lgkmcnt(0)
  s_mov_b32 s4, s50
  s_and_b32 s5, s51, 0xffff
  s_mov_b32 s6, 0x10000000
  s_mov_b32 s7, 0x20000
  s_mov_b32 s16, s48
  s_and_b32 s17, s49, 0xffff
  s_mov_b32 s18, 0x100
  s_mov_b32 s19, 0x20000
  v_mov_b32 v4, 163832
  s_cmp_lg_u32 s20, 0
  s_cbranch_scc1 L_role_wait
  s_lshl_b32 s54, s2, 8
  s_add_u32 s54, s54, 0x3200000
  v_lshlrev_b32 v2, 2, v0
  v_mov_b32 v1, 0
  buffer_store_dword v1, v2, s[4:7], s54 offen sc1
  s_waitcnt vmcnt(0)
  s_lshl_b32 s54, s22, 5
  v_mov_b32 v1, 1
  v_mov_b32 v2, s54
  s_mov_b64 exec, 1
  buffer_atomic_add v1, v2, s[16:19], 0 offen sc0
  s_mov_b64 exec, -1
  v_lshlrev_b32 v2, 5, v0
  s_mov_b32 s63, 0
  s_waitcnt vmcnt(0)
  v_readfirstlane_b32 s53, v1
L_role_poll:
  buffer_load_dword v3, v2, s[16:19], 0 offen sc1
  s_add_u32 s63, s63, 1
  s_waitcnt vmcnt(0)
  v_readlane_b32 s54, v3, 0
  v_readlane_b32 s55, v3, 1
  v_readlane_b32 s56, v3, 2
  v_readlane_b32 s57, v3, 3
  v_readlane_b32 s58, v3, 4
  v_readlane_b32 s59, v3, 5
  v_readlane_b32 s60, v3, 6
  v_readlane_b32 s61, v3, 7
  s_add_u32 s62, s54, s55
  s_add_u32 s62, s62, s56
  s_add_u32 s62, s62, s57
  s_add_u32 s62, s62, s58
  s_add_u32 s62, s62, s59
  s_add_u32 s62, s62, s60
  s_add_u32 s62, s62, s61
  s_cmp_ge_u32 s63, 0x4000
  s_cbranch_scc1 L_role_done
  s_cmp_lt_u32 s62, 256
  s_cbranch_scc1 L_role_poll
L_role_done:
  s_mov_b32 s62, 8
  s_cmp_ge_u32 s61, 32
  s_cselect_b32 s62, 7, s62
  s_cmp_ge_u32 s60, 32
  s_cselect_b32 s62, 6, s62
  s_cmp_ge_u32 s59, 32
  s_cselect_b32 s62, 5, s62
  s_cmp_ge_u32 s58, 32
  s_cselect_b32 s62, 4, s62
  s_cmp_ge_u32 s57, 32
  s_cselect_b32 s62, 3, s62
  s_cmp_ge_u32 s56, 32
  s_cselect_b32 s62, 2, s62
  s_cmp_ge_u32 s55, 32
  s_cselect_b32 s62, 1, s62
  s_cmp_ge_u32 s54, 32
  s_cselect_b32 s62, 0, s62
  s_mov_b32 s63, 0
  s_cmp_gt_u32 s22, 0
  s_cselect_b32 s64, s54, 0
  s_add_u32 s63, s63, s64
  s_cmp_gt_u32 s22, 1
  s_cselect_b32 s64, s55, 0
  s_add_u32 s63, s63, s64
  s_cmp_gt_u32 s22, 2
  s_cselect_b32 s64, s56, 0
  s_add_u32 s63, s63, s64
  s_cmp_gt_u32 s22, 3
  s_cselect_b32 s64, s57, 0
  s_add_u32 s63, s63, s64
  s_cmp_gt_u32 s22, 4
  s_cselect_b32 s64, s58, 0
  s_add_u32 s63, s63, s64
  s_cmp_gt_u32 s22, 5
  s_cselect_b32 s64, s59, 0
  s_add_u32 s63, s63, s64
  s_cmp_gt_u32 s22, 6
  s_cselect_b32 s64, s60, 0
  s_add_u32 s63, s63, s64
  s_add_u32 s63, s63, s53
  s_cmp_ge_u32 s22, s62
  s_cselect_b32 s64, 32, 0
  s_sub_u32 s63, s63, s64
  s_mov_b32 s64, 0
  s_cmp_lg_u32 s22, s62
  s_cbranch_scc1 L_role_pub
  s_cmp_ge_u32 s53, 32
  s_cbranch_scc1 L_role_pub
  s_mov_b32 s64, 1
  s_mov_b32 s63, s53
L_role_pub:
  v_mov_b32 v2, s64
  v_mov_b32 v3, s63
  ds_write_b64 v4, v[2:3]
  s_waitcnt lgkmcnt(0)
L_role_wait:
  s_barrier
  ds_read_b64 v[2:3], v4
  s_waitcnt lgkmcnt(0)
  v_readfirstlane_b32 s23, v2
  v_readfirstlane_b32 s21, v3
  s_barrier
  s_cmp_eq_u32 s23, 0
  s_cbranch_scc1 L_worker
  v_mov_b32 v40, -1
  v_mov_b32 v41, -1
  v_mov_b32 v42, -1
  v_mov_b32 v43, -1
  v_lshlrev_b32 v44, 4, v0
  s_mul_i32 s64, s21, 9216
  s_lshl_b32 s65, s20, 11
  s_add_u32 s65, s64, s65
  s_add_u32 s66, s65, 0x3000000
  buffer_store_dwordx4 v[40:43], v44, s[4:7], s66 offen
  buffer_store_dwordx4 v[40:43], v44, s[4:7], s66 offen offset:1024
  s_add_u32 s66, s64, 0x3002000
  buffer_store_dwordx4 v[40:43], v44, s[4:7], s66 offen
  s_add_u32 s66, s65, 0x3080000
  buffer_store_dwordx4 v[40:43], v44, s[4:7], s66 offen
  buffer_store_dwordx4 v[40:43], v44, s[4:7], s66 offen offset:1024
  s_add_u32 s66, s64, 0x3082000
  buffer_store_dwordx4 v[40:43], v44, s[4:7], s66 offen
  s_lshl_b32 s65, s21, 10
  s_add_u32 s66, s65, 0x3100000
  buffer_store_dwordx4 v[40:43], v44, s[4:7], s66 offen
  s_waitcnt vmcnt(0)
  s_barrier
  s_cmp_lg_u32 s20, 0
  s_cbranch_scc1 L_ri_skip
  v_mov_b32 v40, 1
  v_mov_b32 v41, 4
  s_mov_b64 exec, 1
  buffer_atomic_add v40, v41, s[16:19], 0 offen
  s_mov_b64 exec, -1
L_ri_skip:
  v_and_b32 v22, 15, v0
  v_lshrrev_b32 v23, 4, v0
  v_lshlrev_b32 v24, 4, v22
  v_lshl_add_u32 v30, v23, 13, v24
  v_mul_u32_u24 v31, 1152, v23
  v_add_u32 v31, v31, v24
  v_lshrrev_b32 v25, 3, v0
  v_mul_u32_u24 v32, 1152, v25
  v_and_b32 v25, 7, v0
  v_lshl_add_u32 v32, v25, 4, v32
  v_lshrrev_b32 v25, 2, v22
  v_and_b32 v26, 3, v22
  v_and_b32 v27, 1, v23
  v_lshrrev_b32 v28, 1, v23
  v_and_b32 v29, 1, v25
  v_lshrrev_b32 v25, 1, v25
  v_lshlrev_b32 v26, 3, v26
  v_lshl_add_u32 v33, v28, 4, v27
  v_lshl_add_u32 v33, v29, 1, v33
  v_lshl_add_u32 v33, v25, 3, v33
  v_lshl_add_u32 v33, v33, 8, v26
  s_lshl_b32 s64, s20, 6
  v_add_u32 v33, s64, v33
  v_lshlrev_b32 v36, 4, v27
  v_lshl_add_u32 v36, v28, 2, v36
  v_add_u32 v36, v36, v29
  v_lshl_add_u32 v34, v36, 8, v26
  v_lshl_add_u32 v34, v25, 7, v34
  s_lshl_b32 s64, s20, 5
  v_add_u32 v34, s64, v34
  v_lshl_add_u32 v35, v25, 5, v36
  v_lshl_add_u32 v35, v35, 7, v26
  v_add_u32 v35, s64, v35
  s_lshl_b32 s64, s20, 12
  v_lshlrev_b32 v39, 4, v0
  v_add_u32 v39, s64, v39
  s_lshl_b32 s65, s21, 8
  s_lshl_b32 s64, s20, 17
  s_add_u32 s65, s65, s64
  s_mul_i32 s66, s21, 147456
  s_mul_i32 s64, s20, 36864
  s_add_u32 s67, s66, s64
  s_mul_i32 s64, s20, 18432
  s_add_u32 s66, s66, s64
  s_lshl_b32 s76, s20, 12
  s_mov_b32 s8, s28
  s_and_b32 s9, s29, 0xffff
  s_mov_b32 s10, 0x480000
  s_mov_b32 s11, 0x20000
  s_mov_b32 s12, s30
  s_and_b32 s13, s31, 0xffff
  s_mov_b32 s14, 0x480000
  s_mov_b32 s15, 0x20000
  s_mov_b32 s84, s32
  s_and_b32 s85, s33, 0xffff
  s_mov_b32 s86, 0x480000
  s_mov_b32 s87, 0x20000
  s_mov_b32 s88, s34
  s_and_b32 s89, s35, 0xffff
  s_mov_b32 s90, 0x480000
  s_mov_b32 s91, 0x20000
  s_add_u32 m0, s76, 16384
  s_add_u32 s77, s65, 0
  buffer_load_dwordx4 v30, s[8:11], s77 offen lds
  s_add_u32 m0, s76, 17408
  s_add_u32 s77, s65, 32768
  buffer_load_dwordx4 v30, s[8:11], s77 offen lds
  s_add_u32 m0, s76, 18432
  s_add_u32 s77, s65, 65536
  buffer_load_dwordx4 v30, s[8:11], s77 offen lds
  s_add_u32 m0, s76, 19456
  s_add_u32 s77, s65, 98304
  buffer_load_dwordx4 v30, s[8:11], s77 offen lds
  s_add_u32 m0, s76, 32768
  s_add_u32 s77, s65, 524288
  buffer_load_dwordx4 v30, s[8:11], s77 offen lds
  s_add_u32 m0, s76, 33792
  s_add_u32 s77, s65, 557056
  buffer_load_dwordx4 v30, s[8:11], s77 offen lds
  s_add_u32 m0, s76, 34816
  s_add_u32 s77, s65, 589824
  buffer_load_dwordx4 v30, s[8:11], s77 offen lds
  s_add_u32 m0, s76, 35840
  s_add_u32 s77, s65, 622592
  buffer_load_dwordx4 v30, s[8:11], s77 offen lds
  s_add_u32 m0, s76, 49152
  s_add_u32 s77, s65, 1048576
  buffer_load_dwordx4 v30, s[8:11], s77 offen lds
  s_add_u32 m0, s76, 50176
  s_add_u32 s77, s65, 1081344
  buffer_load_dwordx4 v30, s[8:11], s77 offen lds
  s_add_u32 m0, s76, 51200
  s_add_u32 s77, s65, 1114112
  buffer_load_dwordx4 v30, s[8:11], s77 offen lds
  s_add_u32 m0, s76, 52224
  s_add_u32 s77, s65, 1146880
  buffer_load_dwordx4 v30, s[8:11], s77 offen lds
  s_add_u32 m0, s76, 65536
  s_add_u32 s77, s65, 1572864
  buffer_load_dwordx4 v30, s[8:11], s77 offen lds
  s_add_u32 m0, s76, 66560
  s_add_u32 s77, s65, 1605632
  buffer_load_dwordx4 v30, s[8:11], s77 offen lds
  s_add_u32 m0, s76, 67584
  s_add_u32 s77, s65, 1638400
  buffer_load_dwordx4 v30, s[8:11], s77 offen lds
  s_add_u32 m0, s76, 68608
  s_add_u32 s77, s65, 1671168
  buffer_load_dwordx4 v30, s[8:11], s77 offen lds
  s_add_u32 m0, s76, 81920
  s_add_u32 s77, s65, 2097152
  buffer_load_dwordx4 v30, s[8:11], s77 offen lds
  s_add_u32 m0, s76, 82944
  s_add_u32 s77, s65, 2129920
  buffer_load_dwordx4 v30, s[8:11], s77 offen lds
  s_add_u32 m0, s76, 83968
  s_add_u32 s77, s65, 2162688
  buffer_load_dwordx4 v30, s[8:11], s77 offen lds
  s_add_u32 m0, s76, 84992
  s_add_u32 s77, s65, 2195456
  buffer_load_dwordx4 v30, s[8:11], s77 offen lds
  s_add_u32 m0, s76, 98304
  s_add_u32 s77, s65, 2621440
  buffer_load_dwordx4 v30, s[8:11], s77 offen lds
  s_add_u32 m0, s76, 99328
  s_add_u32 s77, s65, 2654208
  buffer_load_dwordx4 v30, s[8:11], s77 offen lds
  s_add_u32 m0, s76, 100352
  s_add_u32 s77, s65, 2686976
  buffer_load_dwordx4 v30, s[8:11], s77 offen lds
  s_add_u32 m0, s76, 101376
  s_add_u32 s77, s65, 2719744
  buffer_load_dwordx4 v30, s[8:11], s77 offen lds
  s_add_u32 m0, s76, 114688
  s_add_u32 s77, s65, 3145728
  buffer_load_dwordx4 v30, s[8:11], s77 offen lds
  s_add_u32 m0, s76, 115712
  s_add_u32 s77, s65, 3178496
  buffer_load_dwordx4 v30, s[8:11], s77 offen lds
  s_add_u32 m0, s76, 116736
  s_add_u32 s77, s65, 3211264
  buffer_load_dwordx4 v30, s[8:11], s77 offen lds
  s_add_u32 m0, s76, 117760
  s_add_u32 s77, s65, 3244032
  buffer_load_dwordx4 v30, s[8:11], s77 offen lds
  s_add_u32 m0, s76, 131072
  s_add_u32 s77, s65, 3670016
  buffer_load_dwordx4 v30, s[8:11], s77 offen lds
  s_add_u32 m0, s76, 132096
  s_add_u32 s77, s65, 3702784
  buffer_load_dwordx4 v30, s[8:11], s77 offen lds
  s_add_u32 m0, s76, 133120
  s_add_u32 s77, s65, 3735552
  buffer_load_dwordx4 v30, s[8:11], s77 offen lds
  s_add_u32 m0, s76, 134144
  s_add_u32 s77, s65, 3768320
  buffer_load_dwordx4 v30, s[8:11], s77 offen lds
  s_waitcnt vmcnt(28) lgkmcnt(0)
  s_barrier
  s_add_u32 m0, s76, 147456
  s_add_u32 s77, s65, 4194304
  buffer_load_dwordx4 v30, s[8:11], s77 offen lds
  s_add_u32 m0, s76, 148480
  s_add_u32 s77, s65, 4227072
  buffer_load_dwordx4 v30, s[8:11], s77 offen lds
  s_add_u32 m0, s76, 149504
  s_add_u32 s77, s65, 4259840
  buffer_load_dwordx4 v30, s[8:11], s77 offen lds
  s_add_u32 m0, s76, 150528
  s_add_u32 s77, s65, 4292608
  buffer_load_dwordx4 v30, s[8:11], s77 offen lds
  v_add_u32 v38, 16384, v33
  ds_read_b64_tr_b16 a[0:1], v38 offset:0
  ds_read_b64_tr_b16 a[2:3], v38 offset:1024
  ds_read_b64_tr_b16 a[4:5], v38 offset:8192
  ds_read_b64_tr_b16 a[6:7], v38 offset:9216
  ds_read_b64_tr_b16 a[8:9], v38 offset:32
  ds_read_b64_tr_b16 a[10:11], v38 offset:1056
  ds_read_b64_tr_b16 a[12:13], v38 offset:8224
  ds_read_b64_tr_b16 a[14:15], v38 offset:9248
  s_waitcnt vmcnt(28) lgkmcnt(0)
  s_barrier
  s_add_u32 m0, s76, 16384
  s_add_u32 s77, s65, 0
  buffer_load_dwordx4 v30, s[12:15], s77 offen lds
  s_add_u32 m0, s76, 17408
  s_add_u32 s77, s65, 32768
  buffer_load_dwordx4 v30, s[12:15], s77 offen lds
  s_add_u32 m0, s76, 18432
  s_add_u32 s77, s65, 65536
  buffer_load_dwordx4 v30, s[12:15], s77 offen lds
  s_add_u32 m0, s76, 19456
  s_add_u32 s77, s65, 98304
  buffer_load_dwordx4 v30, s[12:15], s77 offen lds
  v_add_u32 v38, 32768, v33
  ds_read_b64_tr_b16 a[16:17], v38 offset:0
  ds_read_b64_tr_b16 a[18:19], v38 offset:1024
  ds_read_b64_tr_b16 a[20:21], v38 offset:8192
  ds_read_b64_tr_b16 a[22:23], v38 offset:9216
  ds_read_b64_tr_b16 a[24:25], v38 offset:32
  ds_read_b64_tr_b16 a[26:27], v38 offset:1056
  ds_read_b64_tr_b16 a[28:29], v38 offset:8224
  ds_read_b64_tr_b16 a[30:31], v38 offset:9248
  s_waitcnt vmcnt(28) lgkmcnt(0)
  s_barrier
  s_add_u32 m0, s76, 32768
  s_add_u32 s77, s65, 524288
  buffer_load_dwordx4 v30, s[12:15], s77 offen lds
  s_add_u32 m0, s76, 33792
  s_add_u32 s77, s65, 557056
  buffer_load_dwordx4 v30, s[12:15], s77 offen lds
  s_add_u32 m0, s76, 34816
  s_add_u32 s77, s65, 589824
  buffer_load_dwordx4 v30, s[12:15], s77 offen lds
  s_add_u32 m0, s76, 35840
  s_add_u32 s77, s65, 622592
  buffer_load_dwordx4 v30, s[12:15], s77 offen lds
  v_add_u32 v38, 49152, v33
  ds_read_b64_tr_b16 a[32:33], v38 offset:0
  ds_read_b64_tr_b16 a[34:35], v38 offset:1024
  ds_read_b64_tr_b16 a[36:37], v38 offset:8192
  ds_read_b64_tr_b16 a[38:39], v38 offset:9216
  ds_read_b64_tr_b16 a[40:41], v38 offset:32
  ds_read_b64_tr_b16 a[42:43], v38 offset:1056
  ds_read_b64_tr_b16 a[44:45], v38 offset:8224
  ds_read_b64_tr_b16 a[46:47], v38 offset:9248
  s_waitcnt vmcnt(28) lgkmcnt(0)
  s_barrier
  s_add_u32 m0, s76, 49152
  s_add_u32 s77, s65, 1048576
  buffer_load_dwordx4 v30, s[12:15], s77 offen lds
  s_add_u32 m0, s76, 50176
  s_add_u32 s77, s65, 1081344
  buffer_load_dwordx4 v30, s[12:15], s77 offen lds
  s_add_u32 m0, s76, 51200
  s_add_u32 s77, s65, 1114112
  buffer_load_dwordx4 v30, s[12:15], s77 offen lds
  s_add_u32 m0, s76, 52224
  s_add_u32 s77, s65, 1146880
  buffer_load_dwordx4 v30, s[12:15], s77 offen lds
  v_add_u32 v38, 65536, v33
  ds_read_b64_tr_b16 a[48:49], v38 offset:0
  ds_read_b64_tr_b16 a[50:51], v38 offset:1024
  ds_read_b64_tr_b16 a[52:53], v38 offset:8192
  ds_read_b64_tr_b16 a[54:55], v38 offset:9216
  ds_read_b64_tr_b16 a[56:57], v38 offset:32
  ds_read_b64_tr_b16 a[58:59], v38 offset:1056
  ds_read_b64_tr_b16 a[60:61], v38 offset:8224
  ds_read_b64_tr_b16 a[62:63], v38 offset:9248
  s_waitcnt vmcnt(28) lgkmcnt(0)
  s_barrier
  s_add_u32 m0, s76, 65536
  s_add_u32 s77, s65, 1572864
  buffer_load_dwordx4 v30, s[12:15], s77 offen lds
  s_add_u32 m0, s76, 66560
  s_add_u32 s77, s65, 1605632
  buffer_load_dwordx4 v30, s[12:15], s77 offen lds
  s_add_u32 m0, s76, 67584
  s_add_u32 s77, s65, 1638400
  buffer_load_dwordx4 v30, s[12:15], s77 offen lds
  s_add_u32 m0, s76, 68608
  s_add_u32 s77, s65, 1671168
  buffer_load_dwordx4 v30, s[12:15], s77 offen lds
  v_add_u32 v38, 81920, v33
  ds_read_b64_tr_b16 a[64:65], v38 offset:0
  ds_read_b64_tr_b16 a[66:67], v38 offset:1024
  ds_read_b64_tr_b16 a[68:69], v38 offset:8192
  ds_read_b64_tr_b16 a[70:71], v38 offset:9216
  ds_read_b64_tr_b16 a[72:73], v38 offset:32
  ds_read_b64_tr_b16 a[74:75], v38 offset:1056
  ds_read_b64_tr_b16 a[76:77], v38 offset:8224
  ds_read_b64_tr_b16 a[78:79], v38 offset:9248
  s_waitcnt vmcnt(28) lgkmcnt(0)
  s_barrier
  s_add_u32 m0, s76, 81920
  s_add_u32 s77, s65, 0
  buffer_load_dwordx4 v30, s[84:87], s77 offen lds
  s_add_u32 m0, s76, 82944
  s_add_u32 s77, s65, 32768
  buffer_load_dwordx4 v30, s[84:87], s77 offen lds
  s_add_u32 m0, s76, 83968
  s_add_u32 s77, s65, 65536
  buffer_load_dwordx4 v30, s[84:87], s77 offen lds
  s_add_u32 m0, s76, 84992
  s_add_u32 s77, s65, 98304
  buffer_load_dwordx4 v30, s[84:87], s77 offen lds
  v_add_u32 v38, 98304, v33
  ds_read_b64_tr_b16 a[80:81], v38 offset:0
  ds_read_b64_tr_b16 a[82:83], v38 offset:1024
  ds_read_b64_tr_b16 a[84:85], v38 offset:8192
  ds_read_b64_tr_b16 a[86:87], v38 offset:9216
  ds_read_b64_tr_b16 a[88:89], v38 offset:32
  ds_read_b64_tr_b16 a[90:91], v38 offset:1056
  ds_read_b64_tr_b16 a[92:93], v38 offset:8224
  ds_read_b64_tr_b16 a[94:95], v38 offset:9248
  s_waitcnt vmcnt(28) lgkmcnt(0)
  s_barrier
  s_add_u32 m0, s76, 98304
  s_add_u32 s77, s65, 524288
  buffer_load_dwordx4 v30, s[84:87], s77 offen lds
  s_add_u32 m0, s76, 99328
  s_add_u32 s77, s65, 557056
  buffer_load_dwordx4 v30, s[84:87], s77 offen lds
  s_add_u32 m0, s76, 100352
  s_add_u32 s77, s65, 589824
  buffer_load_dwordx4 v30, s[84:87], s77 offen lds
  s_add_u32 m0, s76, 101376
  s_add_u32 s77, s65, 622592
  buffer_load_dwordx4 v30, s[84:87], s77 offen lds
  v_add_u32 v38, 114688, v33
  ds_read_b64_tr_b16 a[96:97], v38 offset:0
  ds_read_b64_tr_b16 a[98:99], v38 offset:1024
  ds_read_b64_tr_b16 a[100:101], v38 offset:8192
  ds_read_b64_tr_b16 a[102:103], v38 offset:9216
  ds_read_b64_tr_b16 a[104:105], v38 offset:32
  ds_read_b64_tr_b16 a[106:107], v38 offset:1056
  ds_read_b64_tr_b16 a[108:109], v38 offset:8224
  ds_read_b64_tr_b16 a[110:111], v38 offset:9248
  s_waitcnt vmcnt(28) lgkmcnt(0)
  s_barrier
  s_add_u32 m0, s76, 114688
  s_add_u32 s77, s65, 1048576
  buffer_load_dwordx4 v30, s[84:87], s77 offen lds
  s_add_u32 m0, s76, 115712
  s_add_u32 s77, s65, 1081344
  buffer_load_dwordx4 v30, s[84:87], s77 offen lds
  s_add_u32 m0, s76, 116736
  s_add_u32 s77, s65, 1114112
  buffer_load_dwordx4 v30, s[84:87], s77 offen lds
  s_add_u32 m0, s76, 117760
  s_add_u32 s77, s65, 1146880
  buffer_load_dwordx4 v30, s[84:87], s77 offen lds
  v_add_u32 v38, 131072, v33
  ds_read_b64_tr_b16 a[112:113], v38 offset:0
  ds_read_b64_tr_b16 a[114:115], v38 offset:1024
  ds_read_b64_tr_b16 a[116:117], v38 offset:8192
  ds_read_b64_tr_b16 a[118:119], v38 offset:9216
  ds_read_b64_tr_b16 a[120:121], v38 offset:32
  ds_read_b64_tr_b16 a[122:123], v38 offset:1056
  ds_read_b64_tr_b16 a[124:125], v38 offset:8224
  ds_read_b64_tr_b16 a[126:127], v38 offset:9248
  s_waitcnt vmcnt(28) lgkmcnt(0)
  s_barrier
  s_add_u32 m0, s76, 131072
  s_add_u32 s77, s65, 1572864
  buffer_load_dwordx4 v30, s[84:87], s77 offen lds
  s_add_u32 m0, s76, 132096
  s_add_u32 s77, s65, 1605632
  buffer_load_dwordx4 v30, s[84:87], s77 offen lds
  s_add_u32 m0, s76, 133120
  s_add_u32 s77, s65, 1638400
  buffer_load_dwordx4 v30, s[84:87], s77 offen lds
  s_add_u32 m0, s76, 134144
  s_add_u32 s77, s65, 1671168
  buffer_load_dwordx4 v30, s[84:87], s77 offen lds
  v_add_u32 v38, 147456, v33
  ds_read_b64_tr_b16 a[128:129], v38 offset:0
  ds_read_b64_tr_b16 a[130:131], v38 offset:1024
  ds_read_b64_tr_b16 a[132:133], v38 offset:8192
  ds_read_b64_tr_b16 a[134:135], v38 offset:9216
  ds_read_b64_tr_b16 a[136:137], v38 offset:32
  ds_read_b64_tr_b16 a[138:139], v38 offset:1056
  ds_read_b64_tr_b16 a[140:141], v38 offset:8224
  ds_read_b64_tr_b16 a[142:143], v38 offset:9248
  s_waitcnt vmcnt(28) lgkmcnt(0)
  s_barrier
  s_add_u32 m0, s76, 147456
  s_add_u32 s77, s65, 2097152
  buffer_load_dwordx4 v30, s[84:87], s77 offen lds
  s_add_u32 m0, s76, 148480
  s_add_u32 s77, s65, 2129920
  buffer_load_dwordx4 v30, s[84:87], s77 offen lds
  s_add_u32 m0, s76, 149504
  s_add_u32 s77, s65, 2162688
  buffer_load_dwordx4 v30, s[84:87], s77 offen lds
  s_add_u32 m0, s76, 150528
  s_add_u32 s77, s65, 2195456
  buffer_load_dwordx4 v30, s[84:87], s77 offen lds
  v_add_u32 v38, 16384, v33
  ds_read_b64_tr_b16 a[144:145], v38 offset:0
  ds_read_b64_tr_b16 a[146:147], v38 offset:1024
  ds_read_b64_tr_b16 a[148:149], v38 offset:8192
  ds_read_b64_tr_b16 a[150:151], v38 offset:9216
  ds_read_b64_tr_b16 a[152:153], v38 offset:32
  ds_read_b64_tr_b16 a[154:155], v38 offset:1056
  ds_read_b64_tr_b16 a[156:157], v38 offset:8224
  ds_read_b64_tr_b16 a[158:159], v38 offset:9248
  s_waitcnt vmcnt(28) lgkmcnt(0)
  s_barrier
  s_add_u32 m0, s76, 16384
  s_add_u32 s77, s65, 2621440
  buffer_load_dwordx4 v30, s[84:87], s77 offen lds
  s_add_u32 m0, s76, 17408
  s_add_u32 s77, s65, 2654208
  buffer_load_dwordx4 v30, s[84:87], s77 offen lds
  s_add_u32 m0, s76, 18432
  s_add_u32 s77, s65, 2686976
  buffer_load_dwordx4 v30, s[84:87], s77 offen lds
  s_add_u32 m0, s76, 19456
  s_add_u32 s77, s65, 2719744
  buffer_load_dwordx4 v30, s[84:87], s77 offen lds
  v_add_u32 v38, 32768, v33
  ds_read_b64_tr_b16 a[160:161], v38 offset:0
  ds_read_b64_tr_b16 a[162:163], v38 offset:1024
  ds_read_b64_tr_b16 a[164:165], v38 offset:8192
  ds_read_b64_tr_b16 a[166:167], v38 offset:9216
  ds_read_b64_tr_b16 a[168:169], v38 offset:32
  ds_read_b64_tr_b16 a[170:171], v38 offset:1056
  ds_read_b64_tr_b16 a[172:173], v38 offset:8224
  ds_read_b64_tr_b16 a[174:175], v38 offset:9248
  s_waitcnt vmcnt(28) lgkmcnt(0)
  s_barrier
  s_add_u32 m0, s76, 32768
  s_add_u32 s77, s65, 3145728
  buffer_load_dwordx4 v30, s[84:87], s77 offen lds
  s_add_u32 m0, s76, 33792
  s_add_u32 s77, s65, 3178496
  buffer_load_dwordx4 v30, s[84:87], s77 offen lds
  s_add_u32 m0, s76, 34816
  s_add_u32 s77, s65, 3211264
  buffer_load_dwordx4 v30, s[84:87], s77 offen lds
  s_add_u32 m0, s76, 35840
  s_add_u32 s77, s65, 3244032
  buffer_load_dwordx4 v30, s[84:87], s77 offen lds
  v_add_u32 v38, 49152, v33
  ds_read_b64_tr_b16 a[176:177], v38 offset:0
  ds_read_b64_tr_b16 a[178:179], v38 offset:1024
  ds_read_b64_tr_b16 a[180:181], v38 offset:8192
  ds_read_b64_tr_b16 a[182:183], v38 offset:9216
  ds_read_b64_tr_b16 a[184:185], v38 offset:32
  ds_read_b64_tr_b16 a[186:187], v38 offset:1056
  ds_read_b64_tr_b16 a[188:189], v38 offset:8224
  ds_read_b64_tr_b16 a[190:191], v38 offset:9248
  s_waitcnt vmcnt(28) lgkmcnt(0)
  s_barrier
  s_add_u32 m0, s76, 49152
  s_add_u32 s77, s65, 3670016
  buffer_load_dwordx4 v30, s[84:87], s77 offen lds
  s_add_u32 m0, s76, 50176
  s_add_u32 s77, s65, 3702784
  buffer_load_dwordx4 v30, s[84:87], s77 offen lds
  s_add_u32 m0, s76, 51200
  s_add_u32 s77, s65, 3735552
  buffer_load_dwordx4 v30, s[84:87], s77 offen lds
  s_add_u32 m0, s76, 52224
  s_add_u32 s77, s65, 3768320
  buffer_load_dwordx4 v30, s[84:87], s77 offen lds
  v_add_u32 v38, 65536, v33
  ds_read_b64_tr_b16 a[192:193], v38 offset:0
  ds_read_b64_tr_b16 a[194:195], v38 offset:1024
  ds_read_b64_tr_b16 a[196:197], v38 offset:8192
  ds_read_b64_tr_b16 a[198:199], v38 offset:9216
  ds_read_b64_tr_b16 a[200:201], v38 offset:32
  ds_read_b64_tr_b16 a[202:203], v38 offset:1056
  ds_read_b64_tr_b16 a[204:205], v38 offset:8224
  ds_read_b64_tr_b16 a[206:207], v38 offset:9248
  s_waitcnt vmcnt(28) lgkmcnt(0)
  s_barrier
  s_add_u32 m0, s76, 65536
  s_add_u32 s77, s65, 4194304
  buffer_load_dwordx4 v30, s[84:87], s77 offen lds
  s_add_u32 m0, s76, 66560
  s_add_u32 s77, s65, 4227072
  buffer_load_dwordx4 v30, s[84:87], s77 offen lds
  s_add_u32 m0, s76, 67584
  s_add_u32 s77, s65, 4259840
  buffer_load_dwordx4 v30, s[84:87], s77 offen lds
  s_add_u32 m0, s76, 68608
  s_add_u32 s77, s65, 4292608
  buffer_load_dwordx4 v30, s[84:87], s77 offen lds
  v_add_u32 v38, 81920, v33
  ds_read_b64_tr_b16 a[208:209], v38 offset:0
  ds_read_b64_tr_b16 a[210:211], v38 offset:1024
  ds_read_b64_tr_b16 a[212:213], v38 offset:8192
  ds_read_b64_tr_b16 a[214:215], v38 offset:9216
  ds_read_b64_tr_b16 a[216:217], v38 offset:32
  ds_read_b64_tr_b16 a[218:219], v38 offset:1056
  ds_read_b64_tr_b16 a[220:221], v38 offset:8224
  ds_read_b64_tr_b16 a[222:223], v38 offset:9248
  s_waitcnt vmcnt(28) lgkmcnt(0)
  s_barrier
  s_add_u32 m0, s76, 81920
  s_add_u32 s77, s67, 0
  buffer_load_dwordx4 v32, s[88:91], s77 offen lds
  s_add_u32 m0, s76, 82944
  s_add_u32 s77, s67, 9216
  buffer_load_dwordx4 v32, s[88:91], s77 offen lds
  s_add_u32 m0, s76, 83968
  s_add_u32 s77, s67, 18432
  buffer_load_dwordx4 v32, s[88:91], s77 offen lds
  s_add_u32 m0, s76, 84992
  s_add_u32 s77, s67, 27648
  buffer_load_dwordx4 v32, s[88:91], s77 offen lds
  v_add_u32 v38, 98304, v33
  ds_read_b64_tr_b16 a[224:225], v38 offset:0
  ds_read_b64_tr_b16 a[226:227], v38 offset:1024
  ds_read_b64_tr_b16 a[228:229], v38 offset:8192
  ds_read_b64_tr_b16 a[230:231], v38 offset:9216
  ds_read_b64_tr_b16 a[232:233], v38 offset:32
  ds_read_b64_tr_b16 a[234:235], v38 offset:1056
  ds_read_b64_tr_b16 a[236:237], v38 offset:8224
  ds_read_b64_tr_b16 a[238:239], v38 offset:9248
  s_waitcnt vmcnt(28) lgkmcnt(0)
  s_barrier
  s_add_u32 m0, s76, 98304
  s_add_u32 s77, s66, 73856
  buffer_load_dwordx4 v31, s[88:91], s77 offen lds
  s_add_u32 m0, s76, 99328
  s_add_u32 s77, s66, 78464
  buffer_load_dwordx4 v31, s[88:91], s77 offen lds
  s_add_u32 m0, s76, 100352
  s_add_u32 s77, s66, 83072
  buffer_load_dwordx4 v31, s[88:91], s77 offen lds
  s_add_u32 m0, s76, 101376
  s_add_u32 s77, s66, 87680
  buffer_load_dwordx4 v31, s[88:91], s77 offen lds
  v_add_u32 v38, 114688, v33
  ds_read_b64_tr_b16 a[240:241], v38 offset:0
  ds_read_b64_tr_b16 a[242:243], v38 offset:1024
  ds_read_b64_tr_b16 a[244:245], v38 offset:8192
  ds_read_b64_tr_b16 a[246:247], v38 offset:9216
  ds_read_b64_tr_b16 a[248:249], v38 offset:32
  ds_read_b64_tr_b16 a[250:251], v38 offset:1056
  ds_read_b64_tr_b16 a[252:253], v38 offset:8224
  ds_read_b64_tr_b16 a[254:255], v38 offset:9248
  s_waitcnt vmcnt(28) lgkmcnt(0)
  s_barrier
  s_add_u32 m0, s76, 114688
  s_add_u32 s77, s66, 74112
  buffer_load_dwordx4 v31, s[88:91], s77 offen lds
  s_add_u32 m0, s76, 115712
  s_add_u32 s77, s66, 78720
  buffer_load_dwordx4 v31, s[88:91], s77 offen lds
  s_add_u32 m0, s76, 116736
  s_add_u32 s77, s66, 83328
  buffer_load_dwordx4 v31, s[88:91], s77 offen lds
  s_add_u32 m0, s76, 117760
  s_add_u32 s77, s66, 87936
  buffer_load_dwordx4 v31, s[88:91], s77 offen lds
  v_add_u32 v38, 131072, v33
  ds_read_b64_tr_b16 v[80:81], v38 offset:0
  ds_read_b64_tr_b16 v[82:83], v38 offset:1024
  ds_read_b64_tr_b16 v[84:85], v38 offset:8192
  ds_read_b64_tr_b16 v[86:87], v38 offset:9216
  ds_read_b64_tr_b16 v[88:89], v38 offset:32
  ds_read_b64_tr_b16 v[90:91], v38 offset:1056
  ds_read_b64_tr_b16 v[92:93], v38 offset:8224
  ds_read_b64_tr_b16 v[94:95], v38 offset:9248
  s_waitcnt vmcnt(28) lgkmcnt(0)
  s_barrier
  s_add_u32 m0, s76, 131072
  s_add_u32 s77, s66, 74368
  buffer_load_dwordx4 v31, s[88:91], s77 offen lds
  s_add_u32 m0, s76, 132096
  s_add_u32 s77, s66, 78976
  buffer_load_dwordx4 v31, s[88:91], s77 offen lds
  s_add_u32 m0, s76, 133120
  s_add_u32 s77, s66, 83584
  buffer_load_dwordx4 v31, s[88:91], s77 offen lds
  s_add_u32 m0, s76, 134144
  s_add_u32 s77, s66, 88192
  buffer_load_dwordx4 v31, s[88:91], s77 offen lds
  v_add_u32 v38, 147456, v33
  ds_read_b64_tr_b16 v[96:97], v38 offset:0
  ds_read_b64_tr_b16 v[98:99], v38 offset:1024
  ds_read_b64_tr_b16 v[100:101], v38 offset:8192
  ds_read_b64_tr_b16 v[102:103], v38 offset:9216
  ds_read_b64_tr_b16 v[104:105], v38 offset:32
  ds_read_b64_tr_b16 v[106:107], v38 offset:1056
  ds_read_b64_tr_b16 v[108:109], v38 offset:8224
  ds_read_b64_tr_b16 v[110:111], v38 offset:9248
  s_waitcnt vmcnt(28) lgkmcnt(0)
  s_barrier
  s_add_u32 m0, s76, 147456
  s_add_u32 s77, s66, 74624
  buffer_load_dwordx4 v31, s[88:91], s77 offen lds
  s_add_u32 m0, s76, 148480
  s_add_u32 s77, s66, 79232
  buffer_load_dwordx4 v31, s[88:91], s77 offen lds
  s_add_u32 m0, s76, 149504
  s_add_u32 s77, s66, 83840
  buffer_load_dwordx4 v31, s[88:91], s77 offen lds
  s_add_u32 m0, s76, 150528
  s_add_u32 s77, s66, 88448
  buffer_load_dwordx4 v31, s[88:91], s77 offen lds
  v_add_u32 v38, 16384, v33
  ds_read_b64_tr_b16 v[112:113], v38 offset:0
  ds_read_b64_tr_b16 v[114:115], v38 offset:1024
  ds_read_b64_tr_b16 v[116:117], v38 offset:8192
  ds_read_b64_tr_b16 v[118:119], v38 offset:9216
  ds_read_b64_tr_b16 v[120:121], v38 offset:32
  ds_read_b64_tr_b16 v[122:123], v38 offset:1056
  ds_read_b64_tr_b16 v[124:125], v38 offset:8224
  ds_read_b64_tr_b16 v[126:127], v38 offset:9248
  s_waitcnt vmcnt(28) lgkmcnt(0)
  s_barrier
  s_add_u32 m0, s76, 16384
  s_add_u32 s77, s65, 2097152
  buffer_load_dwordx4 v30, s[12:15], s77 offen lds
  s_add_u32 m0, s76, 17408
  s_add_u32 s77, s65, 2129920
  buffer_load_dwordx4 v30, s[12:15], s77 offen lds
  s_add_u32 m0, s76, 18432
  s_add_u32 s77, s65, 2162688
  buffer_load_dwordx4 v30, s[12:15], s77 offen lds
  s_add_u32 m0, s76, 19456
  s_add_u32 s77, s65, 2195456
  buffer_load_dwordx4 v30, s[12:15], s77 offen lds
  v_add_u32 v38, 32768, v33
  ds_read_b64_tr_b16 v[128:129], v38 offset:0
  ds_read_b64_tr_b16 v[130:131], v38 offset:1024
  ds_read_b64_tr_b16 v[132:133], v38 offset:8192
  ds_read_b64_tr_b16 v[134:135], v38 offset:9216
  ds_read_b64_tr_b16 v[136:137], v38 offset:32
  ds_read_b64_tr_b16 v[138:139], v38 offset:1056
  ds_read_b64_tr_b16 v[140:141], v38 offset:8224
  ds_read_b64_tr_b16 v[142:143], v38 offset:9248
  s_waitcnt vmcnt(28) lgkmcnt(0)
  s_barrier
  s_add_u32 m0, s76, 32768
  s_add_u32 s77, s65, 2621440
  buffer_load_dwordx4 v30, s[12:15], s77 offen lds
  s_add_u32 m0, s76, 33792
  s_add_u32 s77, s65, 2654208
  buffer_load_dwordx4 v30, s[12:15], s77 offen lds
  s_add_u32 m0, s76, 34816
  s_add_u32 s77, s65, 2686976
  buffer_load_dwordx4 v30, s[12:15], s77 offen lds
  s_add_u32 m0, s76, 35840
  s_add_u32 s77, s65, 2719744
  buffer_load_dwordx4 v30, s[12:15], s77 offen lds
  v_add_u32 v38, 49152, v33
  ds_read_b64_tr_b16 v[144:145], v38 offset:0
  ds_read_b64_tr_b16 v[146:147], v38 offset:1024
  ds_read_b64_tr_b16 v[148:149], v38 offset:8192
  ds_read_b64_tr_b16 v[150:151], v38 offset:9216
  ds_read_b64_tr_b16 v[152:153], v38 offset:32
  ds_read_b64_tr_b16 v[154:155], v38 offset:1056
  ds_read_b64_tr_b16 v[156:157], v38 offset:8224
  ds_read_b64_tr_b16 v[158:159], v38 offset:9248
  s_waitcnt vmcnt(28) lgkmcnt(0)
  s_barrier
  s_add_u32 m0, s76, 49152
  s_add_u32 s77, s65, 3145728
  buffer_load_dwordx4 v30, s[12:15], s77 offen lds
  s_add_u32 m0, s76, 50176
  s_add_u32 s77, s65, 3178496
  buffer_load_dwordx4 v30, s[12:15], s77 offen lds
  s_add_u32 m0, s76, 51200
  s_add_u32 s77, s65, 3211264
  buffer_load_dwordx4 v30, s[12:15], s77 offen lds
  s_add_u32 m0, s76, 52224
  s_add_u32 s77, s65, 3244032
  buffer_load_dwordx4 v30, s[12:15], s77 offen lds
  v_add_u32 v38, 65536, v33
  ds_read_b64_tr_b16 v[160:161], v38 offset:0
  ds_read_b64_tr_b16 v[162:163], v38 offset:1024
  ds_read_b64_tr_b16 v[164:165], v38 offset:8192
  ds_read_b64_tr_b16 v[166:167], v38 offset:9216
  ds_read_b64_tr_b16 v[168:169], v38 offset:32
  ds_read_b64_tr_b16 v[170:171], v38 offset:1056
  ds_read_b64_tr_b16 v[172:173], v38 offset:8224
  ds_read_b64_tr_b16 v[174:175], v38 offset:9248
  s_waitcnt vmcnt(28) lgkmcnt(0)
  s_barrier
  s_add_u32 m0, s76, 65536
  s_add_u32 s77, s65, 3670016
  buffer_load_dwordx4 v30, s[12:15], s77 offen lds
  s_add_u32 m0, s76, 66560
  s_add_u32 s77, s65, 3702784
  buffer_load_dwordx4 v30, s[12:15], s77 offen lds
  s_add_u32 m0, s76, 67584
  s_add_u32 s77, s65, 3735552
  buffer_load_dwordx4 v30, s[12:15], s77 offen lds
  s_add_u32 m0, s76, 68608
  s_add_u32 s77, s65, 3768320
  buffer_load_dwordx4 v30, s[12:15], s77 offen lds
  v_add_u32 v38, 81920, v35
  ds_read_b64_tr_b16 v[176:177], v38 offset:0
  ds_read_b64_tr_b16 v[178:179], v38 offset:256
  ds_read_b64_tr_b16 v[180:181], v38 offset:1024
  ds_read_b64_tr_b16 v[182:183], v38 offset:1280
  ds_read_b64_tr_b16 v[184:185], v38 offset:8192
  ds_read_b64_tr_b16 v[186:187], v38 offset:8448
  ds_read_b64_tr_b16 v[188:189], v38 offset:9216
  ds_read_b64_tr_b16 v[190:191], v38 offset:9472
  s_waitcnt vmcnt(28) lgkmcnt(0)
  s_barrier
  s_add_u32 m0, s76, 81920
  s_add_u32 s77, s65, 4194304
  buffer_load_dwordx4 v30, s[12:15], s77 offen lds
  s_add_u32 m0, s76, 82944
  s_add_u32 s77, s65, 4227072
  buffer_load_dwordx4 v30, s[12:15], s77 offen lds
  s_add_u32 m0, s76, 83968
  s_add_u32 s77, s65, 4259840
  buffer_load_dwordx4 v30, s[12:15], s77 offen lds
  s_add_u32 m0, s76, 84992
  s_add_u32 s77, s65, 4292608
  buffer_load_dwordx4 v30, s[12:15], s77 offen lds
  v_add_u32 v38, 98304, v34
  ds_read_b64_tr_b16 v[192:193], v38 offset:0
  ds_read_b64_tr_b16 v[194:195], v38 offset:512
  ds_read_b64_tr_b16 v[196:197], v38 offset:2048
  ds_read_b64_tr_b16 v[198:199], v38 offset:2560
  ds_read_b64_tr_b16 v[200:201], v38 offset:8192
  ds_read_b64_tr_b16 v[202:203], v38 offset:8704
  ds_read_b64_tr_b16 v[204:205], v38 offset:10240
  ds_read_b64_tr_b16 v[206:207], v38 offset:10752
  s_waitcnt vmcnt(28) lgkmcnt(0)
  s_barrier
  s_add_u32 m0, s76, 98304
  s_add_u32 s77, s66, 128
  buffer_load_dwordx4 v31, s[88:91], s77 offen lds
  s_add_u32 m0, s76, 99328
  s_add_u32 s77, s66, 4736
  buffer_load_dwordx4 v31, s[88:91], s77 offen lds
  s_add_u32 m0, s76, 100352
  s_add_u32 s77, s66, 9344
  buffer_load_dwordx4 v31, s[88:91], s77 offen lds
  s_add_u32 m0, s76, 101376
  s_add_u32 s77, s66, 13952
  buffer_load_dwordx4 v31, s[88:91], s77 offen lds
  v_add_u32 v38, 114688, v34
  ds_read_b64_tr_b16 v[208:209], v38 offset:0
  ds_read_b64_tr_b16 v[210:211], v38 offset:512
  ds_read_b64_tr_b16 v[212:213], v38 offset:2048
  ds_read_b64_tr_b16 v[214:215], v38 offset:2560
  ds_read_b64_tr_b16 v[216:217], v38 offset:8192
  ds_read_b64_tr_b16 v[218:219], v38 offset:8704
  ds_read_b64_tr_b16 v[220:221], v38 offset:10240
  ds_read_b64_tr_b16 v[222:223], v38 offset:10752
  s_waitcnt vmcnt(28) lgkmcnt(0)
  s_barrier
  s_add_u32 m0, s76, 114688
  s_add_u32 s77, s66, 384
  buffer_load_dwordx4 v31, s[88:91], s77 offen lds
  s_add_u32 m0, s76, 115712
  s_add_u32 s77, s66, 4992
  buffer_load_dwordx4 v31, s[88:91], s77 offen lds
  s_add_u32 m0, s76, 116736
  s_add_u32 s77, s66, 9600
  buffer_load_dwordx4 v31, s[88:91], s77 offen lds
  s_add_u32 m0, s76, 117760
  s_add_u32 s77, s66, 14208
  buffer_load_dwordx4 v31, s[88:91], s77 offen lds
  v_add_u32 v38, 131072, v34
  ds_read_b64_tr_b16 v[224:225], v38 offset:0
  ds_read_b64_tr_b16 v[226:227], v38 offset:512
  ds_read_b64_tr_b16 v[228:229], v38 offset:2048
  ds_read_b64_tr_b16 v[230:231], v38 offset:2560
  ds_read_b64_tr_b16 v[232:233], v38 offset:8192
  ds_read_b64_tr_b16 v[234:235], v38 offset:8704
  ds_read_b64_tr_b16 v[236:237], v38 offset:10240
  ds_read_b64_tr_b16 v[238:239], v38 offset:10752
  s_waitcnt vmcnt(28) lgkmcnt(0)
  s_barrier
  s_add_u32 m0, s76, 131072
  s_add_u32 s77, s66, 640
  buffer_load_dwordx4 v31, s[88:91], s77 offen lds
  s_add_u32 m0, s76, 132096
  s_add_u32 s77, s66, 5248
  buffer_load_dwordx4 v31, s[88:91], s77 offen lds
  s_add_u32 m0, s76, 133120
  s_add_u32 s77, s66, 9856
  buffer_load_dwordx4 v31, s[88:91], s77 offen lds
  s_add_u32 m0, s76, 134144
  s_add_u32 s77, s66, 14464
  buffer_load_dwordx4 v31, s[88:91], s77 offen lds
  v_add_u32 v38, 147456, v34
  ds_read_b64_tr_b16 v[240:241], v38 offset:0
  ds_read_b64_tr_b16 v[242:243], v38 offset:512
  ds_read_b64_tr_b16 v[244:245], v38 offset:2048
  ds_read_b64_tr_b16 v[246:247], v38 offset:2560
  ds_read_b64_tr_b16 v[248:249], v38 offset:8192
  ds_read_b64_tr_b16 v[250:251], v38 offset:8704
  ds_read_b64_tr_b16 v[252:253], v38 offset:10240
  ds_read_b64_tr_b16 v[254:255], v38 offset:10752
  s_waitcnt vmcnt(28) lgkmcnt(0)
  s_barrier
  s_add_u32 m0, s76, 147456
  s_add_u32 s77, s66, 896
  buffer_load_dwordx4 v31, s[88:91], s77 offen lds
  s_add_u32 m0, s76, 148480
  s_add_u32 s77, s66, 5504
  buffer_load_dwordx4 v31, s[88:91], s77 offen lds
  s_add_u32 m0, s76, 149504
  s_add_u32 s77, s66, 10112
  buffer_load_dwordx4 v31, s[88:91], s77 offen lds
  s_add_u32 m0, s76, 150528
  s_add_u32 s77, s66, 14720
  buffer_load_dwordx4 v31, s[88:91], s77 offen lds
  v_add_u32 v38, 16384, v33
  ds_read_b64_tr_b16 v[40:41], v38 offset:0
  ds_read_b64_tr_b16 v[42:43], v38 offset:1024
  ds_read_b64_tr_b16 v[44:45], v38 offset:8192
  ds_read_b64_tr_b16 v[46:47], v38 offset:9216
  ds_read_b64_tr_b16 v[48:49], v38 offset:32
  ds_read_b64_tr_b16 v[50:51], v38 offset:1056
  ds_read_b64_tr_b16 v[52:53], v38 offset:8224
  ds_read_b64_tr_b16 v[54:55], v38 offset:9248
  s_waitcnt vmcnt(28) lgkmcnt(0)
  s_barrier
  v_add_u32 v37, 16384, v39
  ds_write_b128 v37, v[40:43] offset:0
  ds_write_b128 v37, v[44:47] offset:1024
  ds_write_b128 v37, v[48:51] offset:2048
  ds_write_b128 v37, v[52:55] offset:3072
  v_add_u32 v38, 32768, v33
  ds_read_b64_tr_b16 v[40:41], v38 offset:0
  ds_read_b64_tr_b16 v[42:43], v38 offset:1024
  ds_read_b64_tr_b16 v[44:45], v38 offset:8192
  ds_read_b64_tr_b16 v[46:47], v38 offset:9216
  ds_read_b64_tr_b16 v[48:49], v38 offset:32
  ds_read_b64_tr_b16 v[50:51], v38 offset:1056
  ds_read_b64_tr_b16 v[52:53], v38 offset:8224
  ds_read_b64_tr_b16 v[54:55], v38 offset:9248
  s_waitcnt vmcnt(24) lgkmcnt(0)
  s_barrier
  v_add_u32 v37, 32768, v39
  ds_write_b128 v37, v[40:43] offset:0
  ds_write_b128 v37, v[44:47] offset:1024
  ds_write_b128 v37, v[48:51] offset:2048
  ds_write_b128 v37, v[52:55] offset:3072
  v_add_u32 v38, 49152, v33
  ds_read_b64_tr_b16 v[40:41], v38 offset:0
  ds_read_b64_tr_b16 v[42:43], v38 offset:1024
  ds_read_b64_tr_b16 v[44:45], v38 offset:8192
  ds_read_b64_tr_b16 v[46:47], v38 offset:9216
  ds_read_b64_tr_b16 v[48:49], v38 offset:32
  ds_read_b64_tr_b16 v[50:51], v38 offset:1056
  ds_read_b64_tr_b16 v[52:53], v38 offset:8224
  ds_read_b64_tr_b16 v[54:55], v38 offset:9248
  s_waitcnt vmcnt(20) lgkmcnt(0)
  s_barrier
  v_add_u32 v37, 49152, v39
  ds_write_b128 v37, v[40:43] offset:0
  ds_write_b128 v37, v[44:47] offset:1024
  ds_write_b128 v37, v[48:51] offset:2048
  ds_write_b128 v37, v[52:55] offset:3072
  v_add_u32 v38, 65536, v33
  ds_read_b64_tr_b16 v[40:41], v38 offset:0
  ds_read_b64_tr_b16 v[42:43], v38 offset:1024
  ds_read_b64_tr_b16 v[44:45], v38 offset:8192
  ds_read_b64_tr_b16 v[46:47], v38 offset:9216
  ds_read_b64_tr_b16 v[48:49], v38 offset:32
  ds_read_b64_tr_b16 v[50:51], v38 offset:1056
  ds_read_b64_tr_b16 v[52:53], v38 offset:8224
  ds_read_b64_tr_b16 v[54:55], v38 offset:9248
  s_waitcnt vmcnt(16) lgkmcnt(0)
  s_barrier
  v_add_u32 v37, 65536, v39
  ds_write_b128 v37, v[40:43] offset:0
  ds_write_b128 v37, v[44:47] offset:1024
  ds_write_b128 v37, v[48:51] offset:2048
  ds_write_b128 v37, v[52:55] offset:3072
  v_add_u32 v38, 81920, v33
  ds_read_b64_tr_b16 v[40:41], v38 offset:0
  ds_read_b64_tr_b16 v[42:43], v38 offset:1024
  ds_read_b64_tr_b16 v[44:45], v38 offset:8192
  ds_read_b64_tr_b16 v[46:47], v38 offset:9216
  ds_read_b64_tr_b16 v[48:49], v38 offset:32
  ds_read_b64_tr_b16 v[50:51], v38 offset:1056
  ds_read_b64_tr_b16 v[52:53], v38 offset:8224
  ds_read_b64_tr_b16 v[54:55], v38 offset:9248
  s_waitcnt vmcnt(12) lgkmcnt(0)
  s_barrier
  v_add_u32 v37, 81920, v39
  ds_write_b128 v37, v[40:43] offset:0
  ds_write_b128 v37, v[44:47] offset:1024
  ds_write_b128 v37, v[48:51] offset:2048
  ds_write_b128 v37, v[52:55] offset:3072
  v_add_u32 v38, 98304, v34
  ds_read_b64_tr_b16 v[40:41], v38 offset:0
  ds_read_b64_tr_b16 v[42:43], v38 offset:512
  ds_read_b64_tr_b16 v[44:45], v38 offset:2048
  ds_read_b64_tr_b16 v[46:47], v38 offset:2560
  ds_read_b64_tr_b16 v[48:49], v38 offset:8192
  ds_read_b64_tr_b16 v[50:51], v38 offset:8704
  ds_read_b64_tr_b16 v[52:53], v38 offset:10240
  ds_read_b64_tr_b16 v[54:55], v38 offset:10752
  s_waitcnt vmcnt(8) lgkmcnt(0)
  s_barrier
  v_add_u32 v37, 98304, v39
  ds_write_b128 v37, v[40:43] offset:0
  ds_write_b128 v37, v[44:47] offset:1024
  ds_write_b128 v37, v[48:51] offset:2048
  ds_write_b128 v37, v[52:55] offset:3072
  v_add_u32 v38, 114688, v34
  ds_read_b64_tr_b16 v[40:41], v38 offset:0
  ds_read_b64_tr_b16 v[42:43], v38 offset:512
  ds_read_b64_tr_b16 v[44:45], v38 offset:2048
  ds_read_b64_tr_b16 v[46:47], v38 offset:2560
  ds_read_b64_tr_b16 v[48:49], v38 offset:8192
  ds_read_b64_tr_b16 v[50:51], v38 offset:8704
  ds_read_b64_tr_b16 v[52:53], v38 offset:10240
  ds_read_b64_tr_b16 v[54:55], v38 offset:10752
  s_waitcnt vmcnt(4) lgkmcnt(0)
  s_barrier
  v_add_u32 v37, 114688, v39
  ds_write_b128 v37, v[40:43] offset:0
  ds_write_b128 v37, v[44:47] offset:1024
  ds_write_b128 v37, v[48:51] offset:2048
  ds_write_b128 v37, v[52:55] offset:3072
  v_add_u32 v38, 131072, v34
  ds_read_b64_tr_b16 v[40:41], v38 offset:0
  ds_read_b64_tr_b16 v[42:43], v38 offset:512
  ds_read_b64_tr_b16 v[44:45], v38 offset:2048
  ds_read_b64_tr_b16 v[46:47], v38 offset:2560
  ds_read_b64_tr_b16 v[48:49], v38 offset:8192
  ds_read_b64_tr_b16 v[50:51], v38 offset:8704
  ds_read_b64_tr_b16 v[52:53], v38 offset:10240
  ds_read_b64_tr_b16 v[54:55], v38 offset:10752
  s_waitcnt vmcnt(0) lgkmcnt(0)
  s_barrier
  v_add_u32 v37, 131072, v39
  ds_write_b128 v37, v[40:43] offset:0
  ds_write_b128 v37, v[44:47] offset:1024
  ds_write_b128 v37, v[48:51] offset:2048
  ds_write_b128 v37, v[52:55] offset:3072
  v_add_u32 v38, 147456, v34
  ds_read_b64_tr_b16 v[40:41], v38 offset:0
  ds_read_b64_tr_b16 v[42:43], v38 offset:512
  ds_read_b64_tr_b16 v[44:45], v38 offset:2048
  ds_read_b64_tr_b16 v[46:47], v38 offset:2560
  ds_read_b64_tr_b16 v[48:49], v38 offset:8192
  ds_read_b64_tr_b16 v[50:51], v38 offset:8704
  ds_read_b64_tr_b16 v[52:53], v38 offset:10240
  ds_read_b64_tr_b16 v[54:55], v38 offset:10752
  s_waitcnt lgkmcnt(0)
  s_barrier
  v_add_u32 v37, 147456, v39
  ds_write_b128 v37, v[40:43] offset:0
  ds_write_b128 v37, v[44:47] offset:1024
  ds_write_b128 v37, v[48:51] offset:2048
  ds_write_b128 v37, v[52:55] offset:3072
  s_waitcnt lgkmcnt(0)
  v_and_b32 v22, 15, v0
  v_lshrrev_b32 v23, 4, v0
  v_and_b32 v24, 7, v0
  v_lshrrev_b32 v25, 3, v22
  v_and_b32 v26, 1, v23
  v_lshrrev_b32 v27, 1, v23
  v_mov_b32 v20, 0x3f80
  v_mov_b32 v21, 0x3f800000
  v_mov_b32 v1, 0x44444444
  v_mov_b32 v28, 0xeeeeeeee
  v_cmp_eq_u32 vcc, 1, v25
  s_nop 1
  v_cndmask_b32 v1, v1, v28, vcc
  v_lshlrev_b32 v28, 2, v26
  v_sub_u32 v28, v22, v28
  v_cmp_eq_u32 vcc, 0, v28
  v_mov_b32 v2, 0
  s_nop 0
  v_cndmask_b32 v2, v2, v20, vcc
  v_cmp_eq_u32 vcc, 1, v28
  s_nop 1
  v_cndmask_b32 v2, v2, v21, vcc
  v_cmp_eq_u32 vcc, 2, v28
  v_mov_b32 v3, 0
  s_nop 0
  v_cndmask_b32 v3, v3, v20, vcc
  v_cmp_eq_u32 vcc, 3, v28
  s_nop 1
  v_cndmask_b32 v3, v3, v21, vcc
  v_cmp_eq_u32 vcc, 8, v28
  v_mov_b32 v4, 0
  s_nop 0
  v_cndmask_b32 v4, v4, v20, vcc
  v_cmp_eq_u32 vcc, 9, v28
  s_nop 1
  v_cndmask_b32 v4, v4, v21, vcc
  v_cmp_eq_u32 vcc, 10, v28
  v_mov_b32 v5, 0
  s_nop 0
  v_cndmask_b32 v5, v5, v20, vcc
  v_cmp_eq_u32 vcc, 11, v28
  s_nop 1
  v_cndmask_b32 v5, v5, v21, vcc
  v_lshrrev_b32 v28, 1, v24
  v_cmp_eq_u32 s[8:9], 0, v28
  v_cmp_eq_u32 s[10:11], 1, v28
  v_cmp_eq_u32 s[12:13], 2, v28
  v_cmp_eq_u32 s[14:15], 3, v28
  v_lshl_add_u32 v28, v23, 3, v24
  v_lshlrev_b32 v10, 4, v28
  v_lshl_add_u32 v11, v25, 9, v10
  v_lshl_add_u32 v28, v26, 4, v22
  v_lshlrev_b32 v12, 3, v28
  v_lshlrev_b32 v28, 4, v28
  v_lshl_add_u32 v16, v27, 3, v28
  v_lshlrev_b32 v28, 3, v22
  v_lshl_add_u32 v28, v26, 7, v28
  v_lshl_add_u32 v14, v27, 2, v28
  v_lshl_add_u32 v13, v27, 15, v28
  v_and_b32 v28, 3, v22
  v_lshl_add_u32 v28, v27, 2, v28
  v_lshlrev_b32 v28, 4, v28
  v_lshl_add_u32 v28, v26, 7, v28
  v_bfe_u32 v29, v22, 2, 1
  v_lshl_add_u32 v15, v29, 3, v28
  v_mul_u32_u24 v40, 1152, v24
  v_lshl_add_u32 v40, v23, 5, v40
  v_lshl_add_u32 v40, v25, 4, v40
  v_lshlrev_b32 v0, 4, v0
  v_add_u32 v17, 0x10000, v0
  v_add_u32 v18, 0x20000, v0
  s_mov_b32 s70, 0x3e0293ee
  s_mov_b32 s82, s70
  s_mov_b32 s83, s70
  s_mov_b32 s78, 0xff00ff
  s_mov_b32 s80, 0xff00ff00
  s_mov_b32 s79, 0xff00ff
  s_mov_b32 s81, 0xff00ff00
  s_add_u32 s64, s21, 4
  s_cmp_eq_u32 s20, 1
  s_cselect_b32 s64, s21, s64
  s_lshl_b32 s56, s64, 8
  s_add_u32 s56, s56, 0x3104000
  s_lshl_b32 s59, s64, 13
  s_add_u32 s59, s59, 0x3080000
  s_add_u32 s69, s59, 4096
  s_lshl_b32 s58, s21, 8
  s_lshl_b32 s65, s20, 13
  s_add_u32 s58, s58, s65
  s_add_u32 s58, s58, 0x3080000
  s_add_u32 s72, s58, 32768
  s_add_u32 s73, s58, 98304
  s_add_u32 s74, s58, 163840
  s_add_u32 s75, s58, 229376
  s_lshl_b32 s55, s20, 10
  s_add_u32 s55, s55, 0x3104000
  s_add_u32 s77, s55, 4096
  s_mov_b32 s71, 0x3106000
  s_mov_b32 s52, -1
  s_mov_b32 s57, 0
  s_lshl_b32 s53, s21, 20
  s_lshl_b32 s64, s20, 11
  s_add_u32 s53, s53, s64
  s_add_u32 s53, s53, 0x3fc000
  s_mul_i32 s61, s21, 399360
  s_add_u32 s61, s61, 0x8000000
  s_lshl_b32 s62, s21, 2
  s_add_u32 s62, s62, 0x3200e80
  s_mov_b32 s84, s26
  s_and_b32 s85, s27, 0xffff
  s_mov_b32 s86, 0x2400
  s_mov_b32 s87, 0x20000
  s_lshl_b32 s64, s20, 7
  buffer_load_dwordx4 v[20:23], v40, s[84:87], s64 offen
  buffer_load_dwordx4 v[24:27], v40, s[84:87], s64 offen offset:512
  buffer_load_dwordx4 v[28:31], v40, s[84:87], 0 offen offset:1024
  s_mov_b32 s65, 0x05040100
  s_mov_b32 s66, 0x07060302
  s_waitcnt vmcnt(0)
  v_perm_b32 v44, v21, v20, s65
  v_perm_b32 v45, v23, v22, s65
  v_perm_b32 v46, v21, v20, s66
  v_perm_b32 v23, v23, v22, s66
  v_mov_b32 v20, v44
  v_mov_b32 v21, v45
  v_mov_b32 v22, v46
  v_perm_b32 v44, v25, v24, s65
  v_perm_b32 v45, v27, v26, s65
  v_perm_b32 v46, v25, v24, s66
  v_perm_b32 v27, v27, v26, s66
  v_mov_b32 v24, v44
  v_mov_b32 v25, v45
  v_mov_b32 v26, v46
  v_perm_b32 v44, v29, v28, s65
  v_perm_b32 v45, v31, v30, s65
  v_perm_b32 v46, v29, v28, s66
  v_perm_b32 v31, v31, v30, s66
  v_mov_b32 v28, v44
  v_mov_b32 v29, v45
  v_mov_b32 v30, v46
  v_mov_b32 v45, 4
  s_mov_b32 s63, 0
L_wrecinit:
  buffer_load_dword v44, v45, s[16:19], 0 offen sc1
  s_add_u32 s63, s63, 1
  s_waitcnt vmcnt(0)
  v_readfirstlane_b32 s64, v44
  s_cmp_ge_u32 s63, 0x10000
  s_cbranch_scc1 L_wrecinit_x
  s_cmp_lt_u32 s64, 32
  s_cbranch_scc1 L_wrecinit
L_wrecinit_x:
  v_lshlrev_b32 v45, 3, v0
  s_lshl_b32 s3, s21, 2
  s_add_u32 s3, s3, 0x3204000
  s_mov_b32 s63, 0
  s_mov_b32 exec_lo, 0x3
  s_mov_b32 exec_hi, 0x0
L_kvw:
  buffer_load_dword v44, v45, s[4:7], s3 offen sc1
  s_add_u32 s63, s63, 1
  s_cmp_ge_u32 s63, 0x8000
  s_waitcnt vmcnt(0)
  v_cmp_eq_u32 vcc, 0, v44
  s_cbranch_scc1 L_kvw_x
  s_cbranch_vccz L_kvw_x
  s_sleep 2
  s_branch L_kvw
L_kvw_x:
  s_mov_b64 exec, -1
  v_mov_b32 v16, 1
  s_mov_b32 s63, 0x2000
  s_barrier
  s_cmp_eq_u32 s20, 0
  s_cbranch_scc1 L_shadow_0
  s_cmp_eq_u32 s20, 1
  s_cbranch_scc1 L_shadow_1
  s_cmp_eq_u32 s20, 2
  s_cbranch_scc1 L_shadow_2
  s_cmp_eq_u32 s20, 3
  s_cbranch_scc1 L_shadow_3
  s_branch L_end
.p2align 5
L_step_0:
L_shadow_0:
  ds_read_b128 v[48:51], v0 offset:16384
  ds_read_b128 v[52:55], v0 offset:17408
  ds_read_b128 v[72:75], v0 offset:18432
  ds_read_b128 v[76:79], v0 offset:19456
  ds_read_b128 v[56:59], v0 offset:32768
  ds_read_b128 v[60:63], v0 offset:33792
  s_xor_b32 s58, s58, 0x80000
  s_xor_b32 s59, s59, 0x80000
  s_xor_b32 s69, s69, 0x80000
  s_xor_b32 s72, s72, 0x80000
  s_xor_b32 s73, s73, 0x80000
  s_xor_b32 s74, s74, 0x80000
  s_xor_b32 s75, s75, 0x80000
  s_xor_b32 s56, s56, 0x4000
  s_add_u32 s52, s52, 1
  s_mov_b32 s60, s57
  s_bfe_u32 s57, s52, 0x10001
  s_add_u32 s53, s53, 16384
  s_add_u32 s54, s53, 8192
  s_add_u32 s76, s53, 16384
  s_add_u32 s68, s61, 2048
  s_add_u32 s61, s61, 6144
  s_add_u32 s62, s62, 128
  s_cmp_ge_u32 s63, 0x2000
  s_cbranch_scc1 L_mzero_0
L_mretry_0:
  buffer_load_dwordx4 v[20:23], v0, s[4:7], s55 offen sc1
  buffer_load_dwordx4 v[24:27], v0, s[4:7], s77 offen sc1
L_mzero_0:
  v_mov_b64 v[32:33], 0
  v_mov_b64 v[34:35], 0
  v_mov_b64 v[36:37], 0
  v_mov_b64 v[38:39], 0
  v_mov_b64 v[40:41], 0
  v_mov_b64 v[42:43], 0
  v_mov_b64 v[44:45], 0
  v_mov_b64 v[46:47], 0
L_mchk_0:
  s_add_u32 s63, s63, 1
  s_cmp_ge_u32 s63, 0x2000
  s_cselect_b32 s64, 0, 1
  s_waitcnt vmcnt(1)
  ds_write_b128 v0, v[20:23] offset:0
  v_smfmac_f32_16x16x64_bf16 v[32:35], v[20:23], a[0:7], v1
  s_waitcnt vmcnt(0)
  ds_write_b128 v0, v[24:27] offset:4096
  v_bitop3_b32 v19, v20, v22, s60 bitop3:0x7e
  v_smfmac_f32_16x16x64_bf16 v[40:43], v[20:23], a[8:15], v1
  v_bitop3_b32 v19, v19, v24, s60 bitop3:0xf6
  v_bitop3_b32 v19, v19, v26, s60 bitop3:0xf6
  v_smfmac_f32_16x16x64_bf16 v[36:39], v[20:23], a[144:151], v1
  v_and_b32 v19, s64, v19
  v_cmp_ne_u32 vcc, 0, v19
  v_smfmac_f32_16x16x64_bf16 v[44:47], v[20:23], a[152:159], v1
  s_cbranch_vccnz L_mretry_0
  v_smfmac_f32_16x16x64_bf16 v[32:35], v[24:27], a[64:71], v1
  s_waitcnt lgkmcnt(0)
  s_barrier
  ds_read_b128 v[28:31], v0 offset:5120
  ds_read_b128 v[20:23], v0 offset:1024
  s_xor_b32 s55, s55, 0x4000
  v_smfmac_f32_16x16x64_bf16 v[40:43], v[24:27], a[72:79], v1
  s_xor_b32 s77, s77, 0x4000
  buffer_load_dwordx4 v[64:67], v0, s[4:7], s54 offen sc1
  v_smfmac_f32_16x16x64_bf16 v[36:39], v[24:27], v[48:55], v1
  ds_read_b128 v[48:51], v0 offset:34816
  ds_read_b128 v[52:55], v0 offset:35840
  v_smfmac_f32_16x16x64_bf16 v[44:47], v[24:27], v[72:79], v1
  ds_read_b128 v[72:75], v0 offset:49152
  ds_read_b128 v[76:79], v0 offset:50176
  ds_read_b128 v[24:27], v0 offset:6144
  s_waitcnt lgkmcnt(6)
  v_smfmac_f32_16x16x64_bf16 v[32:35], v[28:31], a[80:87], v1
  v_smfmac_f32_16x16x64_bf16 v[40:43], v[28:31], a[88:95], v1
  buffer_load_dwordx4 v[68:71], v0, s[4:7], s54 offen offset:1024 sc1
  v_smfmac_f32_16x16x64_bf16 v[36:39], v[28:31], v[56:63], v1
  ds_read_b128 v[56:59], v0 offset:51200
  ds_read_b128 v[60:63], v0 offset:52224
  s_waitcnt lgkmcnt(5)
  v_smfmac_f32_16x16x64_bf16 v[44:47], v[28:31], v[48:55], v1
  ds_read_b128 v[48:51], v17 offset:0
  ds_read_b128 v[52:55], v17 offset:1024
  ds_read_b128 v[28:31], v0 offset:7168
  v_smfmac_f32_16x16x64_bf16 v[32:35], v[20:23], a[16:23], v1
  v_smfmac_f32_16x16x64_bf16 v[40:43], v[20:23], a[24:31], v1
  v_smfmac_f32_16x16x64_bf16 v[36:39], v[20:23], a[160:167], v1
  v_smfmac_f32_16x16x64_bf16 v[44:47], v[20:23], a[168:175], v1
  ds_read_b128 v[20:23], v0 offset:2048
  s_waitcnt lgkmcnt(6)
  v_smfmac_f32_16x16x64_bf16 v[32:35], v[24:27], a[96:103], v1
  v_smfmac_f32_16x16x64_bf16 v[40:43], v[24:27], a[104:111], v1
  v_smfmac_f32_16x16x64_bf16 v[36:39], v[24:27], v[72:79], v1
  ds_read_b128 v[72:75], v17 offset:2048
  ds_read_b128 v[76:79], v17 offset:3072
  s_waitcnt lgkmcnt(6)
  v_smfmac_f32_16x16x64_bf16 v[44:47], v[24:27], v[56:63], v1
  ds_read_b128 v[24:27], v0 offset:8192
  buffer_load_dwordx4 v[56:59], v0, s[4:7], s53 offen sc1
  s_waitcnt lgkmcnt(4)
  v_smfmac_f32_16x16x64_bf16 v[32:35], v[28:31], a[112:119], v1
  v_smfmac_f32_16x16x64_bf16 v[40:43], v[28:31], a[120:127], v1
  buffer_load_dwordx4 v[60:63], v0, s[4:7], s53 offen offset:1024 sc1
  v_smfmac_f32_16x16x64_bf16 v[36:39], v[28:31], v[48:55], v1
  ds_read_b128 v[48:51], v17 offset:16384
  ds_read_b128 v[52:55], v17 offset:17408
  s_waitcnt lgkmcnt(3)
  v_smfmac_f32_16x16x64_bf16 v[44:47], v[28:31], v[72:79], v1
  ds_read_b128 v[72:75], v17 offset:18432
  ds_read_b128 v[76:79], v17 offset:19456
  ds_read_b128 v[28:31], v0 offset:3072
  v_smfmac_f32_16x16x64_bf16 v[32:35], v[20:23], a[32:39], v1
  v_smfmac_f32_16x16x64_bf16 v[40:43], v[20:23], a[40:47], v1
  v_smfmac_f32_16x16x64_bf16 v[36:39], v[20:23], a[176:183], v1
  v_smfmac_f32_16x16x64_bf16 v[44:47], v[20:23], a[184:191], v1
  s_waitcnt lgkmcnt(5)
  v_smfmac_f32_16x16x64_bf16 v[32:35], v[24:27], a[128:135], v1
  v_smfmac_f32_16x16x64_bf16 v[40:43], v[24:27], a[136:143], v1
  s_waitcnt lgkmcnt(3)
  v_smfmac_f32_16x16x64_bf16 v[36:39], v[24:27], v[48:55], v1
  s_waitcnt lgkmcnt(1)
  v_mov_b64 v[48:49], 0
  v_smfmac_f32_16x16x64_bf16 v[44:47], v[24:27], v[72:79], v1
  buffer_store_dwordx4 v[6:9], v0, s[4:7], s68 offen sc1
  s_waitcnt lgkmcnt(0)
  v_mov_b64 v[50:51], 0
  v_smfmac_f32_16x16x64_bf16 v[32:35], v[28:31], a[48:55], v1
  v_mov_b64 v[52:53], 0
  v_smfmac_f32_16x16x64_bf16 v[36:39], v[28:31], a[192:199], v1
  v_mov_b64 v[54:55], 0
  v_smfmac_f32_16x16x64_bf16 v[40:43], v[28:31], a[56:63], v1
  v_smfmac_f32_16x16x64_bf16 v[44:47], v[28:31], a[200:207], v1
  ds_read_b128 v[72:75], v0 offset:0
  ds_read_b128 v[76:79], v0 offset:4096
  v_smfmac_f32_16x16x64_bf16 v[48:51], v[20:23], a[240:247], v1
  v_cvt_pk_bf16_f32 v32, v32, v33
  v_cvt_pk_bf16_f32 v33, v34, v35
  v_cvt_pk_bf16_f32 v34, v36, v37
  v_cvt_pk_bf16_f32 v35, v38, v39
  v_cvt_pk_bf16_f32 v40, v40, v41
  v_cvt_pk_bf16_f32 v41, v42, v43
  v_mfma_f32_16x16x32_bf16 v[36:39], v[32:35], v[2:5], 0
  v_cvt_pk_bf16_f32 v42, v44, v45
  v_cvt_pk_bf16_f32 v43, v46, v47
  s_waitcnt vmcnt(1)
  s_nop 0
  v_mfma_f32_16x16x32_bf16 v[44:47], v[40:43], v[2:5], 0
  v_smfmac_f32_16x16x64_bf16 v[52:55], v[20:23], a[248:255], v1
  ds_read_b128 v[20:23], v0 offset:5120
  v_cvt_pk_bf16_f32 v32, v36, v37
  v_cvt_pk_bf16_f32 v33, v38, v39
  v_smfmac_f32_16x16x64_bf16 v[48:51], v[24:27], v[160:167], v1
  v_cvt_pk_bf16_f32 v34, v44, v45
  v_cvt_pk_bf16_f32 v35, v46, v47
  s_nop 1
  v_mfma_f32_16x16x32_bf16 v[36:39], v[56:59], v[32:35], 0
  v_mfma_f32_16x16x32_bf16 v[40:43], v[60:63], v[32:35], 0
  v_mfma_f32_16x16x32_bf16 v[44:47], v[32:35], v[32:35], 0
  v_smfmac_f32_16x16x64_bf16 v[52:55], v[24:27], v[168:175], v1
  ds_read_b128 v[24:27], v0 offset:1024
  v_mov_b32_dpp v36, v40 row_ror:8 row_mask:0xf bank_mask:0xc
  v_mov_b32_dpp v37, v41 row_ror:8 row_mask:0xf bank_mask:0xc
  v_mov_b32_dpp v38, v42 row_ror:8 row_mask:0xf bank_mask:0xc
  v_mov_b32_dpp v39, v43 row_ror:8 row_mask:0xf bank_mask:0xc
  ds_write_b128 v0, v[36:39] offset:9216
  v_mov_b32_dpp v44, v46 row_ror:8 row_mask:0xf bank_mask:0xc
  v_mov_b32_dpp v45, v47 row_ror:8 row_mask:0xf bank_mask:0xc
  s_mov_b32 exec_lo, 0
  ds_write_b64 v12, v[44:45] offset:10240
  s_mov_b64 exec, s[80:81]
  buffer_store_dwordx4 v[32:35], v10, s[4:7], s61 offen offset:0 sc1
  s_mov_b64 exec, -1
  v_smfmac_f32_16x16x64_bf16 v[48:51], v[28:31], v[80:87], v1
  v_smfmac_f32_16x16x64_bf16 v[52:55], v[28:31], v[88:95], v1
  ds_read_b128 v[28:31], v0 offset:6144
  s_waitcnt lgkmcnt(6)
  v_smfmac_f32_16x16x64_bf16 v[48:51], v[72:75], a[208:215], v1
  v_smfmac_f32_16x16x64_bf16 v[52:55], v[72:75], a[216:223], v1
  ds_read_b128 v[72:75], v0 offset:7168
  s_waitcnt lgkmcnt(2)
  s_barrier
  ds_read_b128 v[40:43], v0 offset:10496
  ds_read_b64 v[56:57], v12 offset:10240
  ds_read_b128 v[44:47], v0 offset:11776
  ds_read_b64 v[58:59], v12 offset:11520
  ds_read_b128 v[32:35], v0 offset:13056
  ds_read_b64 v[60:61], v12 offset:12800
  ds_read_b64 v[62:63], v12 offset:14080
  v_smfmac_f32_16x16x64_bf16 v[48:51], v[76:79], v[96:103], v1
  v_smfmac_f32_16x16x64_bf16 v[52:55], v[76:79], v[104:111], v1
  v_smfmac_f32_16x16x64_bf16 v[48:51], v[20:23], v[112:119], v1
  v_smfmac_f32_16x16x64_bf16 v[52:55], v[20:23], v[120:127], v1
  v_smfmac_f32_16x16x64_bf16 v[48:51], v[24:27], a[224:231], v1
  v_smfmac_f32_16x16x64_bf16 v[52:55], v[24:27], a[232:239], v1
  s_waitcnt lgkmcnt(6)
  v_add_f32 v36, v36, v40
  v_add_f32 v37, v37, v41
  v_add_f32 v38, v38, v42
  v_add_f32 v39, v39, v43
  s_waitcnt lgkmcnt(3)
  v_add_f32 v56, v56, v58
  v_add_f32 v57, v57, v59
  s_waitcnt lgkmcnt(0)
  v_pk_add_f32 v[44:45], v[44:45], v[32:33]
  v_pk_add_f32 v[46:47], v[46:47], v[34:35]
  v_pk_add_f32 v[60:61], v[60:61], v[62:63]
  v_pk_add_f32 v[36:37], v[36:37], v[44:45]
  v_pk_add_f32 v[38:39], v[38:39], v[46:47]
  v_pk_add_f32 v[40:41], v[56:57], v[60:61]
  v_max3_f32 v42, v36, v37, v38
  v_max3_f32 v43, v39, v40, v41
  v_max_f32 v42, v42, v43
  ds_read_b128 v[56:59], v17 offset:32768
  ds_read_b128 v[60:63], v17 offset:33792
  v_max_f32_dpp v42, v42, v42 row_ror:8 row_mask:0xf bank_mask:0xf
  v_mov_b32 v43, v42
  v_smfmac_f32_16x16x64_bf16 v[48:51], v[28:31], v[128:135], v1
  s_nop 0
  v_permlane16_swap_b32 v42, v43
  v_max_f32 v42, v42, v43
  v_mov_b32 v43, v42
  v_smfmac_f32_16x16x64_bf16 v[52:55], v[28:31], v[136:143], v1
  s_nop 0
  v_permlane32_swap_b32 v42, v43
  v_max_f32 v42, v42, v43
  v_mul_f32 v42, s70, v42
  v_fma_f32 v36, v36, s70, -v42
  v_smfmac_f32_16x16x64_bf16 v[48:51], v[72:75], v[144:151], v1
  v_exp_f32 v36, v36
  v_fma_f32 v37, v37, s70, -v42
  v_exp_f32 v37, v37
  v_fma_f32 v38, v38, s70, -v42
  v_smfmac_f32_16x16x64_bf16 v[52:55], v[72:75], v[152:159], v1
  v_exp_f32 v38, v38
  v_fma_f32 v39, v39, s70, -v42
  v_exp_f32 v39, v39
  v_fma_f32 v40, v40, s70, -v42
  v_exp_f32 v40, v40
  v_fma_f32 v41, v41, s70, -v42
  v_exp_f32 v41, v41
  v_cvt_pk_bf16_f32 v44, v36, v37
  v_cvt_pk_bf16_f32 v45, v38, v39
  v_cvt_pk_bf16_f32 v32, v40, v41
  s_cmp_eq_u32 s52, 63
  v_mov_b32_dpp v46, v44 row_ror:8 row_mask:0xf bank_mask:0xf
  v_mov_b32_dpp v47, v45 row_ror:8 row_mask:0xf bank_mask:0xf
  v_add_f32 v40, v40, v41
  v_add_f32 v36, v36, v37
  v_mfma_f32_16x16x32_bf16 v[20:23], v[64:67], v[44:47], 0
  v_mov_b32_dpp v33, v32 row_ror:8 row_mask:0xf bank_mask:0xf
  v_add_f32 v38, v38, v39
  v_mfma_f32_16x16x32_bf16 v[24:27], v[68:71], v[44:47], 0
  v_cvt_pk_bf16_f32 v6, v48, v49
  v_cvt_pk_bf16_f32 v7, v50, v51
  v_fmac_f32 v36, 0.5, v40
  v_add_f32 v36, v36, v38
  v_mfma_f32_16x16x16_bf16 v[20:23], v[6:7], v[32:33], v[20:23]
  v_cvt_pk_bf16_f32 v8, v52, v53
  v_cvt_pk_bf16_f32 v9, v54, v55
  s_cbranch_scc1 L_rec_fin
  v_add_f32_dpp v36, v36, v36 row_ror:8 row_mask:0xf bank_mask:0xf
  v_mfma_f32_16x16x16_bf16 v[24:27], v[8:9], v[32:33], v[24:27]
  v_mov_b32 v37, v36
  v_mov_b64 v[64:65], 0
  v_mov_b64 v[66:67], 0
  v_permlane16_swap_b32 v36, v37
  v_add_f32 v36, v36, v37
  v_mov_b32 v37, v36
  v_mov_b64 v[68:69], 0
  v_mov_b64 v[70:71], 0
  v_permlane32_swap_b32 v36, v37
  v_add_f32 v36, v36, v37
  v_mov_b64 v[52:53], 0
  v_rcp_f32 v36, v36
  v_mov_b64 v[54:55], 0
  s_mov_b64 exec, s[78:79]
  v_pk_mul_f32 v[20:21], v[20:21], v[36:37] op_sel_hi:[1,0]
  v_pk_mul_f32 v[22:23], v[22:23], v[36:37] op_sel_hi:[1,0]
  v_pk_mul_f32 v[24:25], v[24:25], v[36:37] op_sel_hi:[1,0]
  v_pk_mul_f32 v[26:27], v[26:27], v[36:37] op_sel_hi:[1,0]
  v_cvt_pk_bf16_f32 v20, v20, v21
  v_cvt_pk_bf16_f32 v21, v22, v23
  v_cvt_pk_bf16_f32 v22, v24, v25
  v_cvt_pk_bf16_f32 v23, v26, v27
  s_barrier
  ds_write_b128 v10, v[20:23] offset:9216
  s_mov_b64 exec, -1
  ds_read_b128 v[72:75], v17 offset:34816
  ds_read_b128 v[76:79], v17 offset:35840
  ds_read_b128 v[28:31], v17 offset:49152
  ds_read_b128 v[32:35], v17 offset:50176
  s_waitcnt lgkmcnt(4)
  s_barrier
  ds_read_b128 v[20:23], v11 offset:9216
  ds_read_b128 v[24:27], v11 offset:10240
  ds_read_b128 v[36:39], v10 offset:9216
  ds_read_b128 v[40:43], v10 offset:9728
  ds_read_b128 v[44:47], v10 offset:10240
  ds_read_b128 v[48:51], v10 offset:10752
  s_waitcnt lgkmcnt(5)
  v_smfmac_f32_16x16x64_bf16 v[52:55], v[20:23], v[176:183], v1
  s_waitcnt lgkmcnt(4)
  v_smfmac_f32_16x16x64_bf16 v[52:55], v[24:27], v[184:191], v1
  ds_read_b128 v[20:23], v17 offset:51200
  ds_read_b128 v[24:27], v17 offset:52224
  s_waitcnt lgkmcnt(5)
  v_smfmac_f32_16x16x64_bf16 v[64:67], v[36:39], v[56:63], v1
  ds_read_b128 v[56:59], v18 offset:0
  ds_read_b128 v[60:63], v18 offset:1024
  s_waitcnt lgkmcnt(6)
  v_smfmac_f32_16x16x64_bf16 v[64:67], v[40:43], v[72:79], v1
  ds_read_b128 v[72:75], v18 offset:2048
  ds_read_b128 v[76:79], v18 offset:3072
  s_waitcnt lgkmcnt(7)
  v_permlane32_swap_b32 v52, v54
  v_smfmac_f32_16x16x64_bf16 v[64:67], v[44:47], v[192:199], v1
  s_waitcnt lgkmcnt(6)
  v_permlane32_swap_b32 v53, v55
  v_add_f32 v52, v52, v54
  v_smfmac_f32_16x16x64_bf16 v[64:67], v[48:51], v[200:207], v1
  v_add_f32 v53, v53, v55
  v_cvt_pk_bf16_f32 v52, v52, v53
  v_smfmac_f32_16x16x64_bf16 v[68:71], v[36:39], v[28:35], v1
  ds_read_b128 v[28:31], v18 offset:16384
  ds_read_b128 v[32:35], v18 offset:17408
  s_waitcnt lgkmcnt(6)
  v_bfi_b32 v52, 1, s57, v52
  v_smfmac_f32_16x16x64_bf16 v[68:71], v[40:43], v[20:27], v1
  ds_read_b128 v[20:23], v18 offset:18432
  ds_read_b128 v[24:27], v18 offset:19456
  buffer_store_dword v52, v14, s[4:7], s58 offen
  v_mov_b64 v[54:55], 0
  v_mov_b64 v[52:53], 0
  v_smfmac_f32_16x16x64_bf16 v[68:71], v[44:47], v[208:215], v1
  v_cvt_pk_bf16_f32 v64, v64, v65
  v_cvt_pk_bf16_f32 v65, v66, v67
  v_smfmac_f32_16x16x64_bf16 v[68:71], v[48:51], v[216:223], v1
  s_waitcnt lgkmcnt(6)
  v_bfi_b32 v64, 1, s57, v64
  v_smfmac_f32_16x16x64_bf16 v[52:55], v[36:39], v[56:63], v1
  buffer_store_dwordx2 v[64:65], v13, s[4:7], s72 offen
  s_waitcnt lgkmcnt(4)
  v_mov_b64 v[66:67], 0
  v_smfmac_f32_16x16x64_bf16 v[52:55], v[40:43], v[72:79], v1
  v_mov_b64 v[64:65], 0
  v_smfmac_f32_16x16x64_bf16 v[52:55], v[44:47], v[224:231], v1
  v_cvt_pk_bf16_f32 v68, v68, v69
  v_smfmac_f32_16x16x64_bf16 v[52:55], v[48:51], v[232:239], v1
  s_waitcnt lgkmcnt(2)
  v_cvt_pk_bf16_f32 v69, v70, v71
  v_smfmac_f32_16x16x64_bf16 v[64:67], v[36:39], v[28:35], v1
  s_waitcnt lgkmcnt(0)
  v_bfi_b32 v68, 1, s57, v68
  v_smfmac_f32_16x16x64_bf16 v[64:67], v[40:43], v[20:27], v1
  buffer_store_dwordx2 v[68:69], v13, s[4:7], s73 offen
  v_cvt_pk_bf16_f32 v52, v52, v53
  v_smfmac_f32_16x16x64_bf16 v[64:67], v[44:47], v[240:247], v1
  v_cvt_pk_bf16_f32 v53, v54, v55
  v_smfmac_f32_16x16x64_bf16 v[64:67], v[48:51], v[248:255], v1
  v_bfi_b32 v52, 1, s57, v52
  s_mov_b32 s63, 0
  buffer_store_dwordx2 v[52:53], v13, s[4:7], s74 offen
  s_nop 4
  v_cvt_pk_bf16_f32 v64, v64, v65
  v_cvt_pk_bf16_f32 v65, v66, v67
  v_bfi_b32 v64, 1, s57, v64
  buffer_store_dwordx2 v[64:65], v13, s[4:7], s75 offen
  v_bfe_u32 v56, v0, 4, 1
  v_lshlrev_b32 v56, 4, v56
  v_mov_b32 v57, 0x3f80
  v_lshlrev_b32 v56, v56, v57
  v_cndmask_b32 v60, 0, v56, s[8:9]
  v_cndmask_b32 v61, 0, v56, s[10:11]
  v_cndmask_b32 v62, 0, v56, s[12:13]
  v_cndmask_b32 v63, 0, v56, s[14:15]
  s_waitcnt vmcnt(1)
L_ppoll_0:
  buffer_load_dwordx4 v[20:23], v0, s[4:7], s59 offen offset:0 sc1
  buffer_load_dwordx4 v[24:27], v0, s[4:7], s59 offen offset:1024 sc1
  buffer_load_dwordx4 v[28:31], v0, s[4:7], s59 offen offset:2048 sc1
  buffer_load_dwordx4 v[32:35], v0, s[4:7], s59 offen offset:3072 sc1
  buffer_load_dwordx4 v[36:39], v0, s[4:7], s69 offen offset:0 sc1
  buffer_load_dwordx4 v[40:43], v0, s[4:7], s69 offen offset:1024 sc1
  buffer_load_dwordx4 v[44:47], v0, s[4:7], s69 offen offset:2048 sc1
  buffer_load_dwordx4 v[48:51], v0, s[4:7], s69 offen offset:3072 sc1
  s_add_u32 s63, s63, 1
  s_cmp_ge_u32 s63, 0x2000
  s_waitcnt vmcnt(7)
  v_mfma_f32_16x16x32_bf16 v[52:55], v[20:23], v[60:63], 0
  v_bitop3_b32 v56, v20, v22, s57 bitop3:0x7e
  s_waitcnt vmcnt(6)
  v_mfma_f32_16x16x32_bf16 v[52:55], v[24:27], v[60:63], v[52:55]
  v_bitop3_b32 v56, v56, v24, s57 bitop3:0xf6
  v_bitop3_b32 v56, v56, v26, s57 bitop3:0xf6
  s_waitcnt vmcnt(5)
  v_mfma_f32_16x16x32_bf16 v[52:55], v[28:31], v[60:63], v[52:55]
  v_bitop3_b32 v56, v56, v28, s57 bitop3:0xf6
  v_bitop3_b32 v56, v56, v30, s57 bitop3:0xf6
  s_waitcnt vmcnt(4)
  v_mfma_f32_16x16x32_bf16 v[52:55], v[32:35], v[60:63], v[52:55]
  v_bitop3_b32 v56, v56, v32, s57 bitop3:0xf6
  v_bitop3_b32 v56, v56, v34, s57 bitop3:0xf6
  s_waitcnt vmcnt(3)
  v_mfma_f32_16x16x32_bf16 v[52:55], v[36:39], v[60:63], v[52:55]
  v_bitop3_b32 v56, v56, v36, s57 bitop3:0xf6
  v_bitop3_b32 v56, v56, v38, s57 bitop3:0xf6
  s_waitcnt vmcnt(2)
  v_mfma_f32_16x16x32_bf16 v[52:55], v[40:43], v[60:63], v[52:55]
  v_bitop3_b32 v56, v56, v40, s57 bitop3:0xf6
  v_bitop3_b32 v56, v56, v42, s57 bitop3:0xf6
  s_waitcnt vmcnt(1)
  v_mfma_f32_16x16x32_bf16 v[52:55], v[44:47], v[60:63], v[52:55]
  v_bitop3_b32 v56, v56, v44, s57 bitop3:0xf6
  v_bitop3_b32 v56, v56, v46, s57 bitop3:0xf6
  s_waitcnt vmcnt(0)
  v_mfma_f32_16x16x32_bf16 v[52:55], v[48:51], v[60:63], v[52:55]
  v_bitop3_b32 v56, v56, v48, s57 bitop3:0xf6
  v_bitop3_b32 v56, v56, v50, s57 bitop3:0xf6
  v_and_b32 v56, 1, v56
  v_cmp_ne_u32 vcc, 0, v56
  s_cbranch_scc1 L_pok_0
  s_cbranch_vccnz L_ppoll_0
L_pok_0:
  s_mov_b64 exec, s[78:79]
  s_nop 1
  v_cvt_pk_bf16_f32 v58, v52, v53
  v_cvt_pk_bf16_f32 v59, v54, v55
  v_bfi_b32 v58, 1, s57, v58
  buffer_store_dwordx2 v[58:59], v15, s[4:7], s56 offen
  s_mov_b64 exec, -1
  s_mov_b32 s63, 0
L_nored_0:
  s_barrier
  s_branch L_step_0
.p2align 5
L_step_1:
L_shadow_1:
  ds_read_b128 v[48:51], v0 offset:36864
  ds_read_b128 v[52:55], v0 offset:37888
  ds_read_b128 v[72:75], v0 offset:38912
  ds_read_b128 v[76:79], v0 offset:39936
  ds_read_b128 v[56:59], v0 offset:20480
  ds_read_b128 v[60:63], v0 offset:21504
  s_xor_b32 s58, s58, 0x80000
  s_xor_b32 s59, s59, 0x80000
  s_xor_b32 s69, s69, 0x80000
  s_xor_b32 s72, s72, 0x80000
  s_xor_b32 s73, s73, 0x80000
  s_xor_b32 s74, s74, 0x80000
  s_xor_b32 s75, s75, 0x80000
  s_xor_b32 s56, s56, 0x4000
  s_add_u32 s52, s52, 1
  s_mov_b32 s60, s57
  s_bfe_u32 s57, s52, 0x10001
  s_add_u32 s53, s53, 16384
  s_add_u32 s54, s53, 8192
  s_add_u32 s76, s53, 22528
  s_add_u32 s68, s61, 3072
  s_add_u32 s61, s61, 6144
  s_add_u32 s62, s62, 128
  s_cmp_ge_u32 s63, 0x2000
  s_cbranch_scc1 L_mzero_1
L_mretry_1:
  buffer_load_dwordx4 v[20:23], v0, s[4:7], s55 offen sc1
  buffer_load_dwordx4 v[24:27], v0, s[4:7], s77 offen sc1
L_mzero_1:
  v_mov_b64 v[32:33], 0
  v_mov_b64 v[34:35], 0
  v_mov_b64 v[36:37], 0
  v_mov_b64 v[38:39], 0
  v_mov_b64 v[40:41], 0
  v_mov_b64 v[42:43], 0
  v_mov_b64 v[44:45], 0
  v_mov_b64 v[46:47], 0
L_mchk_1:
  s_add_u32 s63, s63, 1
  s_cmp_ge_u32 s63, 0x2000
  s_cselect_b32 s64, 0, 1
  s_waitcnt vmcnt(1)
  ds_write_b128 v0, v[20:23] offset:1024
  v_smfmac_f32_16x16x64_bf16 v[32:35], v[20:23], a[16:23], v1
  s_waitcnt vmcnt(0)
  ds_write_b128 v0, v[24:27] offset:5120
  v_bitop3_b32 v19, v20, v22, s60 bitop3:0x7e
  v_smfmac_f32_16x16x64_bf16 v[40:43], v[20:23], a[24:31], v1
  v_bitop3_b32 v19, v19, v24, s60 bitop3:0xf6
  v_bitop3_b32 v19, v19, v26, s60 bitop3:0xf6
  v_smfmac_f32_16x16x64_bf16 v[36:39], v[20:23], a[160:167], v1
  v_and_b32 v19, s64, v19
  v_cmp_ne_u32 vcc, 0, v19
  v_smfmac_f32_16x16x64_bf16 v[44:47], v[20:23], a[168:175], v1
  s_cbranch_vccnz L_mretry_1
  v_smfmac_f32_16x16x64_bf16 v[32:35], v[24:27], a[80:87], v1
  s_waitcnt lgkmcnt(0)
  s_barrier
  ds_read_b128 v[28:31], v0 offset:4096
  ds_read_b128 v[20:23], v0 offset:0
  s_xor_b32 s55, s55, 0x4000
  v_smfmac_f32_16x16x64_bf16 v[40:43], v[24:27], a[88:95], v1
  s_xor_b32 s77, s77, 0x4000
  v_smfmac_f32_16x16x64_bf16 v[36:39], v[24:27], v[48:55], v1
  ds_read_b128 v[48:51], v0 offset:22528
  ds_read_b128 v[52:55], v0 offset:23552
  v_smfmac_f32_16x16x64_bf16 v[44:47], v[24:27], v[72:79], v1
  ds_read_b128 v[72:75], v0 offset:53248
  ds_read_b128 v[76:79], v0 offset:54272
  ds_read_b128 v[24:27], v0 offset:6144
  s_waitcnt lgkmcnt(6)
  v_smfmac_f32_16x16x64_bf16 v[32:35], v[28:31], a[64:71], v1
  buffer_load_dwordx4 v[64:67], v0, s[4:7], s54 offen sc1
  v_smfmac_f32_16x16x64_bf16 v[40:43], v[28:31], a[72:79], v1
  v_smfmac_f32_16x16x64_bf16 v[36:39], v[28:31], v[56:63], v1
  ds_read_b128 v[56:59], v0 offset:55296
  ds_read_b128 v[60:63], v0 offset:56320
  s_waitcnt lgkmcnt(5)
  v_smfmac_f32_16x16x64_bf16 v[44:47], v[28:31], v[48:55], v1
  ds_read_b128 v[48:51], v17 offset:4096
  ds_read_b128 v[52:55], v17 offset:5120
  ds_read_b128 v[28:31], v0 offset:7168
  v_smfmac_f32_16x16x64_bf16 v[32:35], v[20:23], a[0:7], v1
  buffer_load_dwordx4 v[68:71], v0, s[4:7], s54 offen offset:1024 sc1
  v_smfmac_f32_16x16x64_bf16 v[40:43], v[20:23], a[8:15], v1
  v_smfmac_f32_16x16x64_bf16 v[36:39], v[20:23], a[144:151], v1
  v_smfmac_f32_16x16x64_bf16 v[44:47], v[20:23], a[152:159], v1
  ds_read_b128 v[20:23], v0 offset:2048
  s_waitcnt lgkmcnt(6)
  v_smfmac_f32_16x16x64_bf16 v[32:35], v[24:27], a[96:103], v1
  v_smfmac_f32_16x16x64_bf16 v[40:43], v[24:27], a[104:111], v1
  v_smfmac_f32_16x16x64_bf16 v[36:39], v[24:27], v[72:79], v1
  ds_read_b128 v[72:75], v17 offset:6144
  ds_read_b128 v[76:79], v17 offset:7168
  s_waitcnt lgkmcnt(6)
  v_smfmac_f32_16x16x64_bf16 v[44:47], v[24:27], v[56:63], v1
  ds_read_b128 v[24:27], v0 offset:8192
  buffer_load_dwordx4 v[56:59], v0, s[4:7], s53 offen sc1
  s_waitcnt lgkmcnt(4)
  v_smfmac_f32_16x16x64_bf16 v[32:35], v[28:31], a[112:119], v1
  v_smfmac_f32_16x16x64_bf16 v[40:43], v[28:31], a[120:127], v1
  buffer_load_dwordx4 v[60:63], v0, s[4:7], s53 offen offset:1024 sc1
  v_smfmac_f32_16x16x64_bf16 v[36:39], v[28:31], v[48:55], v1
  ds_read_b128 v[48:51], v17 offset:20480
  ds_read_b128 v[52:55], v17 offset:21504
  s_waitcnt lgkmcnt(3)
  v_smfmac_f32_16x16x64_bf16 v[44:47], v[28:31], v[72:79], v1
  ds_read_b128 v[72:75], v17 offset:22528
  ds_read_b128 v[76:79], v17 offset:23552
  ds_read_b128 v[28:31], v0 offset:3072
  v_smfmac_f32_16x16x64_bf16 v[32:35], v[20:23], a[32:39], v1
  v_smfmac_f32_16x16x64_bf16 v[40:43], v[20:23], a[40:47], v1
  v_smfmac_f32_16x16x64_bf16 v[36:39], v[20:23], a[176:183], v1
  v_smfmac_f32_16x16x64_bf16 v[44:47], v[20:23], a[184:191], v1
  s_waitcnt lgkmcnt(5)
  v_smfmac_f32_16x16x64_bf16 v[32:35], v[24:27], a[128:135], v1
  v_smfmac_f32_16x16x64_bf16 v[40:43], v[24:27], a[136:143], v1
  s_waitcnt lgkmcnt(3)
  v_smfmac_f32_16x16x64_bf16 v[36:39], v[24:27], v[48:55], v1
  s_mov_b64 exec, 1
  buffer_store_dword v1, v0, s[4:7], s62 offen sc1
  s_mov_b64 exec, -1
  s_waitcnt lgkmcnt(1)
  v_mov_b64 v[48:49], 0
  v_smfmac_f32_16x16x64_bf16 v[44:47], v[24:27], v[72:79], v1
  s_waitcnt lgkmcnt(0)
  v_mov_b64 v[50:51], 0
  v_smfmac_f32_16x16x64_bf16 v[32:35], v[28:31], a[48:55], v1
  buffer_store_dwordx4 v[6:9], v0, s[4:7], s68 offen sc1
  v_mov_b64 v[52:53], 0
  v_smfmac_f32_16x16x64_bf16 v[36:39], v[28:31], a[192:199], v1
  v_mov_b64 v[54:55], 0
  v_smfmac_f32_16x16x64_bf16 v[40:43], v[28:31], a[56:63], v1
  v_smfmac_f32_16x16x64_bf16 v[44:47], v[28:31], a[200:207], v1
  ds_read_b128 v[72:75], v0 offset:1024
  ds_read_b128 v[76:79], v0 offset:5120
  v_smfmac_f32_16x16x64_bf16 v[48:51], v[20:23], a[240:247], v1
  v_cvt_pk_bf16_f32 v32, v32, v33
  v_cvt_pk_bf16_f32 v33, v34, v35
  v_cvt_pk_bf16_f32 v34, v36, v37
  v_cvt_pk_bf16_f32 v35, v38, v39
  v_cvt_pk_bf16_f32 v40, v40, v41
  v_cvt_pk_bf16_f32 v41, v42, v43
  v_mfma_f32_16x16x32_bf16 v[36:39], v[32:35], v[2:5], 0
  v_cvt_pk_bf16_f32 v42, v44, v45
  v_cvt_pk_bf16_f32 v43, v46, v47
  s_waitcnt vmcnt(2)
  s_nop 0
  v_mfma_f32_16x16x32_bf16 v[44:47], v[40:43], v[2:5], 0
  v_smfmac_f32_16x16x64_bf16 v[52:55], v[20:23], a[248:255], v1
  ds_read_b128 v[20:23], v0 offset:4096
  v_cvt_pk_bf16_f32 v32, v36, v37
  v_cvt_pk_bf16_f32 v33, v38, v39
  v_smfmac_f32_16x16x64_bf16 v[48:51], v[24:27], v[160:167], v1
  v_cvt_pk_bf16_f32 v34, v44, v45
  v_cvt_pk_bf16_f32 v35, v46, v47
  s_nop 1
  v_mfma_f32_16x16x32_bf16 v[36:39], v[56:59], v[32:35], 0
  v_mfma_f32_16x16x32_bf16 v[40:43], v[60:63], v[32:35], 0
  v_mfma_f32_16x16x32_bf16 v[44:47], v[32:35], v[32:35], 0
  v_smfmac_f32_16x16x64_bf16 v[52:55], v[24:27], v[168:175], v1
  ds_read_b128 v[24:27], v0 offset:0
  v_mov_b32_dpp v36, v40 row_ror:8 row_mask:0xf bank_mask:0xc
  v_mov_b32_dpp v37, v41 row_ror:8 row_mask:0xf bank_mask:0xc
  v_mov_b32_dpp v38, v42 row_ror:8 row_mask:0xf bank_mask:0xc
  v_mov_b32_dpp v39, v43 row_ror:8 row_mask:0xf bank_mask:0xc
  ds_write_b128 v0, v[36:39] offset:10496
  v_mov_b32_dpp v44, v46 row_ror:8 row_mask:0xf bank_mask:0xc
  v_mov_b32_dpp v45, v47 row_ror:8 row_mask:0xf bank_mask:0xc
  s_mov_b32 exec_lo, 0
  ds_write_b64 v12, v[44:45] offset:11520
  s_mov_b64 exec, s[80:81]
  buffer_store_dwordx4 v[32:35], v10, s[4:7], s61 offen offset:512 sc1
  s_mov_b64 exec, -1
  v_smfmac_f32_16x16x64_bf16 v[48:51], v[28:31], v[80:87], v1
  v_smfmac_f32_16x16x64_bf16 v[52:55], v[28:31], v[88:95], v1
  ds_read_b128 v[28:31], v0 offset:6144
  s_waitcnt lgkmcnt(6)
  v_smfmac_f32_16x16x64_bf16 v[48:51], v[72:75], a[224:231], v1
  v_smfmac_f32_16x16x64_bf16 v[52:55], v[72:75], a[232:239], v1
  ds_read_b128 v[72:75], v0 offset:7168
  s_waitcnt lgkmcnt(2)
  s_barrier
  ds_read_b128 v[40:43], v0 offset:9216
  ds_read_b64 v[56:57], v12 offset:10240
  ds_read_b128 v[44:47], v0 offset:11776
  ds_read_b64 v[58:59], v12 offset:11520
  ds_read_b128 v[32:35], v0 offset:13056
  ds_read_b64 v[60:61], v12 offset:12800
  ds_read_b64 v[62:63], v12 offset:14080
  v_smfmac_f32_16x16x64_bf16 v[48:51], v[76:79], v[112:119], v1
  v_smfmac_f32_16x16x64_bf16 v[52:55], v[76:79], v[120:127], v1
  v_smfmac_f32_16x16x64_bf16 v[48:51], v[20:23], v[96:103], v1
  v_smfmac_f32_16x16x64_bf16 v[52:55], v[20:23], v[104:111], v1
  v_smfmac_f32_16x16x64_bf16 v[48:51], v[24:27], a[208:215], v1
  v_smfmac_f32_16x16x64_bf16 v[52:55], v[24:27], a[216:223], v1
  s_waitcnt lgkmcnt(6)
  v_add_f32 v36, v36, v40
  v_add_f32 v37, v37, v41
  v_add_f32 v38, v38, v42
  v_add_f32 v39, v39, v43
  s_waitcnt lgkmcnt(3)
  v_add_f32 v56, v56, v58
  v_add_f32 v57, v57, v59
  s_waitcnt lgkmcnt(0)
  v_pk_add_f32 v[44:45], v[44:45], v[32:33]
  v_pk_add_f32 v[46:47], v[46:47], v[34:35]
  v_pk_add_f32 v[60:61], v[60:61], v[62:63]
  v_pk_add_f32 v[36:37], v[36:37], v[44:45]
  v_pk_add_f32 v[38:39], v[38:39], v[46:47]
  v_pk_add_f32 v[40:41], v[56:57], v[60:61]
  v_max3_f32 v42, v36, v37, v38
  v_max3_f32 v43, v39, v40, v41
  v_max_f32 v42, v42, v43
  ds_read_b128 v[56:59], v17 offset:36864
  ds_read_b128 v[60:63], v17 offset:37888
  v_max_f32_dpp v42, v42, v42 row_ror:8 row_mask:0xf bank_mask:0xf
  v_mov_b32 v43, v42
  v_smfmac_f32_16x16x64_bf16 v[48:51], v[28:31], v[128:135], v1
  s_nop 0
  v_permlane16_swap_b32 v42, v43
  v_max_f32 v42, v42, v43
  v_mov_b32 v43, v42
  v_smfmac_f32_16x16x64_bf16 v[52:55], v[28:31], v[136:143], v1
  s_nop 0
  v_permlane32_swap_b32 v42, v43
  v_max_f32 v42, v42, v43
  v_mul_f32 v42, s70, v42
  v_fma_f32 v36, v36, s70, -v42
  v_smfmac_f32_16x16x64_bf16 v[48:51], v[72:75], v[144:151], v1
  v_exp_f32 v36, v36
  v_fma_f32 v37, v37, s70, -v42
  v_exp_f32 v37, v37
  v_fma_f32 v38, v38, s70, -v42
  v_smfmac_f32_16x16x64_bf16 v[52:55], v[72:75], v[152:159], v1
  v_exp_f32 v38, v38
  v_fma_f32 v39, v39, s70, -v42
  v_exp_f32 v39, v39
  v_fma_f32 v40, v40, s70, -v42
  v_exp_f32 v40, v40
  v_fma_f32 v41, v41, s70, -v42
  v_exp_f32 v41, v41
  v_cvt_pk_bf16_f32 v44, v36, v37
  v_cvt_pk_bf16_f32 v45, v38, v39
  v_cvt_pk_bf16_f32 v32, v40, v41
  s_cmp_eq_u32 s52, 63
  v_mov_b32_dpp v46, v44 row_ror:8 row_mask:0xf bank_mask:0xf
  v_mov_b32_dpp v47, v45 row_ror:8 row_mask:0xf bank_mask:0xf
  v_add_f32 v40, v40, v41
  v_add_f32 v36, v36, v37
  v_mfma_f32_16x16x32_bf16 v[20:23], v[64:67], v[44:47], 0
  v_mov_b32_dpp v33, v32 row_ror:8 row_mask:0xf bank_mask:0xf
  v_add_f32 v38, v38, v39
  v_mfma_f32_16x16x32_bf16 v[24:27], v[68:71], v[44:47], 0
  v_cvt_pk_bf16_f32 v6, v48, v49
  v_cvt_pk_bf16_f32 v7, v50, v51
  v_fmac_f32 v36, 0.5, v40
  v_add_f32 v36, v36, v38
  v_mfma_f32_16x16x16_bf16 v[20:23], v[6:7], v[32:33], v[20:23]
  v_cvt_pk_bf16_f32 v8, v52, v53
  v_cvt_pk_bf16_f32 v9, v54, v55
  s_cbranch_scc1 L_rec_fin
  v_add_f32_dpp v36, v36, v36 row_ror:8 row_mask:0xf bank_mask:0xf
  v_mfma_f32_16x16x16_bf16 v[24:27], v[8:9], v[32:33], v[24:27]
  v_mov_b32 v37, v36
  v_mov_b64 v[64:65], 0
  v_mov_b64 v[66:67], 0
  v_permlane16_swap_b32 v36, v37
  v_add_f32 v36, v36, v37
  v_mov_b32 v37, v36
  v_mov_b64 v[68:69], 0
  v_mov_b64 v[70:71], 0
  v_permlane32_swap_b32 v36, v37
  v_add_f32 v36, v36, v37
  v_mov_b64 v[52:53], 0
  v_rcp_f32 v36, v36
  v_mov_b64 v[54:55], 0
  s_mov_b64 exec, s[78:79]
  v_pk_mul_f32 v[20:21], v[20:21], v[36:37] op_sel_hi:[1,0]
  v_pk_mul_f32 v[22:23], v[22:23], v[36:37] op_sel_hi:[1,0]
  v_pk_mul_f32 v[24:25], v[24:25], v[36:37] op_sel_hi:[1,0]
  v_pk_mul_f32 v[26:27], v[26:27], v[36:37] op_sel_hi:[1,0]
  v_cvt_pk_bf16_f32 v20, v20, v21
  v_cvt_pk_bf16_f32 v21, v22, v23
  v_cvt_pk_bf16_f32 v22, v24, v25
  v_cvt_pk_bf16_f32 v23, v26, v27
  s_barrier
  ds_write_b128 v10, v[20:23] offset:9728
  s_mov_b64 exec, -1
  ds_read_b128 v[72:75], v17 offset:38912
  ds_read_b128 v[76:79], v17 offset:39936
  ds_read_b128 v[28:31], v17 offset:53248
  ds_read_b128 v[32:35], v17 offset:54272
  s_waitcnt lgkmcnt(4)
  s_barrier
  ds_read_b128 v[20:23], v11 offset:9216
  ds_read_b128 v[24:27], v11 offset:10240
  ds_read_b128 v[36:39], v10 offset:9216
  ds_read_b128 v[40:43], v10 offset:9728
  ds_read_b128 v[44:47], v10 offset:10240
  ds_read_b128 v[48:51], v10 offset:10752
  s_waitcnt lgkmcnt(5)
  v_smfmac_f32_16x16x64_bf16 v[52:55], v[20:23], v[176:183], v1
  s_waitcnt lgkmcnt(4)
  v_smfmac_f32_16x16x64_bf16 v[52:55], v[24:27], v[184:191], v1
  ds_read_b128 v[20:23], v17 offset:55296
  ds_read_b128 v[24:27], v17 offset:56320
  s_waitcnt lgkmcnt(5)
  v_smfmac_f32_16x16x64_bf16 v[64:67], v[36:39], v[56:63], v1
  ds_read_b128 v[56:59], v18 offset:4096
  ds_read_b128 v[60:63], v18 offset:5120
  s_waitcnt lgkmcnt(6)
  v_smfmac_f32_16x16x64_bf16 v[64:67], v[40:43], v[72:79], v1
  ds_read_b128 v[72:75], v18 offset:6144
  ds_read_b128 v[76:79], v18 offset:7168
  s_waitcnt lgkmcnt(7)
  v_permlane32_swap_b32 v52, v54
  v_smfmac_f32_16x16x64_bf16 v[64:67], v[44:47], v[192:199], v1
  s_waitcnt lgkmcnt(6)
  v_permlane32_swap_b32 v53, v55
  v_add_f32 v52, v52, v54
  v_smfmac_f32_16x16x64_bf16 v[64:67], v[48:51], v[200:207], v1
  v_add_f32 v53, v53, v55
  v_cvt_pk_bf16_f32 v52, v52, v53
  v_smfmac_f32_16x16x64_bf16 v[68:71], v[36:39], v[28:35], v1
  ds_read_b128 v[28:31], v18 offset:20480
  ds_read_b128 v[32:35], v18 offset:21504
  s_waitcnt lgkmcnt(6)
  v_bfi_b32 v52, 1, s57, v52
  v_smfmac_f32_16x16x64_bf16 v[68:71], v[40:43], v[20:27], v1
  ds_read_b128 v[20:23], v18 offset:22528
  ds_read_b128 v[24:27], v18 offset:23552
  buffer_store_dword v52, v14, s[4:7], s58 offen
  v_mov_b64 v[54:55], 0
  v_mov_b64 v[52:53], 0
  v_smfmac_f32_16x16x64_bf16 v[68:71], v[44:47], v[208:215], v1
  v_cvt_pk_bf16_f32 v64, v64, v65
  v_cvt_pk_bf16_f32 v65, v66, v67
  v_smfmac_f32_16x16x64_bf16 v[68:71], v[48:51], v[216:223], v1
  s_waitcnt lgkmcnt(6)
  v_bfi_b32 v64, 1, s57, v64
  v_smfmac_f32_16x16x64_bf16 v[52:55], v[36:39], v[56:63], v1
  buffer_store_dwordx2 v[64:65], v13, s[4:7], s72 offen
  s_waitcnt lgkmcnt(4)
  v_mov_b64 v[66:67], 0
  v_smfmac_f32_16x16x64_bf16 v[52:55], v[40:43], v[72:79], v1
  v_mov_b64 v[64:65], 0
  v_smfmac_f32_16x16x64_bf16 v[52:55], v[44:47], v[224:231], v1
  v_cvt_pk_bf16_f32 v68, v68, v69
  v_smfmac_f32_16x16x64_bf16 v[52:55], v[48:51], v[232:239], v1
  s_waitcnt lgkmcnt(2)
  v_cvt_pk_bf16_f32 v69, v70, v71
  v_smfmac_f32_16x16x64_bf16 v[64:67], v[36:39], v[28:35], v1
  s_waitcnt lgkmcnt(0)
  v_bfi_b32 v68, 1, s57, v68
  v_smfmac_f32_16x16x64_bf16 v[64:67], v[40:43], v[20:27], v1
  buffer_store_dwordx2 v[68:69], v13, s[4:7], s73 offen
  v_cvt_pk_bf16_f32 v52, v52, v53
  v_smfmac_f32_16x16x64_bf16 v[64:67], v[44:47], v[240:247], v1
  v_cvt_pk_bf16_f32 v53, v54, v55
  v_smfmac_f32_16x16x64_bf16 v[64:67], v[48:51], v[248:255], v1
  v_bfi_b32 v52, 1, s57, v52
  s_mov_b32 s63, 0
  buffer_store_dwordx2 v[52:53], v13, s[4:7], s74 offen
  s_nop 4
  v_cvt_pk_bf16_f32 v64, v64, v65
  v_cvt_pk_bf16_f32 v65, v66, v67
  v_bfi_b32 v64, 1, s57, v64
  buffer_store_dwordx2 v[64:65], v13, s[4:7], s75 offen
  s_cmp_ge_u32 s21, 4
  s_cbranch_scc1 L_nored_1
  v_bfe_u32 v56, v0, 4, 1
  v_lshlrev_b32 v56, 4, v56
  v_mov_b32 v57, 0x3f80
  v_lshlrev_b32 v56, v56, v57
  v_cndmask_b32 v60, 0, v56, s[8:9]
  v_cndmask_b32 v61, 0, v56, s[10:11]
  v_cndmask_b32 v62, 0, v56, s[12:13]
  v_cndmask_b32 v63, 0, v56, s[14:15]
  s_waitcnt vmcnt(1)
L_ppoll_1:
  buffer_load_dwordx4 v[20:23], v0, s[4:7], s59 offen offset:0 sc1
  buffer_load_dwordx4 v[24:27], v0, s[4:7], s59 offen offset:1024 sc1
  buffer_load_dwordx4 v[28:31], v0, s[4:7], s59 offen offset:2048 sc1
  buffer_load_dwordx4 v[32:35], v0, s[4:7], s59 offen offset:3072 sc1
  buffer_load_dwordx4 v[36:39], v0, s[4:7], s69 offen offset:0 sc1
  buffer_load_dwordx4 v[40:43], v0, s[4:7], s69 offen offset:1024 sc1
  buffer_load_dwordx4 v[44:47], v0, s[4:7], s69 offen offset:2048 sc1
  buffer_load_dwordx4 v[48:51], v0, s[4:7], s69 offen offset:3072 sc1
  s_add_u32 s63, s63, 1
  s_cmp_ge_u32 s63, 0x2000
  s_waitcnt vmcnt(7)
  v_mfma_f32_16x16x32_bf16 v[52:55], v[20:23], v[60:63], 0
  v_bitop3_b32 v56, v20, v22, s57 bitop3:0x7e
  s_waitcnt vmcnt(6)
  v_mfma_f32_16x16x32_bf16 v[52:55], v[24:27], v[60:63], v[52:55]
  v_bitop3_b32 v56, v56, v24, s57 bitop3:0xf6
  v_bitop3_b32 v56, v56, v26, s57 bitop3:0xf6
  s_waitcnt vmcnt(5)
  v_mfma_f32_16x16x32_bf16 v[52:55], v[28:31], v[60:63], v[52:55]
  v_bitop3_b32 v56, v56, v28, s57 bitop3:0xf6
  v_bitop3_b32 v56, v56, v30, s57 bitop3:0xf6
  s_waitcnt vmcnt(4)
  v_mfma_f32_16x16x32_bf16 v[52:55], v[32:35], v[60:63], v[52:55]
  v_bitop3_b32 v56, v56, v32, s57 bitop3:0xf6
  v_bitop3_b32 v56, v56, v34, s57 bitop3:0xf6
  s_waitcnt vmcnt(3)
  v_mfma_f32_16x16x32_bf16 v[52:55], v[36:39], v[60:63], v[52:55]
  v_bitop3_b32 v56, v56, v36, s57 bitop3:0xf6
  v_bitop3_b32 v56, v56, v38, s57 bitop3:0xf6
  s_waitcnt vmcnt(2)
  v_mfma_f32_16x16x32_bf16 v[52:55], v[40:43], v[60:63], v[52:55]
  v_bitop3_b32 v56, v56, v40, s57 bitop3:0xf6
  v_bitop3_b32 v56, v56, v42, s57 bitop3:0xf6
  s_waitcnt vmcnt(1)
  v_mfma_f32_16x16x32_bf16 v[52:55], v[44:47], v[60:63], v[52:55]
  v_bitop3_b32 v56, v56, v44, s57 bitop3:0xf6
  v_bitop3_b32 v56, v56, v46, s57 bitop3:0xf6
  s_waitcnt vmcnt(0)
  v_mfma_f32_16x16x32_bf16 v[52:55], v[48:51], v[60:63], v[52:55]
  v_bitop3_b32 v56, v56, v48, s57 bitop3:0xf6
  v_bitop3_b32 v56, v56, v50, s57 bitop3:0xf6
  v_and_b32 v56, 1, v56
  v_cmp_ne_u32 vcc, 0, v56
  s_cbranch_scc1 L_pok_1
  s_cbranch_vccnz L_ppoll_1
L_pok_1:
  s_mov_b64 exec, s[78:79]
  s_nop 1
  v_cvt_pk_bf16_f32 v58, v52, v53
  v_cvt_pk_bf16_f32 v59, v54, v55
  v_bfi_b32 v58, 1, s57, v58
  buffer_store_dwordx2 v[58:59], v15, s[4:7], s56 offen
  s_mov_b64 exec, -1
  s_mov_b32 s63, 0
L_nored_1:
  s_barrier
  s_branch L_step_1
.p2align 5
L_step_2:
L_shadow_2:
  ds_read_b128 v[48:51], v0 offset:57344
  ds_read_b128 v[52:55], v0 offset:58368
  ds_read_b128 v[72:75], v0 offset:59392
  ds_read_b128 v[76:79], v0 offset:60416
  ds_read_b128 v[56:59], v0 offset:24576
  ds_read_b128 v[60:63], v0 offset:25600
  s_xor_b32 s58, s58, 0x80000
  s_xor_b32 s59, s59, 0x80000
  s_xor_b32 s72, s72, 0x80000
  s_xor_b32 s73, s73, 0x80000
  s_xor_b32 s74, s74, 0x80000
  s_xor_b32 s75, s75, 0x80000
  s_xor_b32 s56, s56, 0x4000
  s_add_u32 s52, s52, 1
  s_mov_b32 s60, s57
  s_bfe_u32 s57, s52, 0x10001
  s_add_u32 s53, s53, 16384
  s_add_u32 s54, s53, 8192
  s_add_u32 s76, s53, 12288
  s_add_u32 s68, s61, 4096
  s_add_u32 s61, s61, 6144
  s_add_u32 s62, s62, 128
  s_cmp_ge_u32 s63, 0x2000
  s_cbranch_scc1 L_mzero_2
L_mretry_2:
  buffer_load_dwordx4 v[20:23], v0, s[4:7], s55 offen sc1
  buffer_load_dwordx4 v[24:27], v0, s[4:7], s77 offen sc1
L_mzero_2:
  v_mov_b64 v[32:33], 0
  v_mov_b64 v[34:35], 0
  v_mov_b64 v[36:37], 0
  v_mov_b64 v[38:39], 0
  v_mov_b64 v[40:41], 0
  v_mov_b64 v[42:43], 0
  v_mov_b64 v[44:45], 0
  v_mov_b64 v[46:47], 0
L_mchk_2:
  s_add_u32 s63, s63, 1
  s_cmp_ge_u32 s63, 0x2000
  s_cselect_b32 s64, 0, 1
  s_waitcnt vmcnt(1)
  ds_write_b128 v0, v[20:23] offset:2048
  v_smfmac_f32_16x16x64_bf16 v[32:35], v[20:23], a[32:39], v1
  s_waitcnt vmcnt(0)
  ds_write_b128 v0, v[24:27] offset:6144
  v_bitop3_b32 v19, v20, v22, s60 bitop3:0x7e
  v_smfmac_f32_16x16x64_bf16 v[40:43], v[20:23], a[40:47], v1
  v_bitop3_b32 v19, v19, v24, s60 bitop3:0xf6
  v_bitop3_b32 v19, v19, v26, s60 bitop3:0xf6
  v_smfmac_f32_16x16x64_bf16 v[36:39], v[20:23], a[176:183], v1
  v_and_b32 v19, s64, v19
  v_cmp_ne_u32 vcc, 0, v19
  v_smfmac_f32_16x16x64_bf16 v[44:47], v[20:23], a[184:191], v1
  s_cbranch_vccnz L_mretry_2
  v_smfmac_f32_16x16x64_bf16 v[32:35], v[24:27], a[96:103], v1
  s_waitcnt lgkmcnt(0)
  s_barrier
  ds_read_b128 v[28:31], v0 offset:4096
  ds_read_b128 v[20:23], v0 offset:0
  s_xor_b32 s55, s55, 0x4000
  v_smfmac_f32_16x16x64_bf16 v[40:43], v[24:27], a[104:111], v1
  s_xor_b32 s77, s77, 0x4000
  s_mov_b32 m0, 14336
  v_lshlrev_b32 v19, 3, v0
  v_smfmac_f32_16x16x64_bf16 v[36:39], v[24:27], v[48:55], v1
  ds_read_b128 v[48:51], v0 offset:26624
  ds_read_b128 v[52:55], v0 offset:27648
  v_smfmac_f32_16x16x64_bf16 v[44:47], v[24:27], v[72:79], v1
  ds_read_b128 v[72:75], v0 offset:40960
  ds_read_b128 v[76:79], v0 offset:41984
  ds_read_b128 v[24:27], v0 offset:5120
  s_waitcnt lgkmcnt(6)
  v_smfmac_f32_16x16x64_bf16 v[32:35], v[28:31], a[64:71], v1
  buffer_load_dwordx4 v[64:67], v0, s[4:7], s54 offen sc1
  v_smfmac_f32_16x16x64_bf16 v[40:43], v[28:31], a[72:79], v1
  v_smfmac_f32_16x16x64_bf16 v[36:39], v[28:31], v[56:63], v1
  ds_read_b128 v[56:59], v0 offset:43008
  ds_read_b128 v[60:63], v0 offset:44032
  s_waitcnt lgkmcnt(5)
  v_smfmac_f32_16x16x64_bf16 v[44:47], v[28:31], v[48:55], v1
  ds_read_b128 v[48:51], v17 offset:8192
  ds_read_b128 v[52:55], v17 offset:9216
  ds_read_b128 v[28:31], v0 offset:7168
  v_smfmac_f32_16x16x64_bf16 v[32:35], v[20:23], a[0:7], v1
  buffer_load_dwordx4 v[68:71], v0, s[4:7], s54 offen offset:1024 sc1
  v_smfmac_f32_16x16x64_bf16 v[40:43], v[20:23], a[8:15], v1
  v_smfmac_f32_16x16x64_bf16 v[36:39], v[20:23], a[144:151], v1
  v_smfmac_f32_16x16x64_bf16 v[44:47], v[20:23], a[152:159], v1
  ds_read_b128 v[20:23], v0 offset:1024
  s_waitcnt lgkmcnt(6)
  v_smfmac_f32_16x16x64_bf16 v[32:35], v[24:27], a[80:87], v1
  v_smfmac_f32_16x16x64_bf16 v[40:43], v[24:27], a[88:95], v1
  v_smfmac_f32_16x16x64_bf16 v[36:39], v[24:27], v[72:79], v1
  ds_read_b128 v[72:75], v17 offset:10240
  ds_read_b128 v[76:79], v17 offset:11264
  s_waitcnt lgkmcnt(6)
  v_smfmac_f32_16x16x64_bf16 v[44:47], v[24:27], v[56:63], v1
  ds_read_b128 v[24:27], v0 offset:8192
  buffer_load_dwordx4 v[56:59], v0, s[4:7], s53 offen sc1
  s_waitcnt lgkmcnt(4)
  v_smfmac_f32_16x16x64_bf16 v[32:35], v[28:31], a[112:119], v1
  v_smfmac_f32_16x16x64_bf16 v[40:43], v[28:31], a[120:127], v1
  buffer_load_dwordx4 v[60:63], v0, s[4:7], s53 offen offset:1024 sc1
  v_smfmac_f32_16x16x64_bf16 v[36:39], v[28:31], v[48:55], v1
  ds_read_b128 v[48:51], v17 offset:24576
  ds_read_b128 v[52:55], v17 offset:25600
  s_waitcnt lgkmcnt(3)
  v_smfmac_f32_16x16x64_bf16 v[44:47], v[28:31], v[72:79], v1
  ds_read_b128 v[72:75], v17 offset:26624
  ds_read_b128 v[76:79], v17 offset:27648
  ds_read_b128 v[28:31], v0 offset:3072
  v_smfmac_f32_16x16x64_bf16 v[32:35], v[20:23], a[16:23], v1
  v_smfmac_f32_16x16x64_bf16 v[40:43], v[20:23], a[24:31], v1
  v_smfmac_f32_16x16x64_bf16 v[36:39], v[20:23], a[160:167], v1
  v_smfmac_f32_16x16x64_bf16 v[44:47], v[20:23], a[168:175], v1
  s_waitcnt lgkmcnt(5)
  v_smfmac_f32_16x16x64_bf16 v[32:35], v[24:27], a[128:135], v1
  v_smfmac_f32_16x16x64_bf16 v[40:43], v[24:27], a[136:143], v1
  buffer_load_dword v19, s[4:7], s76 offen sc1 lds
  s_waitcnt lgkmcnt(3)
  v_smfmac_f32_16x16x64_bf16 v[36:39], v[24:27], v[48:55], v1
  s_waitcnt lgkmcnt(1)
  v_mov_b64 v[48:49], 0
  v_smfmac_f32_16x16x64_bf16 v[44:47], v[24:27], v[72:79], v1
  s_waitcnt lgkmcnt(0)
  v_mov_b64 v[50:51], 0
  v_smfmac_f32_16x16x64_bf16 v[32:35], v[28:31], a[48:55], v1
  v_mov_b64 v[52:53], 0
  v_smfmac_f32_16x16x64_bf16 v[36:39], v[28:31], a[192:199], v1
  buffer_store_dwordx4 v[6:9], v0, s[4:7], s68 offen sc1
  v_mov_b64 v[54:55], 0
  v_smfmac_f32_16x16x64_bf16 v[40:43], v[28:31], a[56:63], v1
  v_smfmac_f32_16x16x64_bf16 v[44:47], v[28:31], a[200:207], v1
  ds_read_b128 v[72:75], v0 offset:2048
  ds_read_b128 v[76:79], v0 offset:6144
  v_smfmac_f32_16x16x64_bf16 v[48:51], v[20:23], a[224:231], v1
  v_cvt_pk_bf16_f32 v32, v32, v33
  v_cvt_pk_bf16_f32 v33, v34, v35
  v_cvt_pk_bf16_f32 v34, v36, v37
  v_cvt_pk_bf16_f32 v35, v38, v39
  v_cvt_pk_bf16_f32 v40, v40, v41
  v_cvt_pk_bf16_f32 v41, v42, v43
  v_mfma_f32_16x16x32_bf16 v[36:39], v[32:35], v[2:5], 0
  v_cvt_pk_bf16_f32 v42, v44, v45
  v_cvt_pk_bf16_f32 v43, v46, v47
  s_waitcnt vmcnt(2)
  s_nop 0
  v_mfma_f32_16x16x32_bf16 v[44:47], v[40:43], v[2:5], 0
  v_smfmac_f32_16x16x64_bf16 v[52:55], v[20:23], a[232:239], v1
  ds_read_b128 v[20:23], v0 offset:4096
  v_cvt_pk_bf16_f32 v32, v36, v37
  v_cvt_pk_bf16_f32 v33, v38, v39
  v_smfmac_f32_16x16x64_bf16 v[48:51], v[24:27], v[160:167], v1
  v_cvt_pk_bf16_f32 v34, v44, v45
  v_cvt_pk_bf16_f32 v35, v46, v47
  s_nop 1
  v_mfma_f32_16x16x32_bf16 v[36:39], v[56:59], v[32:35], 0
  v_mfma_f32_16x16x32_bf16 v[40:43], v[60:63], v[32:35], 0
  v_mfma_f32_16x16x32_bf16 v[44:47], v[32:35], v[32:35], 0
  v_smfmac_f32_16x16x64_bf16 v[52:55], v[24:27], v[168:175], v1
  ds_read_b128 v[24:27], v0 offset:0
  v_mov_b32_dpp v36, v40 row_ror:8 row_mask:0xf bank_mask:0xc
  v_mov_b32_dpp v37, v41 row_ror:8 row_mask:0xf bank_mask:0xc
  v_mov_b32_dpp v38, v42 row_ror:8 row_mask:0xf bank_mask:0xc
  v_mov_b32_dpp v39, v43 row_ror:8 row_mask:0xf bank_mask:0xc
  ds_write_b128 v0, v[36:39] offset:11776
  v_mov_b32_dpp v44, v46 row_ror:8 row_mask:0xf bank_mask:0xc
  v_mov_b32_dpp v45, v47 row_ror:8 row_mask:0xf bank_mask:0xc
  s_mov_b32 exec_lo, 0
  ds_write_b64 v12, v[44:45] offset:12800
  s_mov_b64 exec, s[80:81]
  buffer_store_dwordx4 v[32:35], v10, s[4:7], s61 offen offset:1024 sc1
  s_mov_b64 exec, -1
  v_smfmac_f32_16x16x64_bf16 v[48:51], v[28:31], v[80:87], v1
  v_smfmac_f32_16x16x64_bf16 v[52:55], v[28:31], v[88:95], v1
  ds_read_b128 v[28:31], v0 offset:5120
  s_waitcnt lgkmcnt(6)
  v_smfmac_f32_16x16x64_bf16 v[48:51], v[72:75], a[240:247], v1
  v_smfmac_f32_16x16x64_bf16 v[52:55], v[72:75], a[248:255], v1
  ds_read_b128 v[72:75], v0 offset:7168
  s_waitcnt lgkmcnt(2)
  s_barrier
  ds_read_b128 v[40:43], v0 offset:9216
  ds_read_b64 v[56:57], v12 offset:10240
  ds_read_b128 v[44:47], v0 offset:10496
  ds_read_b64 v[58:59], v12 offset:11520
  ds_read_b128 v[32:35], v0 offset:13056
  ds_read_b64 v[60:61], v12 offset:12800
  ds_read_b64 v[62:63], v12 offset:14080
  v_smfmac_f32_16x16x64_bf16 v[48:51], v[76:79], v[128:135], v1
  v_smfmac_f32_16x16x64_bf16 v[52:55], v[76:79], v[136:143], v1
  v_smfmac_f32_16x16x64_bf16 v[48:51], v[20:23], v[96:103], v1
  v_smfmac_f32_16x16x64_bf16 v[52:55], v[20:23], v[104:111], v1
  v_smfmac_f32_16x16x64_bf16 v[48:51], v[24:27], a[208:215], v1
  v_smfmac_f32_16x16x64_bf16 v[52:55], v[24:27], a[216:223], v1
  s_waitcnt lgkmcnt(6)
  v_add_f32 v36, v36, v40
  v_add_f32 v37, v37, v41
  v_add_f32 v38, v38, v42
  v_add_f32 v39, v39, v43
  s_waitcnt lgkmcnt(3)
  v_add_f32 v56, v56, v58
  v_add_f32 v57, v57, v59
  s_waitcnt lgkmcnt(0)
  v_pk_add_f32 v[44:45], v[44:45], v[32:33]
  v_pk_add_f32 v[46:47], v[46:47], v[34:35]
  v_pk_add_f32 v[60:61], v[60:61], v[62:63]
  v_pk_add_f32 v[36:37], v[36:37], v[44:45]
  v_pk_add_f32 v[38:39], v[38:39], v[46:47]
  v_pk_add_f32 v[40:41], v[56:57], v[60:61]
  v_max3_f32 v42, v36, v37, v38
  v_max3_f32 v43, v39, v40, v41
  v_max_f32 v42, v42, v43
  ds_read_b128 v[56:59], v17 offset:40960
  ds_read_b128 v[60:63], v17 offset:41984
  v_max_f32_dpp v42, v42, v42 row_ror:8 row_mask:0xf bank_mask:0xf
  v_mov_b32 v43, v42
  v_smfmac_f32_16x16x64_bf16 v[48:51], v[28:31], v[112:119], v1
  s_nop 0
  v_permlane16_swap_b32 v42, v43
  v_max_f32 v42, v42, v43
  v_mov_b32 v43, v42
  v_smfmac_f32_16x16x64_bf16 v[52:55], v[28:31], v[120:127], v1
  s_nop 0
  v_permlane32_swap_b32 v42, v43
  v_max_f32 v42, v42, v43
  v_mul_f32 v42, s70, v42
  v_fma_f32 v36, v36, s70, -v42
  v_smfmac_f32_16x16x64_bf16 v[48:51], v[72:75], v[144:151], v1
  v_exp_f32 v36, v36
  v_fma_f32 v37, v37, s70, -v42
  v_exp_f32 v37, v37
  v_fma_f32 v38, v38, s70, -v42
  v_smfmac_f32_16x16x64_bf16 v[52:55], v[72:75], v[152:159], v1
  v_exp_f32 v38, v38
  v_fma_f32 v39, v39, s70, -v42
  v_exp_f32 v39, v39
  v_fma_f32 v40, v40, s70, -v42
  v_exp_f32 v40, v40
  v_fma_f32 v41, v41, s70, -v42
  v_exp_f32 v41, v41
  v_cvt_pk_bf16_f32 v44, v36, v37
  v_cvt_pk_bf16_f32 v45, v38, v39
  v_cvt_pk_bf16_f32 v32, v40, v41
  s_cmp_eq_u32 s52, 63
  v_mov_b32_dpp v46, v44 row_ror:8 row_mask:0xf bank_mask:0xf
  v_mov_b32_dpp v47, v45 row_ror:8 row_mask:0xf bank_mask:0xf
  v_add_f32 v40, v40, v41
  v_add_f32 v36, v36, v37
  v_mfma_f32_16x16x32_bf16 v[20:23], v[64:67], v[44:47], 0
  v_mov_b32_dpp v33, v32 row_ror:8 row_mask:0xf bank_mask:0xf
  v_add_f32 v38, v38, v39
  v_mfma_f32_16x16x32_bf16 v[24:27], v[68:71], v[44:47], 0
  v_cvt_pk_bf16_f32 v6, v48, v49
  v_cvt_pk_bf16_f32 v7, v50, v51
  v_fmac_f32 v36, 0.5, v40
  v_add_f32 v36, v36, v38
  v_mfma_f32_16x16x16_bf16 v[20:23], v[6:7], v[32:33], v[20:23]
  v_cvt_pk_bf16_f32 v8, v52, v53
  v_cvt_pk_bf16_f32 v9, v54, v55
  s_cbranch_scc1 L_rec_fin
  v_add_f32_dpp v36, v36, v36 row_ror:8 row_mask:0xf bank_mask:0xf
  v_mfma_f32_16x16x16_bf16 v[24:27], v[8:9], v[32:33], v[24:27]
  v_mov_b32 v37, v36
  v_mov_b64 v[64:65], 0
  v_mov_b64 v[66:67], 0
  v_permlane16_swap_b32 v36, v37
  v_add_f32 v36, v36, v37
  v_mov_b32 v37, v36
  v_mov_b64 v[68:69], 0
  v_mov_b64 v[70:71], 0
  v_permlane32_swap_b32 v36, v37
  v_add_f32 v36, v36, v37
  v_mov_b64 v[52:53], 0
  v_rcp_f32 v36, v36
  v_mov_b64 v[54:55], 0
  s_mov_b64 exec, s[78:79]
  v_pk_mul_f32 v[20:21], v[20:21], v[36:37] op_sel_hi:[1,0]
  v_pk_mul_f32 v[22:23], v[22:23], v[36:37] op_sel_hi:[1,0]
  v_pk_mul_f32 v[24:25], v[24:25], v[36:37] op_sel_hi:[1,0]
  v_pk_mul_f32 v[26:27], v[26:27], v[36:37] op_sel_hi:[1,0]
  v_cvt_pk_bf16_f32 v20, v20, v21
  v_cvt_pk_bf16_f32 v21, v22, v23
  v_cvt_pk_bf16_f32 v22, v24, v25
  v_cvt_pk_bf16_f32 v23, v26, v27
  s_barrier
  ds_write_b128 v10, v[20:23] offset:10240
  s_mov_b64 exec, -1
  ds_read_b128 v[72:75], v17 offset:43008
  ds_read_b128 v[76:79], v17 offset:44032
  ds_read_b128 v[28:31], v17 offset:57344
  ds_read_b128 v[32:35], v17 offset:58368
  s_waitcnt lgkmcnt(4)
  s_barrier
  ds_read_b128 v[20:23], v11 offset:9216
  ds_read_b128 v[24:27], v11 offset:10240
  ds_read_b128 v[36:39], v10 offset:9216
  ds_read_b128 v[40:43], v10 offset:9728
  ds_read_b128 v[44:47], v10 offset:10240
  ds_read_b128 v[48:51], v10 offset:10752
  s_waitcnt lgkmcnt(5)
  v_smfmac_f32_16x16x64_bf16 v[52:55], v[20:23], v[176:183], v1
  s_waitcnt lgkmcnt(4)
  v_smfmac_f32_16x16x64_bf16 v[52:55], v[24:27], v[184:191], v1
  ds_read_b128 v[20:23], v17 offset:59392
  ds_read_b128 v[24:27], v17 offset:60416
  s_waitcnt lgkmcnt(5)
  v_smfmac_f32_16x16x64_bf16 v[64:67], v[36:39], v[56:63], v1
  ds_read_b128 v[56:59], v18 offset:8192
  ds_read_b128 v[60:63], v18 offset:9216
  s_waitcnt lgkmcnt(6)
  v_smfmac_f32_16x16x64_bf16 v[64:67], v[40:43], v[72:79], v1
  ds_read_b128 v[72:75], v18 offset:10240
  ds_read_b128 v[76:79], v18 offset:11264
  s_waitcnt lgkmcnt(7)
  v_permlane32_swap_b32 v52, v54
  v_smfmac_f32_16x16x64_bf16 v[64:67], v[44:47], v[192:199], v1
  s_waitcnt lgkmcnt(6)
  v_permlane32_swap_b32 v53, v55
  v_add_f32 v52, v52, v54
  v_smfmac_f32_16x16x64_bf16 v[64:67], v[48:51], v[200:207], v1
  v_add_f32 v53, v53, v55
  v_cvt_pk_bf16_f32 v52, v52, v53
  v_smfmac_f32_16x16x64_bf16 v[68:71], v[36:39], v[28:35], v1
  ds_read_b128 v[28:31], v18 offset:24576
  ds_read_b128 v[32:35], v18 offset:25600
  s_waitcnt lgkmcnt(6)
  v_bfi_b32 v52, 1, s57, v52
  v_smfmac_f32_16x16x64_bf16 v[68:71], v[40:43], v[20:27], v1
  ds_read_b128 v[20:23], v18 offset:26624
  ds_read_b128 v[24:27], v18 offset:27648
  buffer_store_dword v52, v14, s[4:7], s58 offen
  v_mov_b64 v[54:55], 0
  v_mov_b64 v[52:53], 0
  v_smfmac_f32_16x16x64_bf16 v[68:71], v[44:47], v[208:215], v1
  v_cvt_pk_bf16_f32 v64, v64, v65
  v_cvt_pk_bf16_f32 v65, v66, v67
  v_smfmac_f32_16x16x64_bf16 v[68:71], v[48:51], v[216:223], v1
  s_waitcnt lgkmcnt(6)
  v_bfi_b32 v64, 1, s57, v64
  v_smfmac_f32_16x16x64_bf16 v[52:55], v[36:39], v[56:63], v1
  buffer_store_dwordx2 v[64:65], v13, s[4:7], s72 offen
  s_waitcnt lgkmcnt(4)
  v_mov_b64 v[66:67], 0
  v_smfmac_f32_16x16x64_bf16 v[52:55], v[40:43], v[72:79], v1
  v_mov_b64 v[64:65], 0
  v_smfmac_f32_16x16x64_bf16 v[52:55], v[44:47], v[224:231], v1
  v_cvt_pk_bf16_f32 v68, v68, v69
  v_smfmac_f32_16x16x64_bf16 v[52:55], v[48:51], v[232:239], v1
  s_waitcnt lgkmcnt(2)
  v_cvt_pk_bf16_f32 v69, v70, v71
  v_smfmac_f32_16x16x64_bf16 v[64:67], v[36:39], v[28:35], v1
  s_waitcnt lgkmcnt(0)
  v_bfi_b32 v68, 1, s57, v68
  v_smfmac_f32_16x16x64_bf16 v[64:67], v[40:43], v[20:27], v1
  buffer_store_dwordx2 v[68:69], v13, s[4:7], s73 offen
  v_cvt_pk_bf16_f32 v52, v52, v53
  v_smfmac_f32_16x16x64_bf16 v[64:67], v[44:47], v[240:247], v1
  v_cvt_pk_bf16_f32 v53, v54, v55
  v_smfmac_f32_16x16x64_bf16 v[64:67], v[48:51], v[248:255], v1
  v_bfi_b32 v52, 1, s57, v52
  s_mov_b32 s63, 0
  buffer_store_dwordx2 v[52:53], v13, s[4:7], s74 offen
  s_nop 4
  v_cvt_pk_bf16_f32 v64, v64, v65
  v_cvt_pk_bf16_f32 v65, v66, v67
  v_bfi_b32 v64, 1, s57, v64
  buffer_store_dwordx2 v[64:65], v13, s[4:7], s75 offen
  s_barrier
  s_branch L_step_2
.p2align 5
L_step_3:
L_shadow_3:
  ds_read_b128 v[48:51], v17 offset:12288
  ds_read_b128 v[52:55], v17 offset:13312
  ds_read_b128 v[72:75], v17 offset:14336
  ds_read_b128 v[76:79], v17 offset:15360
  ds_read_b128 v[56:59], v17 offset:28672
  ds_read_b128 v[60:63], v17 offset:29696
  s_xor_b32 s58, s58, 0x80000
  s_xor_b32 s59, s59, 0x80000
  s_xor_b32 s72, s72, 0x80000
  s_xor_b32 s73, s73, 0x80000
  s_xor_b32 s74, s74, 0x80000
  s_xor_b32 s75, s75, 0x80000
  s_xor_b32 s56, s56, 0x4000
  s_add_u32 s52, s52, 1
  s_mov_b32 s60, s57
  s_bfe_u32 s57, s52, 0x10001
  s_add_u32 s53, s53, 16384
  s_add_u32 s54, s53, 8192
  s_add_u32 s76, s53, 18432
  s_add_u32 s68, s61, 5120
  s_add_u32 s61, s61, 6144
  s_add_u32 s62, s62, 128
  s_add_u32 s64, s52, 1
  s_lshr_b32 s64, s64, 2
  s_min_u32 s64, s64, 15
  s_lshl_b32 s64, s64, 10
  s_add_u32 s65, s64, s3
  s_mov_b64 exec, 3
  v_cmp_eq_u32 vcc, 0, v16
  s_mov_b64 exec, -1
  s_cbranch_vccz L_kvok
  v_lshlrev_b32 v19, 3, v0
  s_mov_b32 s66, 0
  s_mov_b32 exec_lo, 0x3
  s_mov_b32 exec_hi, 0x0
L_kvs:
  buffer_load_dword v16, v19, s[4:7], s65 offen sc1
  s_add_u32 s66, s66, 1
  s_cmp_ge_u32 s66, 0x8000
  s_waitcnt vmcnt(0)
  v_cmp_eq_u32 vcc, 0, v16
  s_cbranch_scc1 L_kvs_x
  s_cbranch_vccz L_kvs_x
  s_sleep 2
  s_branch L_kvs
L_kvs_x:
  s_mov_b64 exec, -1
L_kvok:
  s_add_u32 s64, s52, 2
  s_lshr_b32 s64, s64, 2
  s_min_u32 s64, s64, 15
  s_lshl_b32 s64, s64, 10
  s_add_u32 s69, s64, s3
  s_cmp_ge_u32 s63, 0x2000
  s_cbranch_scc1 L_mzero_3
L_mretry_3:
  buffer_load_dwordx4 v[20:23], v0, s[4:7], s55 offen sc1
  buffer_load_dwordx4 v[24:27], v0, s[4:7], s77 offen sc1
  buffer_load_dwordx4 v[28:31], v0, s[4:7], s71 offen sc1
L_mzero_3:
  v_mov_b64 v[32:33], 0
  v_mov_b64 v[34:35], 0
  v_mov_b64 v[36:37], 0
  v_mov_b64 v[38:39], 0
  v_mov_b64 v[40:41], 0
  v_mov_b64 v[42:43], 0
  v_mov_b64 v[44:45], 0
  v_mov_b64 v[46:47], 0
L_mchk_3:
  s_add_u32 s63, s63, 1
  s_cmp_ge_u32 s63, 0x2000
  s_cselect_b32 s64, 0, 1
  s_waitcnt vmcnt(2)
  ds_write_b128 v0, v[20:23] offset:3072
  v_smfmac_f32_16x16x64_bf16 v[32:35], v[20:23], a[48:55], v1
  s_waitcnt vmcnt(1)
  ds_write_b128 v0, v[24:27] offset:7168
  v_bitop3_b32 v19, v20, v22, s60 bitop3:0x7e
  v_smfmac_f32_16x16x64_bf16 v[40:43], v[20:23], a[56:63], v1
  s_waitcnt vmcnt(0)
  ds_write_b128 v0, v[28:31] offset:8192
  v_bitop3_b32 v19, v19, v24, s60 bitop3:0xf6
  v_bitop3_b32 v19, v19, v26, s60 bitop3:0xf6
  v_smfmac_f32_16x16x64_bf16 v[36:39], v[20:23], a[192:199], v1
  v_bitop3_b32 v19, v19, v28, s60 bitop3:0xf6
  v_bitop3_b32 v19, v19, v30, s60 bitop3:0xf6
  v_and_b32 v19, s64, v19
  v_cmp_ne_u32 vcc, 0, v19
  v_smfmac_f32_16x16x64_bf16 v[44:47], v[20:23], a[200:207], v1
  s_cbranch_vccnz L_mretry_3
  v_smfmac_f32_16x16x64_bf16 v[32:35], v[24:27], a[112:119], v1
  s_waitcnt lgkmcnt(0)
  s_barrier
  ds_read_b128 v[20:23], v0 offset:0
  s_xor_b32 s55, s55, 0x4000
  s_xor_b32 s77, s77, 0x4000
  v_smfmac_f32_16x16x64_bf16 v[40:43], v[24:27], a[120:127], v1
  s_xor_b32 s71, s71, 0x4000
  s_mov_b32 m0, 14336
  v_lshlrev_b32 v19, 3, v0
  v_smfmac_f32_16x16x64_bf16 v[36:39], v[24:27], v[48:55], v1
  ds_read_b128 v[48:51], v17 offset:30720
  ds_read_b128 v[52:55], v17 offset:31744
  v_smfmac_f32_16x16x64_bf16 v[44:47], v[24:27], v[72:79], v1
  ds_read_b128 v[72:75], v0 offset:28672
  ds_read_b128 v[76:79], v0 offset:29696
  ds_read_b128 v[24:27], v0 offset:4096
  v_smfmac_f32_16x16x64_bf16 v[32:35], v[28:31], a[128:135], v1
  buffer_load_dwordx4 v[64:67], v0, s[4:7], s54 offen sc1
  v_smfmac_f32_16x16x64_bf16 v[40:43], v[28:31], a[136:143], v1
  v_smfmac_f32_16x16x64_bf16 v[36:39], v[28:31], v[56:63], v1
  ds_read_b128 v[56:59], v0 offset:30720
  ds_read_b128 v[60:63], v0 offset:31744
  s_waitcnt lgkmcnt(5)
  v_smfmac_f32_16x16x64_bf16 v[44:47], v[28:31], v[48:55], v1
  ds_read_b128 v[48:51], v0 offset:45056
  ds_read_b128 v[52:55], v0 offset:46080
  ds_read_b128 v[28:31], v0 offset:5120
  v_smfmac_f32_16x16x64_bf16 v[32:35], v[20:23], a[0:7], v1
  buffer_load_dwordx4 v[68:71], v0, s[4:7], s54 offen offset:1024 sc1
  v_smfmac_f32_16x16x64_bf16 v[40:43], v[20:23], a[8:15], v1
  v_smfmac_f32_16x16x64_bf16 v[36:39], v[20:23], a[144:151], v1
  v_smfmac_f32_16x16x64_bf16 v[44:47], v[20:23], a[152:159], v1
  ds_read_b128 v[20:23], v0 offset:1024
  s_waitcnt lgkmcnt(6)
  v_smfmac_f32_16x16x64_bf16 v[32:35], v[24:27], a[64:71], v1
  v_smfmac_f32_16x16x64_bf16 v[40:43], v[24:27], a[72:79], v1
  v_smfmac_f32_16x16x64_bf16 v[36:39], v[24:27], v[72:79], v1
  ds_read_b128 v[72:75], v0 offset:47104
  ds_read_b128 v[76:79], v0 offset:48128
  s_waitcnt lgkmcnt(6)
  v_smfmac_f32_16x16x64_bf16 v[44:47], v[24:27], v[56:63], v1
  ds_read_b128 v[24:27], v0 offset:6144
  buffer_load_dwordx4 v[56:59], v0, s[4:7], s53 offen sc1
  s_waitcnt lgkmcnt(4)
  v_smfmac_f32_16x16x64_bf16 v[32:35], v[28:31], a[80:87], v1
  v_smfmac_f32_16x16x64_bf16 v[40:43], v[28:31], a[88:95], v1
  buffer_load_dwordx4 v[60:63], v0, s[4:7], s53 offen offset:1024 sc1
  v_smfmac_f32_16x16x64_bf16 v[36:39], v[28:31], v[48:55], v1
  ds_read_b128 v[48:51], v0 offset:61440
  ds_read_b128 v[52:55], v0 offset:62464
  s_waitcnt lgkmcnt(3)
  v_smfmac_f32_16x16x64_bf16 v[44:47], v[28:31], v[72:79], v1
  ds_read_b128 v[72:75], v0 offset:63488
  ds_read_b128 v[76:79], v0 offset:64512
  ds_read_b128 v[28:31], v0 offset:2048
  v_smfmac_f32_16x16x64_bf16 v[32:35], v[20:23], a[16:23], v1
  v_smfmac_f32_16x16x64_bf16 v[40:43], v[20:23], a[24:31], v1
  v_smfmac_f32_16x16x64_bf16 v[36:39], v[20:23], a[160:167], v1
  v_smfmac_f32_16x16x64_bf16 v[44:47], v[20:23], a[168:175], v1
  s_waitcnt lgkmcnt(5)
  v_smfmac_f32_16x16x64_bf16 v[32:35], v[24:27], a[96:103], v1
  v_smfmac_f32_16x16x64_bf16 v[40:43], v[24:27], a[104:111], v1
  buffer_load_dword v19, s[4:7], s76 offen sc1 lds
  s_waitcnt lgkmcnt(3)
  v_smfmac_f32_16x16x64_bf16 v[36:39], v[24:27], v[48:55], v1
  s_mov_b64 exec, 3
  buffer_load_dword v16, v19, s[4:7], s69 offen sc1
  s_mov_b64 exec, -1
  s_waitcnt lgkmcnt(1)
  v_mov_b64 v[48:49], 0
  v_smfmac_f32_16x16x64_bf16 v[44:47], v[24:27], v[72:79], v1
  s_waitcnt lgkmcnt(0)
  v_mov_b64 v[50:51], 0
  v_smfmac_f32_16x16x64_bf16 v[32:35], v[28:31], a[32:39], v1
  v_mov_b64 v[52:53], 0
  v_smfmac_f32_16x16x64_bf16 v[36:39], v[28:31], a[176:183], v1
  v_mov_b64 v[54:55], 0
  v_smfmac_f32_16x16x64_bf16 v[40:43], v[28:31], a[40:47], v1
  buffer_store_dwordx4 v[6:9], v0, s[4:7], s68 offen sc1
  v_smfmac_f32_16x16x64_bf16 v[44:47], v[28:31], a[184:191], v1
  ds_read_b128 v[72:75], v0 offset:3072
  ds_read_b128 v[76:79], v0 offset:7168
  v_smfmac_f32_16x16x64_bf16 v[48:51], v[20:23], a[224:231], v1
  v_cvt_pk_bf16_f32 v32, v32, v33
  v_cvt_pk_bf16_f32 v33, v34, v35
  v_cvt_pk_bf16_f32 v34, v36, v37
  v_cvt_pk_bf16_f32 v35, v38, v39
  v_cvt_pk_bf16_f32 v40, v40, v41
  v_cvt_pk_bf16_f32 v41, v42, v43
  v_mfma_f32_16x16x32_bf16 v[36:39], v[32:35], v[2:5], 0
  v_cvt_pk_bf16_f32 v42, v44, v45
  v_cvt_pk_bf16_f32 v43, v46, v47
  s_waitcnt vmcnt(3)
  s_nop 0
  v_mfma_f32_16x16x32_bf16 v[44:47], v[40:43], v[2:5], 0
  v_smfmac_f32_16x16x64_bf16 v[52:55], v[20:23], a[232:239], v1
  ds_read_b128 v[20:23], v0 offset:8192
  v_cvt_pk_bf16_f32 v32, v36, v37
  v_cvt_pk_bf16_f32 v33, v38, v39
  v_smfmac_f32_16x16x64_bf16 v[48:51], v[24:27], v[128:135], v1
  v_cvt_pk_bf16_f32 v34, v44, v45
  v_cvt_pk_bf16_f32 v35, v46, v47
  s_nop 1
  v_mfma_f32_16x16x32_bf16 v[36:39], v[56:59], v[32:35], 0
  v_mfma_f32_16x16x32_bf16 v[40:43], v[60:63], v[32:35], 0
  v_mfma_f32_16x16x32_bf16 v[44:47], v[32:35], v[32:35], 0
  v_smfmac_f32_16x16x64_bf16 v[52:55], v[24:27], v[136:143], v1
  ds_read_b128 v[24:27], v0 offset:0
  v_mov_b32_dpp v36, v40 row_ror:8 row_mask:0xf bank_mask:0xc
  v_mov_b32_dpp v37, v41 row_ror:8 row_mask:0xf bank_mask:0xc
  v_mov_b32_dpp v38, v42 row_ror:8 row_mask:0xf bank_mask:0xc
  v_mov_b32_dpp v39, v43 row_ror:8 row_mask:0xf bank_mask:0xc
  ds_write_b128 v0, v[36:39] offset:13056
  v_mov_b32_dpp v44, v46 row_ror:8 row_mask:0xf bank_mask:0xc
  v_mov_b32_dpp v45, v47 row_ror:8 row_mask:0xf bank_mask:0xc
  s_mov_b32 exec_lo, 0
  ds_write_b64 v12, v[44:45] offset:14080
  s_mov_b64 exec, s[80:81]
  buffer_store_dwordx4 v[32:35], v10, s[4:7], s61 offen offset:1536 sc1
  s_mov_b64 exec, -1
  v_smfmac_f32_16x16x64_bf16 v[48:51], v[28:31], a[240:247], v1
  v_smfmac_f32_16x16x64_bf16 v[52:55], v[28:31], a[248:255], v1
  ds_read_b128 v[28:31], v0 offset:4096
  s_waitcnt lgkmcnt(6)
  v_smfmac_f32_16x16x64_bf16 v[48:51], v[72:75], v[80:87], v1
  v_smfmac_f32_16x16x64_bf16 v[52:55], v[72:75], v[88:95], v1
  ds_read_b128 v[72:75], v0 offset:5120
  s_waitcnt lgkmcnt(2)
  s_barrier
  ds_read_b128 v[40:43], v0 offset:9216
  ds_read_b64 v[56:57], v12 offset:10240
  ds_read_b128 v[44:47], v0 offset:10496
  ds_read_b64 v[58:59], v12 offset:11520
  ds_read_b128 v[32:35], v0 offset:11776
  ds_read_b64 v[60:61], v12 offset:12800
  ds_read_b64 v[62:63], v12 offset:14080
  v_smfmac_f32_16x16x64_bf16 v[48:51], v[76:79], v[144:151], v1
  v_smfmac_f32_16x16x64_bf16 v[52:55], v[76:79], v[152:159], v1
  v_smfmac_f32_16x16x64_bf16 v[48:51], v[20:23], v[160:167], v1
  v_smfmac_f32_16x16x64_bf16 v[52:55], v[20:23], v[168:175], v1
  v_smfmac_f32_16x16x64_bf16 v[48:51], v[24:27], a[208:215], v1
  v_smfmac_f32_16x16x64_bf16 v[52:55], v[24:27], a[216:223], v1
  s_waitcnt lgkmcnt(6)
  v_add_f32 v36, v36, v40
  v_add_f32 v37, v37, v41
  v_add_f32 v38, v38, v42
  v_add_f32 v39, v39, v43
  s_waitcnt lgkmcnt(3)
  v_add_f32 v56, v56, v58
  v_add_f32 v57, v57, v59
  s_waitcnt lgkmcnt(0)
  v_pk_add_f32 v[44:45], v[44:45], v[32:33]
  v_pk_add_f32 v[46:47], v[46:47], v[34:35]
  v_pk_add_f32 v[60:61], v[60:61], v[62:63]
  v_pk_add_f32 v[36:37], v[36:37], v[44:45]
  v_pk_add_f32 v[38:39], v[38:39], v[46:47]
  v_pk_add_f32 v[40:41], v[56:57], v[60:61]
  v_max3_f32 v42, v36, v37, v38
  v_max3_f32 v43, v39, v40, v41
  v_max_f32 v42, v42, v43
  ds_read_b128 v[56:59], v17 offset:45056
  ds_read_b128 v[60:63], v17 offset:46080
  v_max_f32_dpp v42, v42, v42 row_ror:8 row_mask:0xf bank_mask:0xf
  v_mov_b32 v43, v42
  v_smfmac_f32_16x16x64_bf16 v[48:51], v[28:31], v[96:103], v1
  s_nop 0
  v_permlane16_swap_b32 v42, v43
  v_max_f32 v42, v42, v43
  v_mov_b32 v43, v42
  v_smfmac_f32_16x16x64_bf16 v[52:55], v[28:31], v[104:111], v1
  s_nop 0
  v_permlane32_swap_b32 v42, v43
  v_max_f32 v42, v42, v43
  v_mul_f32 v42, s70, v42
  v_fma_f32 v36, v36, s70, -v42
  v_smfmac_f32_16x16x64_bf16 v[48:51], v[72:75], v[112:119], v1
  v_exp_f32 v36, v36
  v_fma_f32 v37, v37, s70, -v42
  v_exp_f32 v37, v37
  v_fma_f32 v38, v38, s70, -v42
  v_smfmac_f32_16x16x64_bf16 v[52:55], v[72:75], v[120:127], v1
  v_exp_f32 v38, v38
  v_fma_f32 v39, v39, s70, -v42
  v_exp_f32 v39, v39
  v_fma_f32 v40, v40, s70, -v42
  v_exp_f32 v40, v40
  v_fma_f32 v41, v41, s70, -v42
  v_exp_f32 v41, v41
  v_cvt_pk_bf16_f32 v44, v36, v37
  v_cvt_pk_bf16_f32 v45, v38, v39
  v_cvt_pk_bf16_f32 v32, v40, v41
  s_cmp_eq_u32 s52, 63
  v_mov_b32_dpp v46, v44 row_ror:8 row_mask:0xf bank_mask:0xf
  v_mov_b32_dpp v47, v45 row_ror:8 row_mask:0xf bank_mask:0xf
  v_add_f32 v40, v40, v41
  v_add_f32 v36, v36, v37
  v_mfma_f32_16x16x32_bf16 v[20:23], v[64:67], v[44:47], 0
  v_mov_b32_dpp v33, v32 row_ror:8 row_mask:0xf bank_mask:0xf
  v_add_f32 v38, v38, v39
  v_mfma_f32_16x16x32_bf16 v[24:27], v[68:71], v[44:47], 0
  v_cvt_pk_bf16_f32 v6, v48, v49
  v_cvt_pk_bf16_f32 v7, v50, v51
  v_fmac_f32 v36, 0.5, v40
  v_add_f32 v36, v36, v38
  v_mfma_f32_16x16x16_bf16 v[20:23], v[6:7], v[32:33], v[20:23]
  v_cvt_pk_bf16_f32 v8, v52, v53
  v_cvt_pk_bf16_f32 v9, v54, v55
  s_cbranch_scc1 L_rec_fin
  v_add_f32_dpp v36, v36, v36 row_ror:8 row_mask:0xf bank_mask:0xf
  v_mfma_f32_16x16x16_bf16 v[24:27], v[8:9], v[32:33], v[24:27]
  v_mov_b32 v37, v36
  v_mov_b64 v[64:65], 0
  v_mov_b64 v[66:67], 0
  v_permlane16_swap_b32 v36, v37
  v_add_f32 v36, v36, v37
  v_mov_b32 v37, v36
  v_mov_b64 v[68:69], 0
  v_mov_b64 v[70:71], 0
  v_permlane32_swap_b32 v36, v37
  v_add_f32 v36, v36, v37
  v_mov_b64 v[52:53], 0
  v_rcp_f32 v36, v36
  v_mov_b64 v[54:55], 0
  s_mov_b64 exec, s[78:79]
  v_pk_mul_f32 v[20:21], v[20:21], v[36:37] op_sel_hi:[1,0]
  v_pk_mul_f32 v[22:23], v[22:23], v[36:37] op_sel_hi:[1,0]
  v_pk_mul_f32 v[24:25], v[24:25], v[36:37] op_sel_hi:[1,0]
  v_pk_mul_f32 v[26:27], v[26:27], v[36:37] op_sel_hi:[1,0]
  v_cvt_pk_bf16_f32 v20, v20, v21
  v_cvt_pk_bf16_f32 v21, v22, v23
  v_cvt_pk_bf16_f32 v22, v24, v25
  v_cvt_pk_bf16_f32 v23, v26, v27
  s_barrier
  ds_write_b128 v10, v[20:23] offset:10752
  s_mov_b64 exec, -1
  ds_read_b128 v[72:75], v17 offset:47104
  ds_read_b128 v[76:79], v17 offset:48128
  ds_read_b128 v[28:31], v17 offset:61440
  ds_read_b128 v[32:35], v17 offset:62464
  s_waitcnt lgkmcnt(4)
  s_barrier
  ds_read_b128 v[20:23], v11 offset:9216
  ds_read_b128 v[24:27], v11 offset:10240
  ds_read_b128 v[36:39], v10 offset:9216
  ds_read_b128 v[40:43], v10 offset:9728
  ds_read_b128 v[44:47], v10 offset:10240
  ds_read_b128 v[48:51], v10 offset:10752
  s_waitcnt lgkmcnt(5)
  v_smfmac_f32_16x16x64_bf16 v[52:55], v[20:23], v[176:183], v1
  s_waitcnt lgkmcnt(4)
  v_smfmac_f32_16x16x64_bf16 v[52:55], v[24:27], v[184:191], v1
  ds_read_b128 v[20:23], v17 offset:63488
  ds_read_b128 v[24:27], v17 offset:64512
  s_waitcnt lgkmcnt(5)
  v_smfmac_f32_16x16x64_bf16 v[64:67], v[36:39], v[56:63], v1
  ds_read_b128 v[56:59], v18 offset:12288
  ds_read_b128 v[60:63], v18 offset:13312
  s_waitcnt lgkmcnt(6)
  v_smfmac_f32_16x16x64_bf16 v[64:67], v[40:43], v[72:79], v1
  ds_read_b128 v[72:75], v18 offset:14336
  ds_read_b128 v[76:79], v18 offset:15360
  s_waitcnt lgkmcnt(7)
  v_permlane32_swap_b32 v52, v54
  v_smfmac_f32_16x16x64_bf16 v[64:67], v[44:47], v[192:199], v1
  s_waitcnt lgkmcnt(6)
  v_permlane32_swap_b32 v53, v55
  v_add_f32 v52, v52, v54
  v_smfmac_f32_16x16x64_bf16 v[64:67], v[48:51], v[200:207], v1
  v_add_f32 v53, v53, v55
  v_cvt_pk_bf16_f32 v52, v52, v53
  v_smfmac_f32_16x16x64_bf16 v[68:71], v[36:39], v[28:35], v1
  ds_read_b128 v[28:31], v18 offset:28672
  ds_read_b128 v[32:35], v18 offset:29696
  s_waitcnt lgkmcnt(6)
  v_bfi_b32 v52, 1, s57, v52
  v_smfmac_f32_16x16x64_bf16 v[68:71], v[40:43], v[20:27], v1
  ds_read_b128 v[20:23], v18 offset:30720
  ds_read_b128 v[24:27], v18 offset:31744
  buffer_store_dword v52, v14, s[4:7], s58 offen
  v_mov_b64 v[54:55], 0
  v_mov_b64 v[52:53], 0
  v_smfmac_f32_16x16x64_bf16 v[68:71], v[44:47], v[208:215], v1
  v_cvt_pk_bf16_f32 v64, v64, v65
  v_cvt_pk_bf16_f32 v65, v66, v67
  v_smfmac_f32_16x16x64_bf16 v[68:71], v[48:51], v[216:223], v1
  s_waitcnt lgkmcnt(6)
  v_bfi_b32 v64, 1, s57, v64
  v_smfmac_f32_16x16x64_bf16 v[52:55], v[36:39], v[56:63], v1
  buffer_store_dwordx2 v[64:65], v13, s[4:7], s72 offen
  s_waitcnt lgkmcnt(4)
  v_mov_b64 v[66:67], 0
  v_smfmac_f32_16x16x64_bf16 v[52:55], v[40:43], v[72:79], v1
  v_mov_b64 v[64:65], 0
  v_smfmac_f32_16x16x64_bf16 v[52:55], v[44:47], v[224:231], v1
  v_cvt_pk_bf16_f32 v68, v68, v69
  v_smfmac_f32_16x16x64_bf16 v[52:55], v[48:51], v[232:239], v1
  s_waitcnt lgkmcnt(2)
  v_cvt_pk_bf16_f32 v69, v70, v71
  v_smfmac_f32_16x16x64_bf16 v[64:67], v[36:39], v[28:35], v1
  s_waitcnt lgkmcnt(0)
  v_bfi_b32 v68, 1, s57, v68
  v_smfmac_f32_16x16x64_bf16 v[64:67], v[40:43], v[20:27], v1
  buffer_store_dwordx2 v[68:69], v13, s[4:7], s73 offen
  v_cvt_pk_bf16_f32 v52, v52, v53
  v_smfmac_f32_16x16x64_bf16 v[64:67], v[44:47], v[240:247], v1
  v_cvt_pk_bf16_f32 v53, v54, v55
  v_smfmac_f32_16x16x64_bf16 v[64:67], v[48:51], v[248:255], v1
  v_bfi_b32 v52, 1, s57, v52
  s_mov_b32 s63, 0
  buffer_store_dwordx2 v[52:53], v13, s[4:7], s74 offen
  s_nop 4
  v_cvt_pk_bf16_f32 v64, v64, v65
  v_cvt_pk_bf16_f32 v65, v66, v67
  v_bfi_b32 v64, 1, s57, v64
  buffer_store_dwordx2 v[64:65], v13, s[4:7], s75 offen
  s_waitcnt vmcnt(7)
  s_barrier
  s_branch L_step_3
L_rec_fin:
  s_lshl_b32 s64, s20, 10
  s_add_u32 s64, s64, s61
  buffer_store_dwordx4 v[6:9], v0, s[4:7], s64 offen offset:2048 sc1
  s_waitcnt vmcnt(0)
  s_barrier
  s_cmp_lg_u32 s20, 0
  s_cbranch_scc1 L_end
  s_mov_b64 exec, 1
  buffer_store_dword v1, v0, s[4:7], s62 offen offset:128 sc1
  buffer_store_dword v1, v0, s[4:7], s62 offen offset:256 sc1
  s_mov_b64 exec, -1
  s_branch L_end
L_worker:
  v_lshlrev_b32 v3, 4, v0
  v_bfe_u32 v20, v0, 4, 1
  v_lshlrev_b32 v20, 2, v20
  v_and_b32 v21, 7, v0
  v_xor_b32 v20, v20, v21
  v_lshlrev_b32 v20, 4, v20
  v_lshrrev_b32 v21, 3, v0
  v_lshl_add_u32 v10, v21, 13, v20
  v_mul_u32_u24 v22, 9216, v21
  v_add_u32 v11, v22, v20
  v_mul_u32_u24 v22, 1152, v21
  v_add_u32 v12, v22, v20
  v_bfe_u32 v20, v0, 2, 2
  v_lshrrev_b32 v21, 5, v0
  v_lshl_add_u32 v22, v21, 3, v20
  v_lshlrev_b32 v22, 7, v22
  v_bfe_u32 v23, v0, 4, 1
  v_lshl_add_u32 v22, v23, 5, v22
  v_and_b32 v23, 3, v0
  v_lshl_add_u32 v22, v23, 3, v22
  v_bfe_u32 v23, v0, 3, 1
  v_lshl_add_u32 v4, v23, 6, v22
  v_xor_b32 v5, 64, v4
  v_add_u32 v6, 0x10000, v4
  v_add_u32 v7, 0x10000, v5
  v_add_u32 v8, 0x20000, v4
  v_add_u32 v9, 0x20000, v5
  v_lshlrev_b32 v23, 9, v21
  v_sub_u32 v13, v4, v23
  v_xor_b32 v14, 64, v13
  v_bfe_u32 v20, v0, 4, 1
  v_lshlrev_b32 v20, 10, v20
  v_lshl_add_u32 v20, v21, 8, v20
  v_and_b32 v22, 15, v0
  v_lshl_add_u32 v2, v22, 4, v20
  s_lshl_b32 s63, s20, 11
  s_and_b32 s52, s21, 15
  s_lshr_b32 s53, s21, 4
  s_mov_b32 s59, 0
  s_getpc_b64 s[92:93]
L_pc:
  s_lshl_b32 s55, s21, 5
  s_add_u32 s92, s92, s55
  s_addc_u32 s93, s93, 0
  s_add_u32 s92, s92, L_sched-L_pc
  s_addc_u32 s93, s93, 0
  s_load_dwordx8 s[84:91], s[92:93], 0
  s_mov_b32 s54, 0
  s_waitcnt lgkmcnt(0)
  s_bfe_u32 s52, s84, 0x80008
L_restart:
  s_mov_b32 s8, s24
  s_and_b32 s9, s25, 0xffff
  s_mov_b32 s10, 0x240000
  s_mov_b32 s11, 0x20000
  v_lshrrev_b32 v20, 4, v0
  v_and_b32 v21, 7, v0
  v_xor_b32 v20, v20, v21
  v_lshrrev_b32 v21, 3, v0
  v_mul_u32_u24 v21, 1152, v21
  v_lshl_add_u32 v22, v20, 4, v21
  v_xor_b32 v20, 4, v20
  v_lshl_add_u32 v23, v20, 4, v21
  s_lshl_b32 s55, s52, 2
  s_add_u32 s55, s55, s20
  s_mul_i32 s55, s55, 36864
  s_mul_i32 s56, s20, 36864
  s_add_u32 m0, s56, 0
  s_add_u32 s57, s55, 0
  buffer_load_dwordx4 v22, s[8:11], s57 offen lds
  s_add_u32 m0, s56, 1024
  s_add_u32 s57, s55, 128
  buffer_load_dwordx4 v22, s[8:11], s57 offen lds
  s_add_u32 m0, s56, 2048
  s_add_u32 s57, s55, 256
  buffer_load_dwordx4 v22, s[8:11], s57 offen lds
  s_add_u32 m0, s56, 3072
  s_add_u32 s57, s55, 384
  buffer_load_dwordx4 v22, s[8:11], s57 offen lds
  s_add_u32 m0, s56, 4096
  s_add_u32 s57, s55, 512
  buffer_load_dwordx4 v22, s[8:11], s57 offen lds
  s_add_u32 m0, s56, 5120
  s_add_u32 s57, s55, 640
  buffer_load_dwordx4 v22, s[8:11], s57 offen lds
  s_add_u32 m0, s56, 6144
  s_add_u32 s57, s55, 768
  buffer_load_dwordx4 v22, s[8:11], s57 offen lds
  s_add_u32 m0, s56, 7168
  s_add_u32 s57, s55, 896
  buffer_load_dwordx4 v22, s[8:11], s57 offen lds
  s_add_u32 m0, s56, 8192
  s_add_u32 s57, s55, 1024
  buffer_load_dwordx4 v22, s[8:11], s57 offen lds
  s_add_u32 m0, s56, 9216
  s_add_u32 s57, s55, 9216
  buffer_load_dwordx4 v23, s[8:11], s57 offen lds
  s_add_u32 m0, s56, 10240
  s_add_u32 s57, s55, 9344
  buffer_load_dwordx4 v23, s[8:11], s57 offen lds
  s_add_u32 m0, s56, 11264
  s_add_u32 s57, s55, 9472
  buffer_load_dwordx4 v23, s[8:11], s57 offen lds
  s_add_u32 m0, s56, 12288
  s_add_u32 s57, s55, 9600
  buffer_load_dwordx4 v23, s[8:11], s57 offen lds
  s_add_u32 m0, s56, 13312
  s_add_u32 s57, s55, 9728
  buffer_load_dwordx4 v23, s[8:11], s57 offen lds
  s_add_u32 m0, s56, 14336
  s_add_u32 s57, s55, 9856
  buffer_load_dwordx4 v23, s[8:11], s57 offen lds
  s_add_u32 m0, s56, 15360
  s_add_u32 s57, s55, 9984
  buffer_load_dwordx4 v23, s[8:11], s57 offen lds
  s_add_u32 m0, s56, 16384
  s_add_u32 s57, s55, 10112
  buffer_load_dwordx4 v23, s[8:11], s57 offen lds
  s_add_u32 m0, s56, 17408
  s_add_u32 s57, s55, 10240
  buffer_load_dwordx4 v23, s[8:11], s57 offen lds
  s_add_u32 m0, s56, 18432
  s_add_u32 s57, s55, 18432
  buffer_load_dwordx4 v22, s[8:11], s57 offen lds
  s_add_u32 m0, s56, 19456
  s_add_u32 s57, s55, 18560
  buffer_load_dwordx4 v22, s[8:11], s57 offen lds
  s_add_u32 m0, s56, 20480
  s_add_u32 s57, s55, 18688
  buffer_load_dwordx4 v22, s[8:11], s57 offen lds
  s_add_u32 m0, s56, 21504
  s_add_u32 s57, s55, 18816
  buffer_load_dwordx4 v22, s[8:11], s57 offen lds
  s_add_u32 m0, s56, 22528
  s_add_u32 s57, s55, 18944
  buffer_load_dwordx4 v22, s[8:11], s57 offen lds
  s_add_u32 m0, s56, 23552
  s_add_u32 s57, s55, 19072
  buffer_load_dwordx4 v22, s[8:11], s57 offen lds
  s_add_u32 m0, s56, 24576
  s_add_u32 s57, s55, 19200
  buffer_load_dwordx4 v22, s[8:11], s57 offen lds
  s_add_u32 m0, s56, 25600
  s_add_u32 s57, s55, 19328
  buffer_load_dwordx4 v22, s[8:11], s57 offen lds
  s_add_u32 m0, s56, 26624
  s_add_u32 s57, s55, 19456
  buffer_load_dwordx4 v22, s[8:11], s57 offen lds
  s_add_u32 m0, s56, 27648
  s_add_u32 s57, s55, 27648
  buffer_load_dwordx4 v23, s[8:11], s57 offen lds
  s_add_u32 m0, s56, 28672
  s_add_u32 s57, s55, 27776
  buffer_load_dwordx4 v23, s[8:11], s57 offen lds
  s_add_u32 m0, s56, 29696
  s_add_u32 s57, s55, 27904
  buffer_load_dwordx4 v23, s[8:11], s57 offen lds
  s_add_u32 m0, s56, 30720
  s_add_u32 s57, s55, 28032
  buffer_load_dwordx4 v23, s[8:11], s57 offen lds
  s_add_u32 m0, s56, 31744
  s_add_u32 s57, s55, 28160
  buffer_load_dwordx4 v23, s[8:11], s57 offen lds
  s_add_u32 m0, s56, 32768
  s_add_u32 s57, s55, 28288
  buffer_load_dwordx4 v23, s[8:11], s57 offen lds
  s_add_u32 m0, s56, 33792
  s_add_u32 s57, s55, 28416
  buffer_load_dwordx4 v23, s[8:11], s57 offen lds
  s_add_u32 m0, s56, 34816
  s_add_u32 s57, s55, 28544
  buffer_load_dwordx4 v23, s[8:11], s57 offen lds
  s_add_u32 m0, s56, 35840
  s_add_u32 s57, s55, 28672
  buffer_load_dwordx4 v23, s[8:11], s57 offen lds
  v_bfe_u32 v20, v0, 3, 2
  v_mul_u32_u24 v24, 9216, v20
  v_and_b32 v21, 7, v0
  v_lshl_add_u32 v24, v21, 7, v24
  v_add_u32 v24, s56, v24
  v_lshrrev_b32 v21, 1, v21
  v_and_b32 v20, 1, v20
  v_lshl_add_u32 v20, v20, 2, v21
  v_lshrrev_b32 v21, 5, v0
  v_xor_b32 v20, v20, v21
  v_xor_b32 v21, 0, v20
  v_lshl_add_u32 v26, v21, 4, v24
  v_xor_b32 v21, 2, v20
  v_lshl_add_u32 v27, v21, 4, v24
  v_xor_b32 v21, 4, v20
  v_lshl_add_u32 v28, v21, 4, v24
  v_xor_b32 v21, 6, v20
  v_lshl_add_u32 v29, v21, 4, v24
  s_waitcnt vmcnt(0)
  ds_read_b128 v[112:115], v26 offset:0
  ds_read_b128 v[116:119], v27 offset:0
  ds_read_b128 v[120:123], v28 offset:0
  ds_read_b128 v[124:127], v29 offset:0
  ds_read_b128 v[128:131], v26 offset:1024
  ds_read_b128 v[132:135], v27 offset:1024
  ds_read_b128 v[136:139], v28 offset:1024
  ds_read_b128 v[140:143], v29 offset:1024
  ds_read_b128 v[144:147], v26 offset:2048
  ds_read_b128 v[148:151], v27 offset:2048
  ds_read_b128 v[152:155], v28 offset:2048
  ds_read_b128 v[156:159], v29 offset:2048
  ds_read_b128 v[160:163], v26 offset:3072
  ds_read_b128 v[164:167], v27 offset:3072
  ds_read_b128 v[168:171], v28 offset:3072
  ds_read_b128 v[172:175], v29 offset:3072
  ds_read_b128 v[176:179], v26 offset:4096
  ds_read_b128 v[180:183], v27 offset:4096
  ds_read_b128 v[184:187], v28 offset:4096
  ds_read_b128 v[188:191], v29 offset:4096
  ds_read_b128 v[192:195], v26 offset:5120
  ds_read_b128 v[196:199], v27 offset:5120
  ds_read_b128 v[200:203], v28 offset:5120
  ds_read_b128 v[204:207], v29 offset:5120
  ds_read_b128 v[208:211], v26 offset:6144
  ds_read_b128 v[212:215], v27 offset:6144
  ds_read_b128 v[216:219], v28 offset:6144
  ds_read_b128 v[220:223], v29 offset:6144
  ds_read_b128 v[224:227], v26 offset:7168
  ds_read_b128 v[228:231], v27 offset:7168
  ds_read_b128 v[232:235], v28 offset:7168
  ds_read_b128 v[236:239], v29 offset:7168
  ds_read_b128 v[240:243], v26 offset:8192
  ds_read_b128 v[244:247], v27 offset:8192
  ds_read_b128 v[248:251], v28 offset:8192
  ds_read_b128 v[252:255], v29 offset:8192
  v_mov_b32 v30, 0x3f803f80
  v_mov_b32 v32, 0
  v_mov_b32 v33, 0
  v_mov_b32 v34, 0
  v_mov_b32 v35, 0
  v_mov_b32 v36, 0
  v_mov_b32 v37, 0
  v_mov_b32 v38, 0
  v_mov_b32 v39, 0
  s_waitcnt lgkmcnt(0)
  s_barrier
  s_mov_b32 s12, s24
  s_and_b32 s13, s25, 0xffff
  s_mov_b32 s14, 0x240000
  s_mov_b32 s15, 0x20000
  v_mov_b32 v1, v10
  s_lshr_b32 m0, s54, 1
  s_and_b32 s56, s54, 1
  s_movrels_b32 s55, s84
  s_lshl_b32 s56, s56, 4
  s_lshr_b32 s55, s55, s56
  s_bfe_u32 s74, s55, 0x80008
  s_and_b32 s55, s55, 255
  s_lshl_b32 s58, s52, 2
  s_add_u32 s58, s58, s20
  s_lshl_b32 s70, s52, 10
  s_add_u32 s70, s70, 0x3204000
  s_cmp_lg_u32 s74, s52
  s_cbranch_scc1 L_up_none_p
  s_cmp_ge_u32 s55, 136
  s_cbranch_scc1 L_up_q_p
  s_cmp_ge_u32 s55, 64
  s_cbranch_scc1 L_up_g_p
  s_and_b32 s68, s55, 1
  s_lshr_b32 s56, s55, 1
  s_cmp_eq_u32 s68, 0
  s_cselect_b32 s8, s30, s32
  s_cselect_b32 s9, s31, s33
  s_lshl_b32 s69, s56, 20
  s_lshl_b32 s57, s58, 14
  s_add_u32 s69, s69, s57
  s_lshl_b32 s57, s68, 13
  s_add_u32 s69, s69, s57
  s_add_u32 s69, s69, 0x400000
  s_lshl_b32 s57, s68, 5
  s_add_u32 s57, s57, s56
  s_branch L_up_qkv_p
L_up_q_p:
  s_sub_u32 s56, s55, 136
  s_mov_b32 s68, 0
  s_mov_b32 s8, s28
  s_mov_b32 s9, s29
  s_lshl_b32 s69, s56, 19
  s_lshl_b32 s57, s58, 13
  s_add_u32 s69, s69, s57
  s_add_u32 s69, s69, 0x4000000
  s_add_u32 s57, s56, 64
L_up_qkv_p:
  s_and_b32 s9, s9, 0xffff
  s_mov_b32 s10, 0x480000
  s_mov_b32 s12, s8
  s_mov_b32 s13, s9
  s_mov_b32 s14, s10
  s_lshl_b32 s60, s56, 8
  s_lshl_b32 s56, s20, 17
  s_add_u32 s60, s60, s56
  s_add_u32 s61, s60, 128
  s_mov_b32 s62, 65536
  v_mov_b32 v1, v10
  s_branch L_up_fin_p
L_up_g_p:
  s_sub_u32 s56, s55, 64
  s_mov_b32 s68, 2
  s_mov_b32 s8, s40
  s_and_b32 s9, s41, 0xffff
  s_mov_b32 s10, 0x510000
  s_mov_b32 s12, s42
  s_and_b32 s13, s43, 0xffff
  s_mov_b32 s14, s10
  s_mul_i32 s69, s58, 294912
  s_lshl_b32 s57, s56, 12
  s_add_u32 s69, s69, s57
  s_add_u32 s69, s69, 0x5000000
  s_lshl_b32 s60, s56, 7
  s_mul_i32 s57, s20, 147456
  s_add_u32 s60, s60, s57
  s_mov_b32 s61, s60
  s_mov_b32 s62, 73728
  v_mov_b32 v1, v11
  s_add_u32 s57, s56, 96
  s_branch L_up_fin_p
L_up_none_p:
  s_mov_b32 s68, 3
  s_mov_b32 s60, 0x40000000
  s_mov_b32 s61, 0x40000000
  s_mov_b32 s62, 0
  s_mov_b32 s57, 255
  s_sub_u32 s54, s54, 1
L_up_fin_p:
  s_lshl_b32 s57, s57, 2
  s_add_u32 s70, s70, s57
  s_lshl_b32 s71, s62, 3
  s_add_u32 s54, s54, 1
  s_add_u32 m0, s63, 0
  s_nop 0
  buffer_load_dwordx4 v1, s[8:11], s60 offen lds
  s_add_u32 m0, s63, 1024
  s_add_u32 s58, s60, s62
  buffer_load_dwordx4 v1, s[8:11], s58 offen lds
  s_add_u32 s60, s60, s71
  s_add_u32 m0, s63, 8192
  s_nop 0
  buffer_load_dwordx4 v1, s[12:15], s61 offen lds
  s_add_u32 m0, s63, 9216
  s_add_u32 s58, s61, s62
  buffer_load_dwordx4 v1, s[12:15], s58 offen lds
  s_add_u32 s61, s61, s71
  s_add_u32 m0, s63, 16384
  s_nop 0
  buffer_load_dwordx4 v1, s[8:11], s60 offen lds
  s_add_u32 m0, s63, 17408
  s_add_u32 s58, s60, s62
  buffer_load_dwordx4 v1, s[8:11], s58 offen lds
  s_add_u32 s60, s60, s71
  s_add_u32 m0, s63, 24576
  s_nop 0
  buffer_load_dwordx4 v1, s[12:15], s61 offen lds
  s_add_u32 m0, s63, 25600
  s_add_u32 s58, s61, s62
  buffer_load_dwordx4 v1, s[12:15], s58 offen lds
  s_add_u32 s61, s61, s71
  s_add_u32 m0, s63, 32768
  s_nop 0
  buffer_load_dwordx4 v1, s[8:11], s60 offen lds
  s_add_u32 m0, s63, 33792
  s_add_u32 s58, s60, s62
  buffer_load_dwordx4 v1, s[8:11], s58 offen lds
  s_add_u32 s60, s60, s71
  s_add_u32 m0, s63, 40960
  s_nop 0
  buffer_load_dwordx4 v1, s[12:15], s61 offen lds
  s_add_u32 m0, s63, 41984
  s_add_u32 s58, s61, s62
  buffer_load_dwordx4 v1, s[12:15], s58 offen lds
  s_add_u32 s61, s61, s71
  s_add_u32 m0, s63, 49152
  s_nop 0
  buffer_load_dwordx4 v1, s[8:11], s60 offen lds
  s_add_u32 m0, s63, 50176
  s_add_u32 s58, s60, s62
  buffer_load_dwordx4 v1, s[8:11], s58 offen lds
  s_add_u32 s60, s60, s71
  s_add_u32 m0, s63, 57344
  s_nop 0
  buffer_load_dwordx4 v1, s[12:15], s61 offen lds
  s_add_u32 m0, s63, 58368
  s_add_u32 s58, s61, s62
  buffer_load_dwordx4 v1, s[12:15], s58 offen lds
  s_add_u32 s61, s61, s71
  s_add_u32 m0, s63, 65536
  s_nop 0
  buffer_load_dwordx4 v1, s[8:11], s60 offen lds
  s_add_u32 m0, s63, 66560
  s_add_u32 s58, s60, s62
  buffer_load_dwordx4 v1, s[8:11], s58 offen lds
  s_add_u32 s60, s60, s71
  s_add_u32 m0, s63, 73728
  s_nop 0
  buffer_load_dwordx4 v1, s[12:15], s61 offen lds
  s_add_u32 m0, s63, 74752
  s_add_u32 s58, s61, s62
  buffer_load_dwordx4 v1, s[12:15], s58 offen lds
  s_add_u32 s61, s61, s71
  s_add_u32 m0, s63, 81920
  s_nop 0
  buffer_load_dwordx4 v1, s[8:11], s60 offen lds
  s_add_u32 m0, s63, 82944
  s_add_u32 s58, s60, s62
  buffer_load_dwordx4 v1, s[8:11], s58 offen lds
  s_add_u32 s60, s60, s71
  s_add_u32 m0, s63, 90112
  s_nop 0
  buffer_load_dwordx4 v1, s[12:15], s61 offen lds
  s_add_u32 m0, s63, 91136
  s_add_u32 s58, s61, s62
  buffer_load_dwordx4 v1, s[12:15], s58 offen lds
  s_add_u32 s61, s61, s71
  s_add_u32 m0, s63, 98304
  s_nop 0
  buffer_load_dwordx4 v1, s[8:11], s60 offen lds
  s_add_u32 m0, s63, 99328
  s_add_u32 s58, s60, s62
  buffer_load_dwordx4 v1, s[8:11], s58 offen lds
  s_add_u32 s60, s60, s71
  s_add_u32 m0, s63, 106496
  s_nop 0
  buffer_load_dwordx4 v1, s[12:15], s61 offen lds
  s_add_u32 m0, s63, 107520
  s_add_u32 s58, s61, s62
  buffer_load_dwordx4 v1, s[12:15], s58 offen lds
  s_add_u32 s61, s61, s71
  s_add_u32 m0, s63, 114688
  s_nop 0
  buffer_load_dwordx4 v1, s[8:11], s60 offen lds
  s_add_u32 m0, s63, 115712
  s_add_u32 s58, s60, s62
  buffer_load_dwordx4 v1, s[8:11], s58 offen lds
  s_add_u32 s60, s60, s71
  s_add_u32 m0, s63, 122880
  s_nop 0
  buffer_load_dwordx4 v1, s[12:15], s61 offen lds
  s_add_u32 m0, s63, 123904
  s_add_u32 s58, s61, s62
  buffer_load_dwordx4 v1, s[12:15], s58 offen lds
  s_add_u32 s61, s61, s71
  v_dot2_f32_bf16 v32, v112, v30, v32
  v_dot2_f32_bf16 v36, v112, v112, v36
  v_dot2_f32_bf16 v33, v113, v30, v33
  v_dot2_f32_bf16 v37, v113, v113, v37
  v_dot2_f32_bf16 v34, v114, v30, v34
  v_dot2_f32_bf16 v38, v114, v114, v38
  v_dot2_f32_bf16 v35, v115, v30, v35
  v_dot2_f32_bf16 v39, v115, v115, v39
  v_dot2_f32_bf16 v32, v116, v30, v32
  v_dot2_f32_bf16 v36, v116, v116, v36
  v_dot2_f32_bf16 v33, v117, v30, v33
  v_dot2_f32_bf16 v37, v117, v117, v37
  v_dot2_f32_bf16 v34, v118, v30, v34
  v_dot2_f32_bf16 v38, v118, v118, v38
  v_dot2_f32_bf16 v35, v119, v30, v35
  v_dot2_f32_bf16 v39, v119, v119, v39
  v_dot2_f32_bf16 v32, v120, v30, v32
  v_dot2_f32_bf16 v36, v120, v120, v36
  v_dot2_f32_bf16 v33, v121, v30, v33
  v_dot2_f32_bf16 v37, v121, v121, v37
  v_dot2_f32_bf16 v34, v122, v30, v34
  v_dot2_f32_bf16 v38, v122, v122, v38
  v_dot2_f32_bf16 v35, v123, v30, v35
  v_dot2_f32_bf16 v39, v123, v123, v39
  v_dot2_f32_bf16 v32, v124, v30, v32
  v_dot2_f32_bf16 v36, v124, v124, v36
  v_dot2_f32_bf16 v33, v125, v30, v33
  v_dot2_f32_bf16 v37, v125, v125, v37
  v_dot2_f32_bf16 v34, v126, v30, v34
  v_dot2_f32_bf16 v38, v126, v126, v38
  v_dot2_f32_bf16 v35, v127, v30, v35
  v_dot2_f32_bf16 v39, v127, v127, v39
  v_dot2_f32_bf16 v32, v128, v30, v32
  v_dot2_f32_bf16 v36, v128, v128, v36
  v_dot2_f32_bf16 v33, v129, v30, v33
  v_dot2_f32_bf16 v37, v129, v129, v37
  v_dot2_f32_bf16 v34, v130, v30, v34
  v_dot2_f32_bf16 v38, v130, v130, v38
  v_dot2_f32_bf16 v35, v131, v30, v35
  v_dot2_f32_bf16 v39, v131, v131, v39
  v_dot2_f32_bf16 v32, v132, v30, v32
  v_dot2_f32_bf16 v36, v132, v132, v36
  v_dot2_f32_bf16 v33, v133, v30, v33
  v_dot2_f32_bf16 v37, v133, v133, v37
  v_dot2_f32_bf16 v34, v134, v30, v34
  v_dot2_f32_bf16 v38, v134, v134, v38
  v_dot2_f32_bf16 v35, v135, v30, v35
  v_dot2_f32_bf16 v39, v135, v135, v39
  v_dot2_f32_bf16 v32, v136, v30, v32
  v_dot2_f32_bf16 v36, v136, v136, v36
  v_dot2_f32_bf16 v33, v137, v30, v33
  v_dot2_f32_bf16 v37, v137, v137, v37
  v_dot2_f32_bf16 v34, v138, v30, v34
  v_dot2_f32_bf16 v38, v138, v138, v38
  v_dot2_f32_bf16 v35, v139, v30, v35
  v_dot2_f32_bf16 v39, v139, v139, v39
  v_dot2_f32_bf16 v32, v140, v30, v32
  v_dot2_f32_bf16 v36, v140, v140, v36
  v_dot2_f32_bf16 v33, v141, v30, v33
  v_dot2_f32_bf16 v37, v141, v141, v37
  v_dot2_f32_bf16 v34, v142, v30, v34
  v_dot2_f32_bf16 v38, v142, v142, v38
  v_dot2_f32_bf16 v35, v143, v30, v35
  v_dot2_f32_bf16 v39, v143, v143, v39
  v_dot2_f32_bf16 v32, v144, v30, v32
  v_dot2_f32_bf16 v36, v144, v144, v36
  v_dot2_f32_bf16 v33, v145, v30, v33
  v_dot2_f32_bf16 v37, v145, v145, v37
  v_dot2_f32_bf16 v34, v146, v30, v34
  v_dot2_f32_bf16 v38, v146, v146, v38
  v_dot2_f32_bf16 v35, v147, v30, v35
  v_dot2_f32_bf16 v39, v147, v147, v39
  v_dot2_f32_bf16 v32, v148, v30, v32
  v_dot2_f32_bf16 v36, v148, v148, v36
  v_dot2_f32_bf16 v33, v149, v30, v33
  v_dot2_f32_bf16 v37, v149, v149, v37
  v_dot2_f32_bf16 v34, v150, v30, v34
  v_dot2_f32_bf16 v38, v150, v150, v38
  v_dot2_f32_bf16 v35, v151, v30, v35
  v_dot2_f32_bf16 v39, v151, v151, v39
  v_dot2_f32_bf16 v32, v152, v30, v32
  v_dot2_f32_bf16 v36, v152, v152, v36
  v_dot2_f32_bf16 v33, v153, v30, v33
  v_dot2_f32_bf16 v37, v153, v153, v37
  v_dot2_f32_bf16 v34, v154, v30, v34
  v_dot2_f32_bf16 v38, v154, v154, v38
  v_dot2_f32_bf16 v35, v155, v30, v35
  v_dot2_f32_bf16 v39, v155, v155, v39
  v_dot2_f32_bf16 v32, v156, v30, v32
  v_dot2_f32_bf16 v36, v156, v156, v36
  v_dot2_f32_bf16 v33, v157, v30, v33
  v_dot2_f32_bf16 v37, v157, v157, v37
  v_dot2_f32_bf16 v34, v158, v30, v34
  v_dot2_f32_bf16 v38, v158, v158, v38
  v_dot2_f32_bf16 v35, v159, v30, v35
  v_dot2_f32_bf16 v39, v159, v159, v39
  v_dot2_f32_bf16 v32, v160, v30, v32
  v_dot2_f32_bf16 v36, v160, v160, v36
  v_dot2_f32_bf16 v33, v161, v30, v33
  v_dot2_f32_bf16 v37, v161, v161, v37
  v_dot2_f32_bf16 v34, v162, v30, v34
  v_dot2_f32_bf16 v38, v162, v162, v38
  v_dot2_f32_bf16 v35, v163, v30, v35
  v_dot2_f32_bf16 v39, v163, v163, v39
  v_dot2_f32_bf16 v32, v164, v30, v32
  v_dot2_f32_bf16 v36, v164, v164, v36
  v_dot2_f32_bf16 v33, v165, v30, v33
  v_dot2_f32_bf16 v37, v165, v165, v37
  v_dot2_f32_bf16 v34, v166, v30, v34
  v_dot2_f32_bf16 v38, v166, v166, v38
  v_dot2_f32_bf16 v35, v167, v30, v35
  v_dot2_f32_bf16 v39, v167, v167, v39
  v_dot2_f32_bf16 v32, v168, v30, v32
  v_dot2_f32_bf16 v36, v168, v168, v36
  v_dot2_f32_bf16 v33, v169, v30, v33
  v_dot2_f32_bf16 v37, v169, v169, v37
  v_dot2_f32_bf16 v34, v170, v30, v34
  v_dot2_f32_bf16 v38, v170, v170, v38
  v_dot2_f32_bf16 v35, v171, v30, v35
  v_dot2_f32_bf16 v39, v171, v171, v39
  v_dot2_f32_bf16 v32, v172, v30, v32
  v_dot2_f32_bf16 v36, v172, v172, v36
  v_dot2_f32_bf16 v33, v173, v30, v33
  v_dot2_f32_bf16 v37, v173, v173, v37
  v_dot2_f32_bf16 v34, v174, v30, v34
  v_dot2_f32_bf16 v38, v174, v174, v38
  v_dot2_f32_bf16 v35, v175, v30, v35
  v_dot2_f32_bf16 v39, v175, v175, v39
  v_dot2_f32_bf16 v32, v176, v30, v32
  v_dot2_f32_bf16 v36, v176, v176, v36
  v_dot2_f32_bf16 v33, v177, v30, v33
  v_dot2_f32_bf16 v37, v177, v177, v37
  v_dot2_f32_bf16 v34, v178, v30, v34
  v_dot2_f32_bf16 v38, v178, v178, v38
  v_dot2_f32_bf16 v35, v179, v30, v35
  v_dot2_f32_bf16 v39, v179, v179, v39
  v_dot2_f32_bf16 v32, v180, v30, v32
  v_dot2_f32_bf16 v36, v180, v180, v36
  v_dot2_f32_bf16 v33, v181, v30, v33
  v_dot2_f32_bf16 v37, v181, v181, v37
  v_dot2_f32_bf16 v34, v182, v30, v34
  v_dot2_f32_bf16 v38, v182, v182, v38
  v_dot2_f32_bf16 v35, v183, v30, v35
  v_dot2_f32_bf16 v39, v183, v183, v39
  v_dot2_f32_bf16 v32, v184, v30, v32
  v_dot2_f32_bf16 v36, v184, v184, v36
  v_dot2_f32_bf16 v33, v185, v30, v33
  v_dot2_f32_bf16 v37, v185, v185, v37
  v_dot2_f32_bf16 v34, v186, v30, v34
  v_dot2_f32_bf16 v38, v186, v186, v38
  v_dot2_f32_bf16 v35, v187, v30, v35
  v_dot2_f32_bf16 v39, v187, v187, v39
  v_dot2_f32_bf16 v32, v188, v30, v32
  v_dot2_f32_bf16 v36, v188, v188, v36
  v_dot2_f32_bf16 v33, v189, v30, v33
  v_dot2_f32_bf16 v37, v189, v189, v37
  v_dot2_f32_bf16 v34, v190, v30, v34
  v_dot2_f32_bf16 v38, v190, v190, v38
  v_dot2_f32_bf16 v35, v191, v30, v35
  v_dot2_f32_bf16 v39, v191, v191, v39
  v_dot2_f32_bf16 v32, v192, v30, v32
  v_dot2_f32_bf16 v36, v192, v192, v36
  v_dot2_f32_bf16 v33, v193, v30, v33
  v_dot2_f32_bf16 v37, v193, v193, v37
  v_dot2_f32_bf16 v34, v194, v30, v34
  v_dot2_f32_bf16 v38, v194, v194, v38
  v_dot2_f32_bf16 v35, v195, v30, v35
  v_dot2_f32_bf16 v39, v195, v195, v39
  v_dot2_f32_bf16 v32, v196, v30, v32
  v_dot2_f32_bf16 v36, v196, v196, v36
  v_dot2_f32_bf16 v33, v197, v30, v33
  v_dot2_f32_bf16 v37, v197, v197, v37
  v_dot2_f32_bf16 v34, v198, v30, v34
  v_dot2_f32_bf16 v38, v198, v198, v38
  v_dot2_f32_bf16 v35, v199, v30, v35
  v_dot2_f32_bf16 v39, v199, v199, v39
  v_dot2_f32_bf16 v32, v200, v30, v32
  v_dot2_f32_bf16 v36, v200, v200, v36
  v_dot2_f32_bf16 v33, v201, v30, v33
  v_dot2_f32_bf16 v37, v201, v201, v37
  v_dot2_f32_bf16 v34, v202, v30, v34
  v_dot2_f32_bf16 v38, v202, v202, v38
  v_dot2_f32_bf16 v35, v203, v30, v35
  v_dot2_f32_bf16 v39, v203, v203, v39
  v_dot2_f32_bf16 v32, v204, v30, v32
  v_dot2_f32_bf16 v36, v204, v204, v36
  v_dot2_f32_bf16 v33, v205, v30, v33
  v_dot2_f32_bf16 v37, v205, v205, v37
  v_dot2_f32_bf16 v34, v206, v30, v34
  v_dot2_f32_bf16 v38, v206, v206, v38
  v_dot2_f32_bf16 v35, v207, v30, v35
  v_dot2_f32_bf16 v39, v207, v207, v39
  v_dot2_f32_bf16 v32, v208, v30, v32
  v_dot2_f32_bf16 v36, v208, v208, v36
  v_dot2_f32_bf16 v33, v209, v30, v33
  v_dot2_f32_bf16 v37, v209, v209, v37
  v_dot2_f32_bf16 v34, v210, v30, v34
  v_dot2_f32_bf16 v38, v210, v210, v38
  v_dot2_f32_bf16 v35, v211, v30, v35
  v_dot2_f32_bf16 v39, v211, v211, v39
  v_dot2_f32_bf16 v32, v212, v30, v32
  v_dot2_f32_bf16 v36, v212, v212, v36
  v_dot2_f32_bf16 v33, v213, v30, v33
  v_dot2_f32_bf16 v37, v213, v213, v37
  v_dot2_f32_bf16 v34, v214, v30, v34
  v_dot2_f32_bf16 v38, v214, v214, v38
  v_dot2_f32_bf16 v35, v215, v30, v35
  v_dot2_f32_bf16 v39, v215, v215, v39
  v_dot2_f32_bf16 v32, v216, v30, v32
  v_dot2_f32_bf16 v36, v216, v216, v36
  v_dot2_f32_bf16 v33, v217, v30, v33
  v_dot2_f32_bf16 v37, v217, v217, v37
  v_dot2_f32_bf16 v34, v218, v30, v34
  v_dot2_f32_bf16 v38, v218, v218, v38
  v_dot2_f32_bf16 v35, v219, v30, v35
  v_dot2_f32_bf16 v39, v219, v219, v39
  v_dot2_f32_bf16 v32, v220, v30, v32
  v_dot2_f32_bf16 v36, v220, v220, v36
  v_dot2_f32_bf16 v33, v221, v30, v33
  v_dot2_f32_bf16 v37, v221, v221, v37
  v_dot2_f32_bf16 v34, v222, v30, v34
  v_dot2_f32_bf16 v38, v222, v222, v38
  v_dot2_f32_bf16 v35, v223, v30, v35
  v_dot2_f32_bf16 v39, v223, v223, v39
  v_dot2_f32_bf16 v32, v224, v30, v32
  v_dot2_f32_bf16 v36, v224, v224, v36
  v_dot2_f32_bf16 v33, v225, v30, v33
  v_dot2_f32_bf16 v37, v225, v225, v37
  v_dot2_f32_bf16 v34, v226, v30, v34
  v_dot2_f32_bf16 v38, v226, v226, v38
  v_dot2_f32_bf16 v35, v227, v30, v35
  v_dot2_f32_bf16 v39, v227, v227, v39
  v_dot2_f32_bf16 v32, v228, v30, v32
  v_dot2_f32_bf16 v36, v228, v228, v36
  v_dot2_f32_bf16 v33, v229, v30, v33
  v_dot2_f32_bf16 v37, v229, v229, v37
  v_dot2_f32_bf16 v34, v230, v30, v34
  v_dot2_f32_bf16 v38, v230, v230, v38
  v_dot2_f32_bf16 v35, v231, v30, v35
  v_dot2_f32_bf16 v39, v231, v231, v39
  v_dot2_f32_bf16 v32, v232, v30, v32
  v_dot2_f32_bf16 v36, v232, v232, v36
  v_dot2_f32_bf16 v33, v233, v30, v33
  v_dot2_f32_bf16 v37, v233, v233, v37
  v_dot2_f32_bf16 v34, v234, v30, v34
  v_dot2_f32_bf16 v38, v234, v234, v38
  v_dot2_f32_bf16 v35, v235, v30, v35
  v_dot2_f32_bf16 v39, v235, v235, v39
  v_dot2_f32_bf16 v32, v236, v30, v32
  v_dot2_f32_bf16 v36, v236, v236, v36
  v_dot2_f32_bf16 v33, v237, v30, v33
  v_dot2_f32_bf16 v37, v237, v237, v37
  v_dot2_f32_bf16 v34, v238, v30, v34
  v_dot2_f32_bf16 v38, v238, v238, v38
  v_dot2_f32_bf16 v35, v239, v30, v35
  v_dot2_f32_bf16 v39, v239, v239, v39
  v_dot2_f32_bf16 v32, v240, v30, v32
  v_dot2_f32_bf16 v36, v240, v240, v36
  v_dot2_f32_bf16 v33, v241, v30, v33
  v_dot2_f32_bf16 v37, v241, v241, v37
  v_dot2_f32_bf16 v34, v242, v30, v34
  v_dot2_f32_bf16 v38, v242, v242, v38
  v_dot2_f32_bf16 v35, v243, v30, v35
  v_dot2_f32_bf16 v39, v243, v243, v39
  v_dot2_f32_bf16 v32, v244, v30, v32
  v_dot2_f32_bf16 v36, v244, v244, v36
  v_dot2_f32_bf16 v33, v245, v30, v33
  v_dot2_f32_bf16 v37, v245, v245, v37
  v_dot2_f32_bf16 v34, v246, v30, v34
  v_dot2_f32_bf16 v38, v246, v246, v38
  v_dot2_f32_bf16 v35, v247, v30, v35
  v_dot2_f32_bf16 v39, v247, v247, v39
  v_dot2_f32_bf16 v32, v248, v30, v32
  v_dot2_f32_bf16 v36, v248, v248, v36
  v_dot2_f32_bf16 v33, v249, v30, v33
  v_dot2_f32_bf16 v37, v249, v249, v37
  v_dot2_f32_bf16 v34, v250, v30, v34
  v_dot2_f32_bf16 v38, v250, v250, v38
  v_dot2_f32_bf16 v35, v251, v30, v35
  v_dot2_f32_bf16 v39, v251, v251, v39
  v_dot2_f32_bf16 v32, v252, v30, v32
  v_dot2_f32_bf16 v36, v252, v252, v36
  v_dot2_f32_bf16 v33, v253, v30, v33
  v_dot2_f32_bf16 v37, v253, v253, v37
  v_dot2_f32_bf16 v34, v254, v30, v34
  v_dot2_f32_bf16 v38, v254, v254, v38
  v_dot2_f32_bf16 v35, v255, v30, v35
  v_dot2_f32_bf16 v39, v255, v255, v39
  s_nop 2
  v_add_f32 v32, v32, v33
  v_add_f32 v34, v34, v35
  v_add_f32 v32, v32, v34
  v_mov_b32 v33, v32
  s_nop 1
  v_permlane32_swap_b32 v32, v33
  v_add_f32 v32, v32, v33
  v_add_f32 v36, v36, v37
  v_add_f32 v38, v38, v39
  v_add_f32 v36, v36, v38
  v_mov_b32 v37, v36
  s_nop 1
  v_permlane32_swap_b32 v36, v37
  v_add_f32 v36, v36, v37
  v_mul_f32 v32, 0x3ae38e39, v32
  v_mul_f32 v36, 0x3ae38e39, v36
  v_fma_f32 v36, -v32, v32, v36
  v_max_f32 v36, 0, v36
  v_add_f32 v36, 0x3727c5ac, v36
  v_rsq_f32 v36, v36
  s_mov_b32 s55, 0xffff0000
  v_mul_f32 v32, v32, v36
  v_lshlrev_b32 v40, 16, v112
  v_and_b32 v41, s55, v112
  v_pk_fma_f32 v[40:41], v[40:41], v[36:37], v[32:33] op_sel_hi:[1,0,0] neg_lo:[0,0,1] neg_hi:[0,0,1]
  v_cvt_pk_bf16_f32 v40, v40, v41
  v_accvgpr_write_b32 a0, v40
  v_lshlrev_b32 v42, 16, v113
  v_and_b32 v43, s55, v113
  v_pk_fma_f32 v[42:43], v[42:43], v[36:37], v[32:33] op_sel_hi:[1,0,0] neg_lo:[0,0,1] neg_hi:[0,0,1]
  v_cvt_pk_bf16_f32 v42, v42, v43
  v_accvgpr_write_b32 a1, v42
  v_lshlrev_b32 v44, 16, v114
  v_and_b32 v45, s55, v114
  v_pk_fma_f32 v[44:45], v[44:45], v[36:37], v[32:33] op_sel_hi:[1,0,0] neg_lo:[0,0,1] neg_hi:[0,0,1]
  v_cvt_pk_bf16_f32 v44, v44, v45
  v_accvgpr_write_b32 a2, v44
  v_lshlrev_b32 v46, 16, v115
  v_and_b32 v47, s55, v115
  v_pk_fma_f32 v[46:47], v[46:47], v[36:37], v[32:33] op_sel_hi:[1,0,0] neg_lo:[0,0,1] neg_hi:[0,0,1]
  v_cvt_pk_bf16_f32 v46, v46, v47
  v_accvgpr_write_b32 a3, v46
  v_lshlrev_b32 v40, 16, v116
  v_and_b32 v41, s55, v116
  v_pk_fma_f32 v[40:41], v[40:41], v[36:37], v[32:33] op_sel_hi:[1,0,0] neg_lo:[0,0,1] neg_hi:[0,0,1]
  v_cvt_pk_bf16_f32 v40, v40, v41
  v_accvgpr_write_b32 a4, v40
  v_lshlrev_b32 v42, 16, v117
  v_and_b32 v43, s55, v117
  v_pk_fma_f32 v[42:43], v[42:43], v[36:37], v[32:33] op_sel_hi:[1,0,0] neg_lo:[0,0,1] neg_hi:[0,0,1]
  v_cvt_pk_bf16_f32 v42, v42, v43
  v_accvgpr_write_b32 a5, v42
  v_lshlrev_b32 v44, 16, v118
  v_and_b32 v45, s55, v118
  v_pk_fma_f32 v[44:45], v[44:45], v[36:37], v[32:33] op_sel_hi:[1,0,0] neg_lo:[0,0,1] neg_hi:[0,0,1]
  v_cvt_pk_bf16_f32 v44, v44, v45
  v_accvgpr_write_b32 a6, v44
  v_lshlrev_b32 v46, 16, v119
  v_and_b32 v47, s55, v119
  v_pk_fma_f32 v[46:47], v[46:47], v[36:37], v[32:33] op_sel_hi:[1,0,0] neg_lo:[0,0,1] neg_hi:[0,0,1]
  v_cvt_pk_bf16_f32 v46, v46, v47
  v_accvgpr_write_b32 a7, v46
  v_lshlrev_b32 v40, 16, v120
  v_and_b32 v41, s55, v120
  v_pk_fma_f32 v[40:41], v[40:41], v[36:37], v[32:33] op_sel_hi:[1,0,0] neg_lo:[0,0,1] neg_hi:[0,0,1]
  v_cvt_pk_bf16_f32 v40, v40, v41
  v_accvgpr_write_b32 a8, v40
  v_lshlrev_b32 v42, 16, v121
  v_and_b32 v43, s55, v121
  v_pk_fma_f32 v[42:43], v[42:43], v[36:37], v[32:33] op_sel_hi:[1,0,0] neg_lo:[0,0,1] neg_hi:[0,0,1]
  v_cvt_pk_bf16_f32 v42, v42, v43
  v_accvgpr_write_b32 a9, v42
  v_lshlrev_b32 v44, 16, v122
  v_and_b32 v45, s55, v122
  v_pk_fma_f32 v[44:45], v[44:45], v[36:37], v[32:33] op_sel_hi:[1,0,0] neg_lo:[0,0,1] neg_hi:[0,0,1]
  v_cvt_pk_bf16_f32 v44, v44, v45
  v_accvgpr_write_b32 a10, v44
  v_lshlrev_b32 v46, 16, v123
  v_and_b32 v47, s55, v123
  v_pk_fma_f32 v[46:47], v[46:47], v[36:37], v[32:33] op_sel_hi:[1,0,0] neg_lo:[0,0,1] neg_hi:[0,0,1]
  v_cvt_pk_bf16_f32 v46, v46, v47
  v_accvgpr_write_b32 a11, v46
  v_lshlrev_b32 v40, 16, v124
  v_and_b32 v41, s55, v124
  v_pk_fma_f32 v[40:41], v[40:41], v[36:37], v[32:33] op_sel_hi:[1,0,0] neg_lo:[0,0,1] neg_hi:[0,0,1]
  v_cvt_pk_bf16_f32 v40, v40, v41
  v_accvgpr_write_b32 a12, v40
  v_lshlrev_b32 v42, 16, v125
  v_and_b32 v43, s55, v125
  v_pk_fma_f32 v[42:43], v[42:43], v[36:37], v[32:33] op_sel_hi:[1,0,0] neg_lo:[0,0,1] neg_hi:[0,0,1]
  v_cvt_pk_bf16_f32 v42, v42, v43
  v_accvgpr_write_b32 a13, v42
  v_lshlrev_b32 v44, 16, v126
  v_and_b32 v45, s55, v126
  v_pk_fma_f32 v[44:45], v[44:45], v[36:37], v[32:33] op_sel_hi:[1,0,0] neg_lo:[0,0,1] neg_hi:[0,0,1]
  v_cvt_pk_bf16_f32 v44, v44, v45
  v_accvgpr_write_b32 a14, v44
  v_lshlrev_b32 v46, 16, v127
  v_and_b32 v47, s55, v127
  v_pk_fma_f32 v[46:47], v[46:47], v[36:37], v[32:33] op_sel_hi:[1,0,0] neg_lo:[0,0,1] neg_hi:[0,0,1]
  v_cvt_pk_bf16_f32 v46, v46, v47
  v_accvgpr_write_b32 a15, v46
  v_lshlrev_b32 v40, 16, v128
  v_and_b32 v41, s55, v128
  v_pk_fma_f32 v[40:41], v[40:41], v[36:37], v[32:33] op_sel_hi:[1,0,0] neg_lo:[0,0,1] neg_hi:[0,0,1]
  v_cvt_pk_bf16_f32 v40, v40, v41
  v_accvgpr_write_b32 a16, v40
  v_lshlrev_b32 v42, 16, v129
  v_and_b32 v43, s55, v129
  v_pk_fma_f32 v[42:43], v[42:43], v[36:37], v[32:33] op_sel_hi:[1,0,0] neg_lo:[0,0,1] neg_hi:[0,0,1]
  v_cvt_pk_bf16_f32 v42, v42, v43
  v_accvgpr_write_b32 a17, v42
  v_lshlrev_b32 v44, 16, v130
  v_and_b32 v45, s55, v130
  v_pk_fma_f32 v[44:45], v[44:45], v[36:37], v[32:33] op_sel_hi:[1,0,0] neg_lo:[0,0,1] neg_hi:[0,0,1]
  v_cvt_pk_bf16_f32 v44, v44, v45
  v_accvgpr_write_b32 a18, v44
  v_lshlrev_b32 v46, 16, v131
  v_and_b32 v47, s55, v131
  v_pk_fma_f32 v[46:47], v[46:47], v[36:37], v[32:33] op_sel_hi:[1,0,0] neg_lo:[0,0,1] neg_hi:[0,0,1]
  v_cvt_pk_bf16_f32 v46, v46, v47
  v_accvgpr_write_b32 a19, v46
  v_lshlrev_b32 v40, 16, v132
  v_and_b32 v41, s55, v132
  v_pk_fma_f32 v[40:41], v[40:41], v[36:37], v[32:33] op_sel_hi:[1,0,0] neg_lo:[0,0,1] neg_hi:[0,0,1]
  v_cvt_pk_bf16_f32 v40, v40, v41
  v_accvgpr_write_b32 a20, v40
  v_lshlrev_b32 v42, 16, v133
  v_and_b32 v43, s55, v133
  v_pk_fma_f32 v[42:43], v[42:43], v[36:37], v[32:33] op_sel_hi:[1,0,0] neg_lo:[0,0,1] neg_hi:[0,0,1]
  v_cvt_pk_bf16_f32 v42, v42, v43
  v_accvgpr_write_b32 a21, v42
  v_lshlrev_b32 v44, 16, v134
  v_and_b32 v45, s55, v134
  v_pk_fma_f32 v[44:45], v[44:45], v[36:37], v[32:33] op_sel_hi:[1,0,0] neg_lo:[0,0,1] neg_hi:[0,0,1]
  v_cvt_pk_bf16_f32 v44, v44, v45
  v_accvgpr_write_b32 a22, v44
  v_lshlrev_b32 v46, 16, v135
  v_and_b32 v47, s55, v135
  v_pk_fma_f32 v[46:47], v[46:47], v[36:37], v[32:33] op_sel_hi:[1,0,0] neg_lo:[0,0,1] neg_hi:[0,0,1]
  v_cvt_pk_bf16_f32 v46, v46, v47
  v_accvgpr_write_b32 a23, v46
  v_lshlrev_b32 v40, 16, v136
  v_and_b32 v41, s55, v136
  v_pk_fma_f32 v[40:41], v[40:41], v[36:37], v[32:33] op_sel_hi:[1,0,0] neg_lo:[0,0,1] neg_hi:[0,0,1]
  v_cvt_pk_bf16_f32 v40, v40, v41
  v_accvgpr_write_b32 a24, v40
  v_lshlrev_b32 v42, 16, v137
  v_and_b32 v43, s55, v137
  v_pk_fma_f32 v[42:43], v[42:43], v[36:37], v[32:33] op_sel_hi:[1,0,0] neg_lo:[0,0,1] neg_hi:[0,0,1]
  v_cvt_pk_bf16_f32 v42, v42, v43
  v_accvgpr_write_b32 a25, v42
  v_lshlrev_b32 v44, 16, v138
  v_and_b32 v45, s55, v138
  v_pk_fma_f32 v[44:45], v[44:45], v[36:37], v[32:33] op_sel_hi:[1,0,0] neg_lo:[0,0,1] neg_hi:[0,0,1]
  v_cvt_pk_bf16_f32 v44, v44, v45
  v_accvgpr_write_b32 a26, v44
  v_lshlrev_b32 v46, 16, v139
  v_and_b32 v47, s55, v139
  v_pk_fma_f32 v[46:47], v[46:47], v[36:37], v[32:33] op_sel_hi:[1,0,0] neg_lo:[0,0,1] neg_hi:[0,0,1]
  v_cvt_pk_bf16_f32 v46, v46, v47
  v_accvgpr_write_b32 a27, v46
  v_lshlrev_b32 v40, 16, v140
  v_and_b32 v41, s55, v140
  v_pk_fma_f32 v[40:41], v[40:41], v[36:37], v[32:33] op_sel_hi:[1,0,0] neg_lo:[0,0,1] neg_hi:[0,0,1]
  v_cvt_pk_bf16_f32 v40, v40, v41
  v_accvgpr_write_b32 a28, v40
  v_lshlrev_b32 v42, 16, v141
  v_and_b32 v43, s55, v141
  v_pk_fma_f32 v[42:43], v[42:43], v[36:37], v[32:33] op_sel_hi:[1,0,0] neg_lo:[0,0,1] neg_hi:[0,0,1]
  v_cvt_pk_bf16_f32 v42, v42, v43
  v_accvgpr_write_b32 a29, v42
  v_lshlrev_b32 v44, 16, v142
  v_and_b32 v45, s55, v142
  v_pk_fma_f32 v[44:45], v[44:45], v[36:37], v[32:33] op_sel_hi:[1,0,0] neg_lo:[0,0,1] neg_hi:[0,0,1]
  v_cvt_pk_bf16_f32 v44, v44, v45
  v_accvgpr_write_b32 a30, v44
  v_lshlrev_b32 v46, 16, v143
  v_and_b32 v47, s55, v143
  v_pk_fma_f32 v[46:47], v[46:47], v[36:37], v[32:33] op_sel_hi:[1,0,0] neg_lo:[0,0,1] neg_hi:[0,0,1]
  v_cvt_pk_bf16_f32 v46, v46, v47
  v_accvgpr_write_b32 a31, v46
  v_lshlrev_b32 v40, 16, v144
  v_and_b32 v41, s55, v144
  v_pk_fma_f32 v[40:41], v[40:41], v[36:37], v[32:33] op_sel_hi:[1,0,0] neg_lo:[0,0,1] neg_hi:[0,0,1]
  v_cvt_pk_bf16_f32 v40, v40, v41
  v_accvgpr_write_b32 a32, v40
  v_lshlrev_b32 v42, 16, v145
  v_and_b32 v43, s55, v145
  v_pk_fma_f32 v[42:43], v[42:43], v[36:37], v[32:33] op_sel_hi:[1,0,0] neg_lo:[0,0,1] neg_hi:[0,0,1]
  v_cvt_pk_bf16_f32 v42, v42, v43
  v_accvgpr_write_b32 a33, v42
  v_lshlrev_b32 v44, 16, v146
  v_and_b32 v45, s55, v146
  v_pk_fma_f32 v[44:45], v[44:45], v[36:37], v[32:33] op_sel_hi:[1,0,0] neg_lo:[0,0,1] neg_hi:[0,0,1]
  v_cvt_pk_bf16_f32 v44, v44, v45
  v_accvgpr_write_b32 a34, v44
  v_lshlrev_b32 v46, 16, v147
  v_and_b32 v47, s55, v147
  v_pk_fma_f32 v[46:47], v[46:47], v[36:37], v[32:33] op_sel_hi:[1,0,0] neg_lo:[0,0,1] neg_hi:[0,0,1]
  v_cvt_pk_bf16_f32 v46, v46, v47
  v_accvgpr_write_b32 a35, v46
  v_lshlrev_b32 v40, 16, v148
  v_and_b32 v41, s55, v148
  v_pk_fma_f32 v[40:41], v[40:41], v[36:37], v[32:33] op_sel_hi:[1,0,0] neg_lo:[0,0,1] neg_hi:[0,0,1]
  v_cvt_pk_bf16_f32 v40, v40, v41
  v_accvgpr_write_b32 a36, v40
  v_lshlrev_b32 v42, 16, v149
  v_and_b32 v43, s55, v149
  v_pk_fma_f32 v[42:43], v[42:43], v[36:37], v[32:33] op_sel_hi:[1,0,0] neg_lo:[0,0,1] neg_hi:[0,0,1]
  v_cvt_pk_bf16_f32 v42, v42, v43
  v_accvgpr_write_b32 a37, v42
  v_lshlrev_b32 v44, 16, v150
  v_and_b32 v45, s55, v150
  v_pk_fma_f32 v[44:45], v[44:45], v[36:37], v[32:33] op_sel_hi:[1,0,0] neg_lo:[0,0,1] neg_hi:[0,0,1]
  v_cvt_pk_bf16_f32 v44, v44, v45
  v_accvgpr_write_b32 a38, v44
  v_lshlrev_b32 v46, 16, v151
  v_and_b32 v47, s55, v151
  v_pk_fma_f32 v[46:47], v[46:47], v[36:37], v[32:33] op_sel_hi:[1,0,0] neg_lo:[0,0,1] neg_hi:[0,0,1]
  v_cvt_pk_bf16_f32 v46, v46, v47
  v_accvgpr_write_b32 a39, v46
  v_lshlrev_b32 v40, 16, v152
  v_and_b32 v41, s55, v152
  v_pk_fma_f32 v[40:41], v[40:41], v[36:37], v[32:33] op_sel_hi:[1,0,0] neg_lo:[0,0,1] neg_hi:[0,0,1]
  v_cvt_pk_bf16_f32 v40, v40, v41
  v_accvgpr_write_b32 a40, v40
  v_lshlrev_b32 v42, 16, v153
  v_and_b32 v43, s55, v153
  v_pk_fma_f32 v[42:43], v[42:43], v[36:37], v[32:33] op_sel_hi:[1,0,0] neg_lo:[0,0,1] neg_hi:[0,0,1]
  v_cvt_pk_bf16_f32 v42, v42, v43
  v_accvgpr_write_b32 a41, v42
  v_lshlrev_b32 v44, 16, v154
  v_and_b32 v45, s55, v154
  v_pk_fma_f32 v[44:45], v[44:45], v[36:37], v[32:33] op_sel_hi:[1,0,0] neg_lo:[0,0,1] neg_hi:[0,0,1]
  v_cvt_pk_bf16_f32 v44, v44, v45
  v_accvgpr_write_b32 a42, v44
  v_lshlrev_b32 v46, 16, v155
  v_and_b32 v47, s55, v155
  v_pk_fma_f32 v[46:47], v[46:47], v[36:37], v[32:33] op_sel_hi:[1,0,0] neg_lo:[0,0,1] neg_hi:[0,0,1]
  v_cvt_pk_bf16_f32 v46, v46, v47
  v_accvgpr_write_b32 a43, v46
  v_lshlrev_b32 v40, 16, v156
  v_and_b32 v41, s55, v156
  v_pk_fma_f32 v[40:41], v[40:41], v[36:37], v[32:33] op_sel_hi:[1,0,0] neg_lo:[0,0,1] neg_hi:[0,0,1]
  v_cvt_pk_bf16_f32 v40, v40, v41
  v_accvgpr_write_b32 a44, v40
  v_lshlrev_b32 v42, 16, v157
  v_and_b32 v43, s55, v157
  v_pk_fma_f32 v[42:43], v[42:43], v[36:37], v[32:33] op_sel_hi:[1,0,0] neg_lo:[0,0,1] neg_hi:[0,0,1]
  v_cvt_pk_bf16_f32 v42, v42, v43
  v_accvgpr_write_b32 a45, v42
  v_lshlrev_b32 v44, 16, v158
  v_and_b32 v45, s55, v158
  v_pk_fma_f32 v[44:45], v[44:45], v[36:37], v[32:33] op_sel_hi:[1,0,0] neg_lo:[0,0,1] neg_hi:[0,0,1]
  v_cvt_pk_bf16_f32 v44, v44, v45
  v_accvgpr_write_b32 a46, v44
  v_lshlrev_b32 v46, 16, v159
  v_and_b32 v47, s55, v159
  v_pk_fma_f32 v[46:47], v[46:47], v[36:37], v[32:33] op_sel_hi:[1,0,0] neg_lo:[0,0,1] neg_hi:[0,0,1]
  v_cvt_pk_bf16_f32 v46, v46, v47
  v_accvgpr_write_b32 a47, v46
  v_lshlrev_b32 v40, 16, v160
  v_and_b32 v41, s55, v160
  v_pk_fma_f32 v[40:41], v[40:41], v[36:37], v[32:33] op_sel_hi:[1,0,0] neg_lo:[0,0,1] neg_hi:[0,0,1]
  v_cvt_pk_bf16_f32 v40, v40, v41
  v_accvgpr_write_b32 a48, v40
  v_lshlrev_b32 v42, 16, v161
  v_and_b32 v43, s55, v161
  v_pk_fma_f32 v[42:43], v[42:43], v[36:37], v[32:33] op_sel_hi:[1,0,0] neg_lo:[0,0,1] neg_hi:[0,0,1]
  v_cvt_pk_bf16_f32 v42, v42, v43
  v_accvgpr_write_b32 a49, v42
  v_lshlrev_b32 v44, 16, v162
  v_and_b32 v45, s55, v162
  v_pk_fma_f32 v[44:45], v[44:45], v[36:37], v[32:33] op_sel_hi:[1,0,0] neg_lo:[0,0,1] neg_hi:[0,0,1]
  v_cvt_pk_bf16_f32 v44, v44, v45
  v_accvgpr_write_b32 a50, v44
  v_lshlrev_b32 v46, 16, v163
  v_and_b32 v47, s55, v163
  v_pk_fma_f32 v[46:47], v[46:47], v[36:37], v[32:33] op_sel_hi:[1,0,0] neg_lo:[0,0,1] neg_hi:[0,0,1]
  v_cvt_pk_bf16_f32 v46, v46, v47
  v_accvgpr_write_b32 a51, v46
  v_lshlrev_b32 v40, 16, v164
  v_and_b32 v41, s55, v164
  v_pk_fma_f32 v[40:41], v[40:41], v[36:37], v[32:33] op_sel_hi:[1,0,0] neg_lo:[0,0,1] neg_hi:[0,0,1]
  v_cvt_pk_bf16_f32 v40, v40, v41
  v_accvgpr_write_b32 a52, v40
  v_lshlrev_b32 v42, 16, v165
  v_and_b32 v43, s55, v165
  v_pk_fma_f32 v[42:43], v[42:43], v[36:37], v[32:33] op_sel_hi:[1,0,0] neg_lo:[0,0,1] neg_hi:[0,0,1]
  v_cvt_pk_bf16_f32 v42, v42, v43
  v_accvgpr_write_b32 a53, v42
  v_lshlrev_b32 v44, 16, v166
  v_and_b32 v45, s55, v166
  v_pk_fma_f32 v[44:45], v[44:45], v[36:37], v[32:33] op_sel_hi:[1,0,0] neg_lo:[0,0,1] neg_hi:[0,0,1]
  v_cvt_pk_bf16_f32 v44, v44, v45
  v_accvgpr_write_b32 a54, v44
  v_lshlrev_b32 v46, 16, v167
  v_and_b32 v47, s55, v167
  v_pk_fma_f32 v[46:47], v[46:47], v[36:37], v[32:33] op_sel_hi:[1,0,0] neg_lo:[0,0,1] neg_hi:[0,0,1]
  v_cvt_pk_bf16_f32 v46, v46, v47
  v_accvgpr_write_b32 a55, v46
  v_lshlrev_b32 v40, 16, v168
  v_and_b32 v41, s55, v168
  v_pk_fma_f32 v[40:41], v[40:41], v[36:37], v[32:33] op_sel_hi:[1,0,0] neg_lo:[0,0,1] neg_hi:[0,0,1]
  v_cvt_pk_bf16_f32 v40, v40, v41
  v_accvgpr_write_b32 a56, v40
  v_lshlrev_b32 v42, 16, v169
  v_and_b32 v43, s55, v169
  v_pk_fma_f32 v[42:43], v[42:43], v[36:37], v[32:33] op_sel_hi:[1,0,0] neg_lo:[0,0,1] neg_hi:[0,0,1]
  v_cvt_pk_bf16_f32 v42, v42, v43
  v_accvgpr_write_b32 a57, v42
  v_lshlrev_b32 v44, 16, v170
  v_and_b32 v45, s55, v170
  v_pk_fma_f32 v[44:45], v[44:45], v[36:37], v[32:33] op_sel_hi:[1,0,0] neg_lo:[0,0,1] neg_hi:[0,0,1]
  v_cvt_pk_bf16_f32 v44, v44, v45
  v_accvgpr_write_b32 a58, v44
  v_lshlrev_b32 v46, 16, v171
  v_and_b32 v47, s55, v171
  v_pk_fma_f32 v[46:47], v[46:47], v[36:37], v[32:33] op_sel_hi:[1,0,0] neg_lo:[0,0,1] neg_hi:[0,0,1]
  v_cvt_pk_bf16_f32 v46, v46, v47
  v_accvgpr_write_b32 a59, v46
  v_lshlrev_b32 v40, 16, v172
  v_and_b32 v41, s55, v172
  v_pk_fma_f32 v[40:41], v[40:41], v[36:37], v[32:33] op_sel_hi:[1,0,0] neg_lo:[0,0,1] neg_hi:[0,0,1]
  v_cvt_pk_bf16_f32 v40, v40, v41
  v_accvgpr_write_b32 a60, v40
  v_lshlrev_b32 v42, 16, v173
  v_and_b32 v43, s55, v173
  v_pk_fma_f32 v[42:43], v[42:43], v[36:37], v[32:33] op_sel_hi:[1,0,0] neg_lo:[0,0,1] neg_hi:[0,0,1]
  v_cvt_pk_bf16_f32 v42, v42, v43
  v_accvgpr_write_b32 a61, v42
  v_lshlrev_b32 v44, 16, v174
  v_and_b32 v45, s55, v174
  v_pk_fma_f32 v[44:45], v[44:45], v[36:37], v[32:33] op_sel_hi:[1,0,0] neg_lo:[0,0,1] neg_hi:[0,0,1]
  v_cvt_pk_bf16_f32 v44, v44, v45
  v_accvgpr_write_b32 a62, v44
  v_lshlrev_b32 v46, 16, v175
  v_and_b32 v47, s55, v175
  v_pk_fma_f32 v[46:47], v[46:47], v[36:37], v[32:33] op_sel_hi:[1,0,0] neg_lo:[0,0,1] neg_hi:[0,0,1]
  v_cvt_pk_bf16_f32 v46, v46, v47
  v_accvgpr_write_b32 a63, v46
  v_lshlrev_b32 v40, 16, v176
  v_and_b32 v41, s55, v176
  v_pk_fma_f32 v[40:41], v[40:41], v[36:37], v[32:33] op_sel_hi:[1,0,0] neg_lo:[0,0,1] neg_hi:[0,0,1]
  v_cvt_pk_bf16_f32 v40, v40, v41
  v_accvgpr_write_b32 a64, v40
  v_lshlrev_b32 v42, 16, v177
  v_and_b32 v43, s55, v177
  v_pk_fma_f32 v[42:43], v[42:43], v[36:37], v[32:33] op_sel_hi:[1,0,0] neg_lo:[0,0,1] neg_hi:[0,0,1]
  v_cvt_pk_bf16_f32 v42, v42, v43
  v_accvgpr_write_b32 a65, v42
  v_lshlrev_b32 v44, 16, v178
  v_and_b32 v45, s55, v178
  v_pk_fma_f32 v[44:45], v[44:45], v[36:37], v[32:33] op_sel_hi:[1,0,0] neg_lo:[0,0,1] neg_hi:[0,0,1]
  v_cvt_pk_bf16_f32 v44, v44, v45
  v_accvgpr_write_b32 a66, v44
  v_lshlrev_b32 v46, 16, v179
  v_and_b32 v47, s55, v179
  v_pk_fma_f32 v[46:47], v[46:47], v[36:37], v[32:33] op_sel_hi:[1,0,0] neg_lo:[0,0,1] neg_hi:[0,0,1]
  v_cvt_pk_bf16_f32 v46, v46, v47
  v_accvgpr_write_b32 a67, v46
  v_lshlrev_b32 v40, 16, v180
  v_and_b32 v41, s55, v180
  v_pk_fma_f32 v[40:41], v[40:41], v[36:37], v[32:33] op_sel_hi:[1,0,0] neg_lo:[0,0,1] neg_hi:[0,0,1]
  v_cvt_pk_bf16_f32 v40, v40, v41
  v_accvgpr_write_b32 a68, v40
  v_lshlrev_b32 v42, 16, v181
  v_and_b32 v43, s55, v181
  v_pk_fma_f32 v[42:43], v[42:43], v[36:37], v[32:33] op_sel_hi:[1,0,0] neg_lo:[0,0,1] neg_hi:[0,0,1]
  v_cvt_pk_bf16_f32 v42, v42, v43
  v_accvgpr_write_b32 a69, v42
  v_lshlrev_b32 v44, 16, v182
  v_and_b32 v45, s55, v182
  v_pk_fma_f32 v[44:45], v[44:45], v[36:37], v[32:33] op_sel_hi:[1,0,0] neg_lo:[0,0,1] neg_hi:[0,0,1]
  v_cvt_pk_bf16_f32 v44, v44, v45
  v_accvgpr_write_b32 a70, v44
  v_lshlrev_b32 v46, 16, v183
  v_and_b32 v47, s55, v183
  v_pk_fma_f32 v[46:47], v[46:47], v[36:37], v[32:33] op_sel_hi:[1,0,0] neg_lo:[0,0,1] neg_hi:[0,0,1]
  v_cvt_pk_bf16_f32 v46, v46, v47
  v_accvgpr_write_b32 a71, v46
  v_lshlrev_b32 v40, 16, v184
  v_and_b32 v41, s55, v184
  v_pk_fma_f32 v[40:41], v[40:41], v[36:37], v[32:33] op_sel_hi:[1,0,0] neg_lo:[0,0,1] neg_hi:[0,0,1]
  v_cvt_pk_bf16_f32 v40, v40, v41
  v_accvgpr_write_b32 a72, v40
  v_lshlrev_b32 v42, 16, v185
  v_and_b32 v43, s55, v185
  v_pk_fma_f32 v[42:43], v[42:43], v[36:37], v[32:33] op_sel_hi:[1,0,0] neg_lo:[0,0,1] neg_hi:[0,0,1]
  v_cvt_pk_bf16_f32 v42, v42, v43
  v_accvgpr_write_b32 a73, v42
  v_lshlrev_b32 v44, 16, v186
  v_and_b32 v45, s55, v186
  v_pk_fma_f32 v[44:45], v[44:45], v[36:37], v[32:33] op_sel_hi:[1,0,0] neg_lo:[0,0,1] neg_hi:[0,0,1]
  v_cvt_pk_bf16_f32 v44, v44, v45
  v_accvgpr_write_b32 a74, v44
  v_lshlrev_b32 v46, 16, v187
  v_and_b32 v47, s55, v187
  v_pk_fma_f32 v[46:47], v[46:47], v[36:37], v[32:33] op_sel_hi:[1,0,0] neg_lo:[0,0,1] neg_hi:[0,0,1]
  v_cvt_pk_bf16_f32 v46, v46, v47
  v_accvgpr_write_b32 a75, v46
  v_lshlrev_b32 v40, 16, v188
  v_and_b32 v41, s55, v188
  v_pk_fma_f32 v[40:41], v[40:41], v[36:37], v[32:33] op_sel_hi:[1,0,0] neg_lo:[0,0,1] neg_hi:[0,0,1]
  v_cvt_pk_bf16_f32 v40, v40, v41
  v_accvgpr_write_b32 a76, v40
  v_lshlrev_b32 v42, 16, v189
  v_and_b32 v43, s55, v189
  v_pk_fma_f32 v[42:43], v[42:43], v[36:37], v[32:33] op_sel_hi:[1,0,0] neg_lo:[0,0,1] neg_hi:[0,0,1]
  v_cvt_pk_bf16_f32 v42, v42, v43
  v_accvgpr_write_b32 a77, v42
  v_lshlrev_b32 v44, 16, v190
  v_and_b32 v45, s55, v190
  v_pk_fma_f32 v[44:45], v[44:45], v[36:37], v[32:33] op_sel_hi:[1,0,0] neg_lo:[0,0,1] neg_hi:[0,0,1]
  v_cvt_pk_bf16_f32 v44, v44, v45
  v_accvgpr_write_b32 a78, v44
  v_lshlrev_b32 v46, 16, v191
  v_and_b32 v47, s55, v191
  v_pk_fma_f32 v[46:47], v[46:47], v[36:37], v[32:33] op_sel_hi:[1,0,0] neg_lo:[0,0,1] neg_hi:[0,0,1]
  v_cvt_pk_bf16_f32 v46, v46, v47
  v_accvgpr_write_b32 a79, v46
  v_lshlrev_b32 v40, 16, v192
  v_and_b32 v41, s55, v192
  v_pk_fma_f32 v[40:41], v[40:41], v[36:37], v[32:33] op_sel_hi:[1,0,0] neg_lo:[0,0,1] neg_hi:[0,0,1]
  v_cvt_pk_bf16_f32 v40, v40, v41
  v_accvgpr_write_b32 a80, v40
  v_lshlrev_b32 v42, 16, v193
  v_and_b32 v43, s55, v193
  v_pk_fma_f32 v[42:43], v[42:43], v[36:37], v[32:33] op_sel_hi:[1,0,0] neg_lo:[0,0,1] neg_hi:[0,0,1]
  v_cvt_pk_bf16_f32 v42, v42, v43
  v_accvgpr_write_b32 a81, v42
  v_lshlrev_b32 v44, 16, v194
  v_and_b32 v45, s55, v194
  v_pk_fma_f32 v[44:45], v[44:45], v[36:37], v[32:33] op_sel_hi:[1,0,0] neg_lo:[0,0,1] neg_hi:[0,0,1]
  v_cvt_pk_bf16_f32 v44, v44, v45
  v_accvgpr_write_b32 a82, v44
  v_lshlrev_b32 v46, 16, v195
  v_and_b32 v47, s55, v195
  v_pk_fma_f32 v[46:47], v[46:47], v[36:37], v[32:33] op_sel_hi:[1,0,0] neg_lo:[0,0,1] neg_hi:[0,0,1]
  v_cvt_pk_bf16_f32 v46, v46, v47
  v_accvgpr_write_b32 a83, v46
  v_lshlrev_b32 v40, 16, v196
  v_and_b32 v41, s55, v196
  v_pk_fma_f32 v[40:41], v[40:41], v[36:37], v[32:33] op_sel_hi:[1,0,0] neg_lo:[0,0,1] neg_hi:[0,0,1]
  v_cvt_pk_bf16_f32 v40, v40, v41
  v_accvgpr_write_b32 a84, v40
  v_lshlrev_b32 v42, 16, v197
  v_and_b32 v43, s55, v197
  v_pk_fma_f32 v[42:43], v[42:43], v[36:37], v[32:33] op_sel_hi:[1,0,0] neg_lo:[0,0,1] neg_hi:[0,0,1]
  v_cvt_pk_bf16_f32 v42, v42, v43
  v_accvgpr_write_b32 a85, v42
  v_lshlrev_b32 v44, 16, v198
  v_and_b32 v45, s55, v198
  v_pk_fma_f32 v[44:45], v[44:45], v[36:37], v[32:33] op_sel_hi:[1,0,0] neg_lo:[0,0,1] neg_hi:[0,0,1]
  v_cvt_pk_bf16_f32 v44, v44, v45
  v_accvgpr_write_b32 a86, v44
  v_lshlrev_b32 v46, 16, v199
  v_and_b32 v47, s55, v199
  v_pk_fma_f32 v[46:47], v[46:47], v[36:37], v[32:33] op_sel_hi:[1,0,0] neg_lo:[0,0,1] neg_hi:[0,0,1]
  v_cvt_pk_bf16_f32 v46, v46, v47
  v_accvgpr_write_b32 a87, v46
  v_lshlrev_b32 v40, 16, v200
  v_and_b32 v41, s55, v200
  v_pk_fma_f32 v[40:41], v[40:41], v[36:37], v[32:33] op_sel_hi:[1,0,0] neg_lo:[0,0,1] neg_hi:[0,0,1]
  v_cvt_pk_bf16_f32 v40, v40, v41
  v_accvgpr_write_b32 a88, v40
  v_lshlrev_b32 v42, 16, v201
  v_and_b32 v43, s55, v201
  v_pk_fma_f32 v[42:43], v[42:43], v[36:37], v[32:33] op_sel_hi:[1,0,0] neg_lo:[0,0,1] neg_hi:[0,0,1]
  v_cvt_pk_bf16_f32 v42, v42, v43
  v_accvgpr_write_b32 a89, v42
  v_lshlrev_b32 v44, 16, v202
  v_and_b32 v45, s55, v202
  v_pk_fma_f32 v[44:45], v[44:45], v[36:37], v[32:33] op_sel_hi:[1,0,0] neg_lo:[0,0,1] neg_hi:[0,0,1]
  v_cvt_pk_bf16_f32 v44, v44, v45
  v_accvgpr_write_b32 a90, v44
  v_lshlrev_b32 v46, 16, v203
  v_and_b32 v47, s55, v203
  v_pk_fma_f32 v[46:47], v[46:47], v[36:37], v[32:33] op_sel_hi:[1,0,0] neg_lo:[0,0,1] neg_hi:[0,0,1]
  v_cvt_pk_bf16_f32 v46, v46, v47
  v_accvgpr_write_b32 a91, v46
  v_lshlrev_b32 v40, 16, v204
  v_and_b32 v41, s55, v204
  v_pk_fma_f32 v[40:41], v[40:41], v[36:37], v[32:33] op_sel_hi:[1,0,0] neg_lo:[0,0,1] neg_hi:[0,0,1]
  v_cvt_pk_bf16_f32 v40, v40, v41
  v_accvgpr_write_b32 a92, v40
  v_lshlrev_b32 v42, 16, v205
  v_and_b32 v43, s55, v205
  v_pk_fma_f32 v[42:43], v[42:43], v[36:37], v[32:33] op_sel_hi:[1,0,0] neg_lo:[0,0,1] neg_hi:[0,0,1]
  v_cvt_pk_bf16_f32 v42, v42, v43
  v_accvgpr_write_b32 a93, v42
  v_lshlrev_b32 v44, 16, v206
  v_and_b32 v45, s55, v206
  v_pk_fma_f32 v[44:45], v[44:45], v[36:37], v[32:33] op_sel_hi:[1,0,0] neg_lo:[0,0,1] neg_hi:[0,0,1]
  v_cvt_pk_bf16_f32 v44, v44, v45
  v_accvgpr_write_b32 a94, v44
  v_lshlrev_b32 v46, 16, v207
  v_and_b32 v47, s55, v207
  v_pk_fma_f32 v[46:47], v[46:47], v[36:37], v[32:33] op_sel_hi:[1,0,0] neg_lo:[0,0,1] neg_hi:[0,0,1]
  v_cvt_pk_bf16_f32 v46, v46, v47
  v_accvgpr_write_b32 a95, v46
  v_lshlrev_b32 v40, 16, v208
  v_and_b32 v41, s55, v208
  v_pk_fma_f32 v[40:41], v[40:41], v[36:37], v[32:33] op_sel_hi:[1,0,0] neg_lo:[0,0,1] neg_hi:[0,0,1]
  v_cvt_pk_bf16_f32 v40, v40, v41
  v_accvgpr_write_b32 a96, v40
  v_lshlrev_b32 v42, 16, v209
  v_and_b32 v43, s55, v209
  v_pk_fma_f32 v[42:43], v[42:43], v[36:37], v[32:33] op_sel_hi:[1,0,0] neg_lo:[0,0,1] neg_hi:[0,0,1]
  v_cvt_pk_bf16_f32 v42, v42, v43
  v_accvgpr_write_b32 a97, v42
  v_lshlrev_b32 v44, 16, v210
  v_and_b32 v45, s55, v210
  v_pk_fma_f32 v[44:45], v[44:45], v[36:37], v[32:33] op_sel_hi:[1,0,0] neg_lo:[0,0,1] neg_hi:[0,0,1]
  v_cvt_pk_bf16_f32 v44, v44, v45
  v_accvgpr_write_b32 a98, v44
  v_lshlrev_b32 v46, 16, v211
  v_and_b32 v47, s55, v211
  v_pk_fma_f32 v[46:47], v[46:47], v[36:37], v[32:33] op_sel_hi:[1,0,0] neg_lo:[0,0,1] neg_hi:[0,0,1]
  v_cvt_pk_bf16_f32 v46, v46, v47
  v_accvgpr_write_b32 a99, v46
  v_lshlrev_b32 v40, 16, v212
  v_and_b32 v41, s55, v212
  v_pk_fma_f32 v[40:41], v[40:41], v[36:37], v[32:33] op_sel_hi:[1,0,0] neg_lo:[0,0,1] neg_hi:[0,0,1]
  v_cvt_pk_bf16_f32 v40, v40, v41
  v_accvgpr_write_b32 a100, v40
  v_lshlrev_b32 v42, 16, v213
  v_and_b32 v43, s55, v213
  v_pk_fma_f32 v[42:43], v[42:43], v[36:37], v[32:33] op_sel_hi:[1,0,0] neg_lo:[0,0,1] neg_hi:[0,0,1]
  v_cvt_pk_bf16_f32 v42, v42, v43
  v_accvgpr_write_b32 a101, v42
  v_lshlrev_b32 v44, 16, v214
  v_and_b32 v45, s55, v214
  v_pk_fma_f32 v[44:45], v[44:45], v[36:37], v[32:33] op_sel_hi:[1,0,0] neg_lo:[0,0,1] neg_hi:[0,0,1]
  v_cvt_pk_bf16_f32 v44, v44, v45
  v_accvgpr_write_b32 a102, v44
  v_lshlrev_b32 v46, 16, v215
  v_and_b32 v47, s55, v215
  v_pk_fma_f32 v[46:47], v[46:47], v[36:37], v[32:33] op_sel_hi:[1,0,0] neg_lo:[0,0,1] neg_hi:[0,0,1]
  v_cvt_pk_bf16_f32 v46, v46, v47
  v_accvgpr_write_b32 a103, v46
  v_lshlrev_b32 v40, 16, v216
  v_and_b32 v41, s55, v216
  v_pk_fma_f32 v[40:41], v[40:41], v[36:37], v[32:33] op_sel_hi:[1,0,0] neg_lo:[0,0,1] neg_hi:[0,0,1]
  v_cvt_pk_bf16_f32 v40, v40, v41
  v_accvgpr_write_b32 a104, v40
  v_lshlrev_b32 v42, 16, v217
  v_and_b32 v43, s55, v217
  v_pk_fma_f32 v[42:43], v[42:43], v[36:37], v[32:33] op_sel_hi:[1,0,0] neg_lo:[0,0,1] neg_hi:[0,0,1]
  v_cvt_pk_bf16_f32 v42, v42, v43
  v_accvgpr_write_b32 a105, v42
  v_lshlrev_b32 v44, 16, v218
  v_and_b32 v45, s55, v218
  v_pk_fma_f32 v[44:45], v[44:45], v[36:37], v[32:33] op_sel_hi:[1,0,0] neg_lo:[0,0,1] neg_hi:[0,0,1]
  v_cvt_pk_bf16_f32 v44, v44, v45
  v_accvgpr_write_b32 a106, v44
  v_lshlrev_b32 v46, 16, v219
  v_and_b32 v47, s55, v219
  v_pk_fma_f32 v[46:47], v[46:47], v[36:37], v[32:33] op_sel_hi:[1,0,0] neg_lo:[0,0,1] neg_hi:[0,0,1]
  v_cvt_pk_bf16_f32 v46, v46, v47
  v_accvgpr_write_b32 a107, v46
  v_lshlrev_b32 v40, 16, v220
  v_and_b32 v41, s55, v220
  v_pk_fma_f32 v[40:41], v[40:41], v[36:37], v[32:33] op_sel_hi:[1,0,0] neg_lo:[0,0,1] neg_hi:[0,0,1]
  v_cvt_pk_bf16_f32 v40, v40, v41
  v_accvgpr_write_b32 a108, v40
  v_lshlrev_b32 v42, 16, v221
  v_and_b32 v43, s55, v221
  v_pk_fma_f32 v[42:43], v[42:43], v[36:37], v[32:33] op_sel_hi:[1,0,0] neg_lo:[0,0,1] neg_hi:[0,0,1]
  v_cvt_pk_bf16_f32 v42, v42, v43
  v_accvgpr_write_b32 a109, v42
  v_lshlrev_b32 v44, 16, v222
  v_and_b32 v45, s55, v222
  v_pk_fma_f32 v[44:45], v[44:45], v[36:37], v[32:33] op_sel_hi:[1,0,0] neg_lo:[0,0,1] neg_hi:[0,0,1]
  v_cvt_pk_bf16_f32 v44, v44, v45
  v_accvgpr_write_b32 a110, v44
  v_lshlrev_b32 v46, 16, v223
  v_and_b32 v47, s55, v223
  v_pk_fma_f32 v[46:47], v[46:47], v[36:37], v[32:33] op_sel_hi:[1,0,0] neg_lo:[0,0,1] neg_hi:[0,0,1]
  v_cvt_pk_bf16_f32 v46, v46, v47
  v_accvgpr_write_b32 a111, v46
  v_lshlrev_b32 v40, 16, v224
  v_and_b32 v41, s55, v224
  v_pk_fma_f32 v[40:41], v[40:41], v[36:37], v[32:33] op_sel_hi:[1,0,0] neg_lo:[0,0,1] neg_hi:[0,0,1]
  v_cvt_pk_bf16_f32 v40, v40, v41
  v_accvgpr_write_b32 a112, v40
  v_lshlrev_b32 v42, 16, v225
  v_and_b32 v43, s55, v225
  v_pk_fma_f32 v[42:43], v[42:43], v[36:37], v[32:33] op_sel_hi:[1,0,0] neg_lo:[0,0,1] neg_hi:[0,0,1]
  v_cvt_pk_bf16_f32 v42, v42, v43
  v_accvgpr_write_b32 a113, v42
  v_lshlrev_b32 v44, 16, v226
  v_and_b32 v45, s55, v226
  v_pk_fma_f32 v[44:45], v[44:45], v[36:37], v[32:33] op_sel_hi:[1,0,0] neg_lo:[0,0,1] neg_hi:[0,0,1]
  v_cvt_pk_bf16_f32 v44, v44, v45
  v_accvgpr_write_b32 a114, v44
  v_lshlrev_b32 v46, 16, v227
  v_and_b32 v47, s55, v227
  v_pk_fma_f32 v[46:47], v[46:47], v[36:37], v[32:33] op_sel_hi:[1,0,0] neg_lo:[0,0,1] neg_hi:[0,0,1]
  v_cvt_pk_bf16_f32 v46, v46, v47
  v_accvgpr_write_b32 a115, v46
  v_lshlrev_b32 v40, 16, v228
  v_and_b32 v41, s55, v228
  v_pk_fma_f32 v[40:41], v[40:41], v[36:37], v[32:33] op_sel_hi:[1,0,0] neg_lo:[0,0,1] neg_hi:[0,0,1]
  v_cvt_pk_bf16_f32 v40, v40, v41
  v_accvgpr_write_b32 a116, v40
  v_lshlrev_b32 v42, 16, v229
  v_and_b32 v43, s55, v229
  v_pk_fma_f32 v[42:43], v[42:43], v[36:37], v[32:33] op_sel_hi:[1,0,0] neg_lo:[0,0,1] neg_hi:[0,0,1]
  v_cvt_pk_bf16_f32 v42, v42, v43
  v_accvgpr_write_b32 a117, v42
  v_lshlrev_b32 v44, 16, v230
  v_and_b32 v45, s55, v230
  v_pk_fma_f32 v[44:45], v[44:45], v[36:37], v[32:33] op_sel_hi:[1,0,0] neg_lo:[0,0,1] neg_hi:[0,0,1]
  v_cvt_pk_bf16_f32 v44, v44, v45
  v_accvgpr_write_b32 a118, v44
  v_lshlrev_b32 v46, 16, v231
  v_and_b32 v47, s55, v231
  v_pk_fma_f32 v[46:47], v[46:47], v[36:37], v[32:33] op_sel_hi:[1,0,0] neg_lo:[0,0,1] neg_hi:[0,0,1]
  v_cvt_pk_bf16_f32 v46, v46, v47
  v_accvgpr_write_b32 a119, v46
  v_lshlrev_b32 v40, 16, v232
  v_and_b32 v41, s55, v232
  v_pk_fma_f32 v[40:41], v[40:41], v[36:37], v[32:33] op_sel_hi:[1,0,0] neg_lo:[0,0,1] neg_hi:[0,0,1]
  v_cvt_pk_bf16_f32 v40, v40, v41
  v_accvgpr_write_b32 a120, v40
  v_lshlrev_b32 v42, 16, v233
  v_and_b32 v43, s55, v233
  v_pk_fma_f32 v[42:43], v[42:43], v[36:37], v[32:33] op_sel_hi:[1,0,0] neg_lo:[0,0,1] neg_hi:[0,0,1]
  v_cvt_pk_bf16_f32 v42, v42, v43
  v_accvgpr_write_b32 a121, v42
  v_lshlrev_b32 v44, 16, v234
  v_and_b32 v45, s55, v234
  v_pk_fma_f32 v[44:45], v[44:45], v[36:37], v[32:33] op_sel_hi:[1,0,0] neg_lo:[0,0,1] neg_hi:[0,0,1]
  v_cvt_pk_bf16_f32 v44, v44, v45
  v_accvgpr_write_b32 a122, v44
  v_lshlrev_b32 v46, 16, v235
  v_and_b32 v47, s55, v235
  v_pk_fma_f32 v[46:47], v[46:47], v[36:37], v[32:33] op_sel_hi:[1,0,0] neg_lo:[0,0,1] neg_hi:[0,0,1]
  v_cvt_pk_bf16_f32 v46, v46, v47
  v_accvgpr_write_b32 a123, v46
  v_lshlrev_b32 v40, 16, v236
  v_and_b32 v41, s55, v236
  v_pk_fma_f32 v[40:41], v[40:41], v[36:37], v[32:33] op_sel_hi:[1,0,0] neg_lo:[0,0,1] neg_hi:[0,0,1]
  v_cvt_pk_bf16_f32 v40, v40, v41
  v_accvgpr_write_b32 a124, v40
  v_lshlrev_b32 v42, 16, v237
  v_and_b32 v43, s55, v237
  v_pk_fma_f32 v[42:43], v[42:43], v[36:37], v[32:33] op_sel_hi:[1,0,0] neg_lo:[0,0,1] neg_hi:[0,0,1]
  v_cvt_pk_bf16_f32 v42, v42, v43
  v_accvgpr_write_b32 a125, v42
  v_lshlrev_b32 v44, 16, v238
  v_and_b32 v45, s55, v238
  v_pk_fma_f32 v[44:45], v[44:45], v[36:37], v[32:33] op_sel_hi:[1,0,0] neg_lo:[0,0,1] neg_hi:[0,0,1]
  v_cvt_pk_bf16_f32 v44, v44, v45
  v_accvgpr_write_b32 a126, v44
  v_lshlrev_b32 v46, 16, v239
  v_and_b32 v47, s55, v239
  v_pk_fma_f32 v[46:47], v[46:47], v[36:37], v[32:33] op_sel_hi:[1,0,0] neg_lo:[0,0,1] neg_hi:[0,0,1]
  v_cvt_pk_bf16_f32 v46, v46, v47
  v_accvgpr_write_b32 a127, v46
  v_lshlrev_b32 v40, 16, v240
  v_and_b32 v41, s55, v240
  v_pk_fma_f32 v[40:41], v[40:41], v[36:37], v[32:33] op_sel_hi:[1,0,0] neg_lo:[0,0,1] neg_hi:[0,0,1]
  v_cvt_pk_bf16_f32 v40, v40, v41
  v_accvgpr_write_b32 a128, v40
  v_lshlrev_b32 v42, 16, v241
  v_and_b32 v43, s55, v241
  v_pk_fma_f32 v[42:43], v[42:43], v[36:37], v[32:33] op_sel_hi:[1,0,0] neg_lo:[0,0,1] neg_hi:[0,0,1]
  v_cvt_pk_bf16_f32 v42, v42, v43
  v_accvgpr_write_b32 a129, v42
  v_lshlrev_b32 v44, 16, v242
  v_and_b32 v45, s55, v242
  v_pk_fma_f32 v[44:45], v[44:45], v[36:37], v[32:33] op_sel_hi:[1,0,0] neg_lo:[0,0,1] neg_hi:[0,0,1]
  v_cvt_pk_bf16_f32 v44, v44, v45
  v_accvgpr_write_b32 a130, v44
  v_lshlrev_b32 v46, 16, v243
  v_and_b32 v47, s55, v243
  v_pk_fma_f32 v[46:47], v[46:47], v[36:37], v[32:33] op_sel_hi:[1,0,0] neg_lo:[0,0,1] neg_hi:[0,0,1]
  v_cvt_pk_bf16_f32 v46, v46, v47
  v_accvgpr_write_b32 a131, v46
  v_lshlrev_b32 v40, 16, v244
  v_and_b32 v41, s55, v244
  v_pk_fma_f32 v[40:41], v[40:41], v[36:37], v[32:33] op_sel_hi:[1,0,0] neg_lo:[0,0,1] neg_hi:[0,0,1]
  v_cvt_pk_bf16_f32 v40, v40, v41
  v_accvgpr_write_b32 a132, v40
  v_lshlrev_b32 v42, 16, v245
  v_and_b32 v43, s55, v245
  v_pk_fma_f32 v[42:43], v[42:43], v[36:37], v[32:33] op_sel_hi:[1,0,0] neg_lo:[0,0,1] neg_hi:[0,0,1]
  v_cvt_pk_bf16_f32 v42, v42, v43
  v_accvgpr_write_b32 a133, v42
  v_lshlrev_b32 v44, 16, v246
  v_and_b32 v45, s55, v246
  v_pk_fma_f32 v[44:45], v[44:45], v[36:37], v[32:33] op_sel_hi:[1,0,0] neg_lo:[0,0,1] neg_hi:[0,0,1]
  v_cvt_pk_bf16_f32 v44, v44, v45
  v_accvgpr_write_b32 a134, v44
  v_lshlrev_b32 v46, 16, v247
  v_and_b32 v47, s55, v247
  v_pk_fma_f32 v[46:47], v[46:47], v[36:37], v[32:33] op_sel_hi:[1,0,0] neg_lo:[0,0,1] neg_hi:[0,0,1]
  v_cvt_pk_bf16_f32 v46, v46, v47
  v_accvgpr_write_b32 a135, v46
  v_lshlrev_b32 v40, 16, v248
  v_and_b32 v41, s55, v248
  v_pk_fma_f32 v[40:41], v[40:41], v[36:37], v[32:33] op_sel_hi:[1,0,0] neg_lo:[0,0,1] neg_hi:[0,0,1]
  v_cvt_pk_bf16_f32 v40, v40, v41
  v_accvgpr_write_b32 a136, v40
  v_lshlrev_b32 v42, 16, v249
  v_and_b32 v43, s55, v249
  v_pk_fma_f32 v[42:43], v[42:43], v[36:37], v[32:33] op_sel_hi:[1,0,0] neg_lo:[0,0,1] neg_hi:[0,0,1]
  v_cvt_pk_bf16_f32 v42, v42, v43
  v_accvgpr_write_b32 a137, v42
  v_lshlrev_b32 v44, 16, v250
  v_and_b32 v45, s55, v250
  v_pk_fma_f32 v[44:45], v[44:45], v[36:37], v[32:33] op_sel_hi:[1,0,0] neg_lo:[0,0,1] neg_hi:[0,0,1]
  v_cvt_pk_bf16_f32 v44, v44, v45
  v_accvgpr_write_b32 a138, v44
  v_lshlrev_b32 v46, 16, v251
  v_and_b32 v47, s55, v251
  v_pk_fma_f32 v[46:47], v[46:47], v[36:37], v[32:33] op_sel_hi:[1,0,0] neg_lo:[0,0,1] neg_hi:[0,0,1]
  v_cvt_pk_bf16_f32 v46, v46, v47
  v_accvgpr_write_b32 a139, v46
  v_lshlrev_b32 v40, 16, v252
  v_and_b32 v41, s55, v252
  v_pk_fma_f32 v[40:41], v[40:41], v[36:37], v[32:33] op_sel_hi:[1,0,0] neg_lo:[0,0,1] neg_hi:[0,0,1]
  v_cvt_pk_bf16_f32 v40, v40, v41
  v_accvgpr_write_b32 a140, v40
  v_lshlrev_b32 v42, 16, v253
  v_and_b32 v43, s55, v253
  v_pk_fma_f32 v[42:43], v[42:43], v[36:37], v[32:33] op_sel_hi:[1,0,0] neg_lo:[0,0,1] neg_hi:[0,0,1]
  v_cvt_pk_bf16_f32 v42, v42, v43
  v_accvgpr_write_b32 a141, v42
  v_lshlrev_b32 v44, 16, v254
  v_and_b32 v45, s55, v254
  v_pk_fma_f32 v[44:45], v[44:45], v[36:37], v[32:33] op_sel_hi:[1,0,0] neg_lo:[0,0,1] neg_hi:[0,0,1]
  v_cvt_pk_bf16_f32 v44, v44, v45
  v_accvgpr_write_b32 a142, v44
  v_lshlrev_b32 v46, 16, v255
  v_and_b32 v47, s55, v255
  v_pk_fma_f32 v[46:47], v[46:47], v[36:37], v[32:33] op_sel_hi:[1,0,0] neg_lo:[0,0,1] neg_hi:[0,0,1]
  v_cvt_pk_bf16_f32 v46, v46, v47
  v_accvgpr_write_b32 a143, v46
  s_mov_b32 s67, 0x40000000
  s_waitcnt vmcnt(28)
  s_barrier
  ds_read_b64_tr_b16 v[16:17], v4 offset:0
  ds_read_b64_tr_b16 v[18:19], v4 offset:512
  ds_read_b64_tr_b16 v[20:21], v5 offset:0
  ds_read_b64_tr_b16 v[22:23], v5 offset:512
  ds_read_b64_tr_b16 v[24:25], v4 offset:8192
  ds_read_b64_tr_b16 v[26:27], v4 offset:8704
  ds_read_b64_tr_b16 v[28:29], v5 offset:8192
  ds_read_b64_tr_b16 v[30:31], v5 offset:8704
L_unit:
  s_mov_b32 s64, s68
  s_mov_b32 s65, s69
  s_mov_b32 s66, s70
  s_cmp_eq_u32 s64, 1
  s_cbranch_scc1 L_unit_n
  s_waitcnt lgkmcnt(6)
  v_mfma_f32_32x32x16_bf16 v[48:63], v[16:19], a[0:3], 0
  ds_read_b64_tr_b16 v[32:33], v4 offset:2048
  ds_read_b64_tr_b16 v[34:35], v4 offset:2560
  s_waitcnt lgkmcnt(6)
  v_mfma_f32_32x32x16_bf16 v[64:79], v[20:23], a[0:3], 0
  ds_read_b64_tr_b16 v[36:37], v5 offset:2048
  ds_read_b64_tr_b16 v[38:39], v5 offset:2560
  s_waitcnt lgkmcnt(6)
  v_mfma_f32_32x32x16_bf16 v[80:95], v[24:27], a[0:3], 0
  ds_read_b64_tr_b16 v[40:41], v4 offset:10240
  ds_read_b64_tr_b16 v[42:43], v4 offset:10752
  s_waitcnt lgkmcnt(6)
  v_mfma_f32_32x32x16_bf16 v[96:111], v[28:31], a[0:3], 0
  ds_read_b64_tr_b16 v[44:45], v5 offset:10240
  ds_read_b64_tr_b16 v[46:47], v5 offset:10752
  s_waitcnt lgkmcnt(6)
  v_mfma_f32_32x32x16_bf16 v[48:63], v[32:35], a[4:7], v[48:63]
  s_waitcnt vmcnt(24)
  s_barrier
  ds_read_b64_tr_b16 v[16:17], v4 offset:4096
  ds_read_b64_tr_b16 v[18:19], v4 offset:4608
  s_waitcnt lgkmcnt(6)
  v_mfma_f32_32x32x16_bf16 v[64:79], v[36:39], a[4:7], v[64:79]
  ds_read_b64_tr_b16 v[20:21], v5 offset:4096
  ds_read_b64_tr_b16 v[22:23], v5 offset:4608
  s_add_u32 m0, s63, 131072
  s_nop 0
  buffer_load_dwordx4 v1, s[8:11], s60 offen lds
  s_waitcnt lgkmcnt(6)
  v_mfma_f32_32x32x16_bf16 v[80:95], v[40:43], a[4:7], v[80:95]
  ds_read_b64_tr_b16 v[24:25], v4 offset:12288
  ds_read_b64_tr_b16 v[26:27], v4 offset:12800
  s_add_u32 m0, s63, 132096
  s_add_u32 s58, s60, s62
  buffer_load_dwordx4 v1, s[8:11], s58 offen lds
  s_add_u32 s60, s60, s71
  s_waitcnt lgkmcnt(6)
  v_mfma_f32_32x32x16_bf16 v[96:111], v[44:47], a[4:7], v[96:111]
  ds_read_b64_tr_b16 v[28:29], v5 offset:12288
  ds_read_b64_tr_b16 v[30:31], v5 offset:12800
  s_add_u32 m0, s63, 139264
  s_nop 0
  buffer_load_dwordx4 v1, s[12:15], s61 offen lds
  s_waitcnt lgkmcnt(6)
  v_mfma_f32_32x32x16_bf16 v[48:63], v[16:19], a[8:11], v[48:63]
  ds_read_b64_tr_b16 v[32:33], v4 offset:6144
  ds_read_b64_tr_b16 v[34:35], v4 offset:6656
  s_add_u32 m0, s63, 140288
  s_add_u32 s58, s61, s62
  buffer_load_dwordx4 v1, s[12:15], s58 offen lds
  s_add_u32 s61, s61, s71
  s_waitcnt lgkmcnt(6)
  v_mfma_f32_32x32x16_bf16 v[64:79], v[20:23], a[8:11], v[64:79]
  ds_read_b64_tr_b16 v[36:37], v5 offset:6144
  ds_read_b64_tr_b16 v[38:39], v5 offset:6656
  s_waitcnt lgkmcnt(6)
  v_mfma_f32_32x32x16_bf16 v[80:95], v[24:27], a[8:11], v[80:95]
  ds_read_b64_tr_b16 v[40:41], v4 offset:14336
  ds_read_b64_tr_b16 v[42:43], v4 offset:14848
  s_waitcnt lgkmcnt(6)
  v_mfma_f32_32x32x16_bf16 v[96:111], v[28:31], a[8:11], v[96:111]
  ds_read_b64_tr_b16 v[44:45], v5 offset:14336
  ds_read_b64_tr_b16 v[46:47], v5 offset:14848
  s_waitcnt lgkmcnt(6)
  v_mfma_f32_32x32x16_bf16 v[48:63], v[32:35], a[12:15], v[48:63]
  ds_read_b64_tr_b16 v[16:17], v4 offset:16384
  ds_read_b64_tr_b16 v[18:19], v4 offset:16896
  s_waitcnt lgkmcnt(6)
  v_mfma_f32_32x32x16_bf16 v[64:79], v[36:39], a[12:15], v[64:79]
  ds_read_b64_tr_b16 v[20:21], v5 offset:16384
  ds_read_b64_tr_b16 v[22:23], v5 offset:16896
  s_waitcnt lgkmcnt(6)
  v_mfma_f32_32x32x16_bf16 v[80:95], v[40:43], a[12:15], v[80:95]
  ds_read_b64_tr_b16 v[24:25], v4 offset:24576
  ds_read_b64_tr_b16 v[26:27], v4 offset:25088
  s_waitcnt lgkmcnt(6)
  v_mfma_f32_32x32x16_bf16 v[96:111], v[44:47], a[12:15], v[96:111]
  ds_read_b64_tr_b16 v[28:29], v5 offset:24576
  ds_read_b64_tr_b16 v[30:31], v5 offset:25088
  s_waitcnt lgkmcnt(6)
  v_mfma_f32_32x32x16_bf16 v[48:63], v[16:19], a[16:19], v[48:63]
  ds_read_b64_tr_b16 v[32:33], v4 offset:18432
  ds_read_b64_tr_b16 v[34:35], v4 offset:18944
  s_waitcnt lgkmcnt(6)
  v_mfma_f32_32x32x16_bf16 v[64:79], v[20:23], a[16:19], v[64:79]
  ds_read_b64_tr_b16 v[36:37], v5 offset:18432
  ds_read_b64_tr_b16 v[38:39], v5 offset:18944
  s_waitcnt lgkmcnt(6)
  v_mfma_f32_32x32x16_bf16 v[80:95], v[24:27], a[16:19], v[80:95]
  ds_read_b64_tr_b16 v[40:41], v4 offset:26624
  ds_read_b64_tr_b16 v[42:43], v4 offset:27136
  s_waitcnt lgkmcnt(6)
  v_mfma_f32_32x32x16_bf16 v[96:111], v[28:31], a[16:19], v[96:111]
  ds_read_b64_tr_b16 v[44:45], v5 offset:26624
  ds_read_b64_tr_b16 v[46:47], v5 offset:27136
  s_waitcnt lgkmcnt(6)
  v_mfma_f32_32x32x16_bf16 v[48:63], v[32:35], a[20:23], v[48:63]
  s_waitcnt vmcnt(24)
  s_barrier
  s_lshr_b32 m0, s54, 1
  s_and_b32 s56, s54, 1
  s_movrels_b32 s55, s84
  s_lshl_b32 s56, s56, 4
  s_lshr_b32 s55, s55, s56
  s_bfe_u32 s74, s55, 0x80008
  s_and_b32 s55, s55, 255
  s_lshl_b32 s58, s52, 2
  s_add_u32 s58, s58, s20
  s_lshl_b32 s70, s52, 10
  s_add_u32 s70, s70, 0x3204000
  s_cmp_lg_u32 s74, s52
  s_cbranch_scc1 L_up_none_t
  s_cmp_ge_u32 s55, 136
  s_cbranch_scc1 L_up_q_t
  s_cmp_ge_u32 s55, 64
  s_cbranch_scc1 L_up_g_t
  s_and_b32 s68, s55, 1
  s_lshr_b32 s56, s55, 1
  s_cmp_eq_u32 s68, 0
  s_cselect_b32 s8, s30, s32
  s_cselect_b32 s9, s31, s33
  s_lshl_b32 s69, s56, 20
  s_lshl_b32 s57, s58, 14
  s_add_u32 s69, s69, s57
  s_lshl_b32 s57, s68, 13
  s_add_u32 s69, s69, s57
  s_add_u32 s69, s69, 0x400000
  s_lshl_b32 s57, s68, 5
  s_add_u32 s57, s57, s56
  s_branch L_up_qkv_t
L_up_q_t:
  s_sub_u32 s56, s55, 136
  s_mov_b32 s68, 0
  s_mov_b32 s8, s28
  s_mov_b32 s9, s29
  s_lshl_b32 s69, s56, 19
  s_lshl_b32 s57, s58, 13
  s_add_u32 s69, s69, s57
  s_add_u32 s69, s69, 0x4000000
  s_add_u32 s57, s56, 64
L_up_qkv_t:
  s_and_b32 s9, s9, 0xffff
  s_mov_b32 s10, 0x480000
  s_mov_b32 s12, s8
  s_mov_b32 s13, s9
  s_mov_b32 s14, s10
  s_lshl_b32 s60, s56, 8
  s_lshl_b32 s56, s20, 17
  s_add_u32 s60, s60, s56
  s_add_u32 s61, s60, 128
  s_mov_b32 s62, 65536
  v_mov_b32 v1, v10
  s_branch L_up_fin_t
L_up_g_t:
  s_sub_u32 s56, s55, 64
  s_mov_b32 s68, 2
  s_mov_b32 s8, s40
  s_and_b32 s9, s41, 0xffff
  s_mov_b32 s10, 0x510000
  s_mov_b32 s12, s42
  s_and_b32 s13, s43, 0xffff
  s_mov_b32 s14, s10
  s_mul_i32 s69, s58, 294912
  s_lshl_b32 s57, s56, 12
  s_add_u32 s69, s69, s57
  s_add_u32 s69, s69, 0x5000000
  s_lshl_b32 s60, s56, 7
  s_mul_i32 s57, s20, 147456
  s_add_u32 s60, s60, s57
  s_mov_b32 s61, s60
  s_mov_b32 s62, 73728
  v_mov_b32 v1, v11
  s_add_u32 s57, s56, 96
  s_branch L_up_fin_t
L_up_none_t:
  s_mov_b32 s68, 3
  s_mov_b32 s60, 0x40000000
  s_mov_b32 s61, 0x40000000
  s_mov_b32 s62, 0
  s_mov_b32 s57, 255
  s_sub_u32 s54, s54, 1
L_up_fin_t:
  s_lshl_b32 s57, s57, 2
  s_add_u32 s70, s70, s57
  s_lshl_b32 s71, s62, 3
  s_add_u32 s54, s54, 1
  ds_read_b64_tr_b16 v[16:17], v4 offset:20480
  ds_read_b64_tr_b16 v[18:19], v4 offset:20992
  s_waitcnt lgkmcnt(6)
  v_mfma_f32_32x32x16_bf16 v[64:79], v[36:39], a[20:23], v[64:79]
  ds_read_b64_tr_b16 v[20:21], v5 offset:20480
  ds_read_b64_tr_b16 v[22:23], v5 offset:20992
  s_add_u32 m0, s63, 0
  s_nop 0
  buffer_load_dwordx4 v1, s[8:11], s60 offen lds
  s_waitcnt lgkmcnt(6)
  v_mfma_f32_32x32x16_bf16 v[80:95], v[40:43], a[20:23], v[80:95]
  ds_read_b64_tr_b16 v[24:25], v4 offset:28672
  ds_read_b64_tr_b16 v[26:27], v4 offset:29184
  s_add_u32 m0, s63, 1024
  s_add_u32 s58, s60, s62
  buffer_load_dwordx4 v1, s[8:11], s58 offen lds
  s_add_u32 s60, s60, s71
  s_waitcnt lgkmcnt(6)
  v_mfma_f32_32x32x16_bf16 v[96:111], v[44:47], a[20:23], v[96:111]
  ds_read_b64_tr_b16 v[28:29], v5 offset:28672
  ds_read_b64_tr_b16 v[30:31], v5 offset:29184
  s_add_u32 m0, s63, 8192
  s_nop 0
  buffer_load_dwordx4 v1, s[12:15], s61 offen lds
  s_waitcnt lgkmcnt(6)
  v_mfma_f32_32x32x16_bf16 v[48:63], v[16:19], a[24:27], v[48:63]
  ds_read_b64_tr_b16 v[32:33], v4 offset:22528
  ds_read_b64_tr_b16 v[34:35], v4 offset:23040
  s_add_u32 m0, s63, 9216
  s_add_u32 s58, s61, s62
  buffer_load_dwordx4 v1, s[12:15], s58 offen lds
  s_add_u32 s61, s61, s71
  s_waitcnt lgkmcnt(6)
  v_mfma_f32_32x32x16_bf16 v[64:79], v[20:23], a[24:27], v[64:79]
  ds_read_b64_tr_b16 v[36:37], v5 offset:22528
  ds_read_b64_tr_b16 v[38:39], v5 offset:23040
  s_waitcnt lgkmcnt(6)
  v_mfma_f32_32x32x16_bf16 v[80:95], v[24:27], a[24:27], v[80:95]
  ds_read_b64_tr_b16 v[40:41], v4 offset:30720
  ds_read_b64_tr_b16 v[42:43], v4 offset:31232
  s_waitcnt lgkmcnt(6)
  v_mfma_f32_32x32x16_bf16 v[96:111], v[28:31], a[24:27], v[96:111]
  ds_read_b64_tr_b16 v[44:45], v5 offset:30720
  ds_read_b64_tr_b16 v[46:47], v5 offset:31232
  s_waitcnt lgkmcnt(6)
  v_mfma_f32_32x32x16_bf16 v[48:63], v[32:35], a[28:31], v[48:63]
  ds_read_b64_tr_b16 v[16:17], v4 offset:32768
  ds_read_b64_tr_b16 v[18:19], v4 offset:33280
  s_waitcnt lgkmcnt(6)
  v_mfma_f32_32x32x16_bf16 v[64:79], v[36:39], a[28:31], v[64:79]
  ds_read_b64_tr_b16 v[20:21], v5 offset:32768
  ds_read_b64_tr_b16 v[22:23], v5 offset:33280
  s_waitcnt lgkmcnt(6)
  v_mfma_f32_32x32x16_bf16 v[80:95], v[40:43], a[28:31], v[80:95]
  ds_read_b64_tr_b16 v[24:25], v4 offset:40960
  ds_read_b64_tr_b16 v[26:27], v4 offset:41472
  s_waitcnt lgkmcnt(6)
  v_mfma_f32_32x32x16_bf16 v[96:111], v[44:47], a[28:31], v[96:111]
  ds_read_b64_tr_b16 v[28:29], v5 offset:40960
  ds_read_b64_tr_b16 v[30:31], v5 offset:41472
  s_waitcnt lgkmcnt(6)
  v_mfma_f32_32x32x16_bf16 v[48:63], v[16:19], a[32:35], v[48:63]
  ds_read_b64_tr_b16 v[32:33], v4 offset:34816
  ds_read_b64_tr_b16 v[34:35], v4 offset:35328
  s_waitcnt lgkmcnt(6)
  v_mfma_f32_32x32x16_bf16 v[64:79], v[20:23], a[32:35], v[64:79]
  ds_read_b64_tr_b16 v[36:37], v5 offset:34816
  ds_read_b64_tr_b16 v[38:39], v5 offset:35328
  s_waitcnt lgkmcnt(6)
  v_mfma_f32_32x32x16_bf16 v[80:95], v[24:27], a[32:35], v[80:95]
  ds_read_b64_tr_b16 v[40:41], v4 offset:43008
  ds_read_b64_tr_b16 v[42:43], v4 offset:43520
  s_waitcnt lgkmcnt(6)
  v_mfma_f32_32x32x16_bf16 v[96:111], v[28:31], a[32:35], v[96:111]
  ds_read_b64_tr_b16 v[44:45], v5 offset:43008
  ds_read_b64_tr_b16 v[46:47], v5 offset:43520
  s_waitcnt lgkmcnt(6)
  v_mfma_f32_32x32x16_bf16 v[48:63], v[32:35], a[36:39], v[48:63]
  s_waitcnt vmcnt(24)
  s_barrier
  ds_read_b64_tr_b16 v[16:17], v4 offset:36864
  ds_read_b64_tr_b16 v[18:19], v4 offset:37376
  s_waitcnt lgkmcnt(6)
  v_mfma_f32_32x32x16_bf16 v[64:79], v[36:39], a[36:39], v[64:79]
  ds_read_b64_tr_b16 v[20:21], v5 offset:36864
  ds_read_b64_tr_b16 v[22:23], v5 offset:37376
  s_add_u32 m0, s63, 16384
  s_nop 0
  buffer_load_dwordx4 v1, s[8:11], s60 offen lds
  s_waitcnt lgkmcnt(6)
  v_mfma_f32_32x32x16_bf16 v[80:95], v[40:43], a[36:39], v[80:95]
  ds_read_b64_tr_b16 v[24:25], v4 offset:45056
  ds_read_b64_tr_b16 v[26:27], v4 offset:45568
  s_add_u32 m0, s63, 17408
  s_add_u32 s58, s60, s62
  buffer_load_dwordx4 v1, s[8:11], s58 offen lds
  s_add_u32 s60, s60, s71
  s_waitcnt lgkmcnt(6)
  v_mfma_f32_32x32x16_bf16 v[96:111], v[44:47], a[36:39], v[96:111]
  ds_read_b64_tr_b16 v[28:29], v5 offset:45056
  ds_read_b64_tr_b16 v[30:31], v5 offset:45568
  s_add_u32 m0, s63, 24576
  s_nop 0
  buffer_load_dwordx4 v1, s[12:15], s61 offen lds
  s_waitcnt lgkmcnt(6)
  v_mfma_f32_32x32x16_bf16 v[48:63], v[16:19], a[40:43], v[48:63]
  ds_read_b64_tr_b16 v[32:33], v4 offset:38912
  ds_read_b64_tr_b16 v[34:35], v4 offset:39424
  s_add_u32 m0, s63, 25600
  s_add_u32 s58, s61, s62
  buffer_load_dwordx4 v1, s[12:15], s58 offen lds
  s_add_u32 s61, s61, s71
  s_waitcnt lgkmcnt(6)
  v_mfma_f32_32x32x16_bf16 v[64:79], v[20:23], a[40:43], v[64:79]
  ds_read_b64_tr_b16 v[36:37], v5 offset:38912
  ds_read_b64_tr_b16 v[38:39], v5 offset:39424
  s_waitcnt lgkmcnt(6)
  v_mfma_f32_32x32x16_bf16 v[80:95], v[24:27], a[40:43], v[80:95]
  ds_read_b64_tr_b16 v[40:41], v4 offset:47104
  ds_read_b64_tr_b16 v[42:43], v4 offset:47616
  s_waitcnt lgkmcnt(6)
  v_mfma_f32_32x32x16_bf16 v[96:111], v[28:31], a[40:43], v[96:111]
  ds_read_b64_tr_b16 v[44:45], v5 offset:47104
  ds_read_b64_tr_b16 v[46:47], v5 offset:47616
  s_waitcnt lgkmcnt(6)
  v_mfma_f32_32x32x16_bf16 v[48:63], v[32:35], a[44:47], v[48:63]
  ds_read_b64_tr_b16 v[16:17], v4 offset:49152
  ds_read_b64_tr_b16 v[18:19], v4 offset:49664
  s_waitcnt lgkmcnt(6)
  v_mfma_f32_32x32x16_bf16 v[64:79], v[36:39], a[44:47], v[64:79]
  ds_read_b64_tr_b16 v[20:21], v5 offset:49152
  ds_read_b64_tr_b16 v[22:23], v5 offset:49664
  s_waitcnt lgkmcnt(6)
  v_mfma_f32_32x32x16_bf16 v[80:95], v[40:43], a[44:47], v[80:95]
  ds_read_b64_tr_b16 v[24:25], v4 offset:57344
  ds_read_b64_tr_b16 v[26:27], v4 offset:57856
  s_waitcnt lgkmcnt(6)
  v_mfma_f32_32x32x16_bf16 v[96:111], v[44:47], a[44:47], v[96:111]
  ds_read_b64_tr_b16 v[28:29], v5 offset:57344
  ds_read_b64_tr_b16 v[30:31], v5 offset:57856
  s_waitcnt lgkmcnt(6)
  v_mfma_f32_32x32x16_bf16 v[48:63], v[16:19], a[48:51], v[48:63]
  ds_read_b64_tr_b16 v[32:33], v4 offset:51200
  ds_read_b64_tr_b16 v[34:35], v4 offset:51712
  s_waitcnt lgkmcnt(6)
  v_mfma_f32_32x32x16_bf16 v[64:79], v[20:23], a[48:51], v[64:79]
  ds_read_b64_tr_b16 v[36:37], v5 offset:51200
  ds_read_b64_tr_b16 v[38:39], v5 offset:51712
  s_waitcnt lgkmcnt(6)
  v_mfma_f32_32x32x16_bf16 v[80:95], v[24:27], a[48:51], v[80:95]
  ds_read_b64_tr_b16 v[40:41], v4 offset:59392
  ds_read_b64_tr_b16 v[42:43], v4 offset:59904
  s_waitcnt lgkmcnt(6)
  v_mfma_f32_32x32x16_bf16 v[96:111], v[28:31], a[48:51], v[96:111]
  ds_read_b64_tr_b16 v[44:45], v5 offset:59392
  ds_read_b64_tr_b16 v[46:47], v5 offset:59904
  s_waitcnt lgkmcnt(6)
  v_mfma_f32_32x32x16_bf16 v[48:63], v[32:35], a[52:55], v[48:63]
  s_waitcnt vmcnt(24)
  s_barrier
  ds_read_b64_tr_b16 v[16:17], v4 offset:53248
  ds_read_b64_tr_b16 v[18:19], v4 offset:53760
  s_waitcnt lgkmcnt(6)
  v_mfma_f32_32x32x16_bf16 v[64:79], v[36:39], a[52:55], v[64:79]
  ds_read_b64_tr_b16 v[20:21], v5 offset:53248
  ds_read_b64_tr_b16 v[22:23], v5 offset:53760
  s_add_u32 m0, s63, 32768
  s_nop 0
  buffer_load_dwordx4 v1, s[8:11], s60 offen lds
  s_waitcnt lgkmcnt(6)
  v_mfma_f32_32x32x16_bf16 v[80:95], v[40:43], a[52:55], v[80:95]
  ds_read_b64_tr_b16 v[24:25], v4 offset:61440
  ds_read_b64_tr_b16 v[26:27], v4 offset:61952
  s_add_u32 m0, s63, 33792
  s_add_u32 s58, s60, s62
  buffer_load_dwordx4 v1, s[8:11], s58 offen lds
  s_add_u32 s60, s60, s71
  s_waitcnt lgkmcnt(6)
  v_mfma_f32_32x32x16_bf16 v[96:111], v[44:47], a[52:55], v[96:111]
  ds_read_b64_tr_b16 v[28:29], v5 offset:61440
  ds_read_b64_tr_b16 v[30:31], v5 offset:61952
  s_add_u32 m0, s63, 40960
  s_nop 0
  buffer_load_dwordx4 v1, s[12:15], s61 offen lds
  s_waitcnt lgkmcnt(6)
  v_mfma_f32_32x32x16_bf16 v[48:63], v[16:19], a[56:59], v[48:63]
  ds_read_b64_tr_b16 v[32:33], v4 offset:55296
  ds_read_b64_tr_b16 v[34:35], v4 offset:55808
  s_add_u32 m0, s63, 41984
  s_add_u32 s58, s61, s62
  buffer_load_dwordx4 v1, s[12:15], s58 offen lds
  s_add_u32 s61, s61, s71
  s_waitcnt lgkmcnt(6)
  v_mfma_f32_32x32x16_bf16 v[64:79], v[20:23], a[56:59], v[64:79]
  ds_read_b64_tr_b16 v[36:37], v5 offset:55296
  ds_read_b64_tr_b16 v[38:39], v5 offset:55808
  s_waitcnt lgkmcnt(6)
  v_mfma_f32_32x32x16_bf16 v[80:95], v[24:27], a[56:59], v[80:95]
  ds_read_b64_tr_b16 v[40:41], v4 offset:63488
  ds_read_b64_tr_b16 v[42:43], v4 offset:64000
  s_waitcnt lgkmcnt(6)
  v_mfma_f32_32x32x16_bf16 v[96:111], v[28:31], a[56:59], v[96:111]
  ds_read_b64_tr_b16 v[44:45], v5 offset:63488
  ds_read_b64_tr_b16 v[46:47], v5 offset:64000
  s_waitcnt lgkmcnt(6)
  v_mfma_f32_32x32x16_bf16 v[48:63], v[32:35], a[60:63], v[48:63]
  ds_read_b64_tr_b16 v[16:17], v6 offset:0
  ds_read_b64_tr_b16 v[18:19], v6 offset:512
  s_waitcnt lgkmcnt(6)
  v_mfma_f32_32x32x16_bf16 v[64:79], v[36:39], a[60:63], v[64:79]
  ds_read_b64_tr_b16 v[20:21], v7 offset:0
  ds_read_b64_tr_b16 v[22:23], v7 offset:512
  s_waitcnt lgkmcnt(6)
  v_mfma_f32_32x32x16_bf16 v[80:95], v[40:43], a[60:63], v[80:95]
  ds_read_b64_tr_b16 v[24:25], v6 offset:8192
  ds_read_b64_tr_b16 v[26:27], v6 offset:8704
  s_waitcnt lgkmcnt(6)
  v_mfma_f32_32x32x16_bf16 v[96:111], v[44:47], a[60:63], v[96:111]
  ds_read_b64_tr_b16 v[28:29], v7 offset:8192
  ds_read_b64_tr_b16 v[30:31], v7 offset:8704
  s_waitcnt lgkmcnt(6)
  v_mfma_f32_32x32x16_bf16 v[48:63], v[16:19], a[64:67], v[48:63]
  ds_read_b64_tr_b16 v[32:33], v6 offset:2048
  ds_read_b64_tr_b16 v[34:35], v6 offset:2560
  s_waitcnt lgkmcnt(6)
  v_mfma_f32_32x32x16_bf16 v[64:79], v[20:23], a[64:67], v[64:79]
  ds_read_b64_tr_b16 v[36:37], v7 offset:2048
  ds_read_b64_tr_b16 v[38:39], v7 offset:2560
  s_waitcnt lgkmcnt(6)
  v_mfma_f32_32x32x16_bf16 v[80:95], v[24:27], a[64:67], v[80:95]
  ds_read_b64_tr_b16 v[40:41], v6 offset:10240
  ds_read_b64_tr_b16 v[42:43], v6 offset:10752
  s_waitcnt lgkmcnt(6)
  v_mfma_f32_32x32x16_bf16 v[96:111], v[28:31], a[64:67], v[96:111]
  ds_read_b64_tr_b16 v[44:45], v7 offset:10240
  ds_read_b64_tr_b16 v[46:47], v7 offset:10752
  s_waitcnt lgkmcnt(6)
  v_mfma_f32_32x32x16_bf16 v[48:63], v[32:35], a[68:71], v[48:63]
  s_waitcnt vmcnt(16)
  s_barrier
  s_cmp_lg_u32 s20, 0
  s_cbranch_scc1 L_nofl_t
  s_mov_b64 exec, 1
  buffer_store_dword v6, v3, s[4:7], s67 offen sc1
  s_mov_b64 exec, -1
L_nofl_t:
  ds_read_b64_tr_b16 v[16:17], v6 offset:4096
  ds_read_b64_tr_b16 v[18:19], v6 offset:4608
  s_waitcnt lgkmcnt(6)
  v_mfma_f32_32x32x16_bf16 v[64:79], v[36:39], a[68:71], v[64:79]
  ds_read_b64_tr_b16 v[20:21], v7 offset:4096
  ds_read_b64_tr_b16 v[22:23], v7 offset:4608
  s_add_u32 m0, s63, 49152
  s_nop 0
  buffer_load_dwordx4 v1, s[8:11], s60 offen lds
  s_waitcnt lgkmcnt(6)
  v_mfma_f32_32x32x16_bf16 v[80:95], v[40:43], a[68:71], v[80:95]
  ds_read_b64_tr_b16 v[24:25], v6 offset:12288
  ds_read_b64_tr_b16 v[26:27], v6 offset:12800
  s_add_u32 m0, s63, 50176
  s_add_u32 s58, s60, s62
  buffer_load_dwordx4 v1, s[8:11], s58 offen lds
  s_add_u32 s60, s60, s71
  s_waitcnt lgkmcnt(6)
  v_mfma_f32_32x32x16_bf16 v[96:111], v[44:47], a[68:71], v[96:111]
  ds_read_b64_tr_b16 v[28:29], v7 offset:12288
  ds_read_b64_tr_b16 v[30:31], v7 offset:12800
  s_add_u32 m0, s63, 57344
  s_nop 0
  buffer_load_dwordx4 v1, s[12:15], s61 offen lds
  s_waitcnt lgkmcnt(6)
  v_mfma_f32_32x32x16_bf16 v[48:63], v[16:19], a[72:75], v[48:63]
  ds_read_b64_tr_b16 v[32:33], v6 offset:6144
  ds_read_b64_tr_b16 v[34:35], v6 offset:6656
  s_add_u32 m0, s63, 58368
  s_add_u32 s58, s61, s62
  buffer_load_dwordx4 v1, s[12:15], s58 offen lds
  s_add_u32 s61, s61, s71
  s_waitcnt lgkmcnt(6)
  v_mfma_f32_32x32x16_bf16 v[64:79], v[20:23], a[72:75], v[64:79]
  ds_read_b64_tr_b16 v[36:37], v7 offset:6144
  ds_read_b64_tr_b16 v[38:39], v7 offset:6656
  s_waitcnt lgkmcnt(6)
  v_mfma_f32_32x32x16_bf16 v[80:95], v[24:27], a[72:75], v[80:95]
  ds_read_b64_tr_b16 v[40:41], v6 offset:14336
  ds_read_b64_tr_b16 v[42:43], v6 offset:14848
  s_waitcnt lgkmcnt(6)
  v_mfma_f32_32x32x16_bf16 v[96:111], v[28:31], a[72:75], v[96:111]
  ds_read_b64_tr_b16 v[44:45], v7 offset:14336
  ds_read_b64_tr_b16 v[46:47], v7 offset:14848
  s_waitcnt lgkmcnt(6)
  v_mfma_f32_32x32x16_bf16 v[48:63], v[32:35], a[76:79], v[48:63]
  ds_read_b64_tr_b16 v[16:17], v6 offset:16384
  ds_read_b64_tr_b16 v[18:19], v6 offset:16896
  s_waitcnt lgkmcnt(6)
  v_mfma_f32_32x32x16_bf16 v[64:79], v[36:39], a[76:79], v[64:79]
  ds_read_b64_tr_b16 v[20:21], v7 offset:16384
  ds_read_b64_tr_b16 v[22:23], v7 offset:16896
  s_waitcnt lgkmcnt(6)
  v_mfma_f32_32x32x16_bf16 v[80:95], v[40:43], a[76:79], v[80:95]
  ds_read_b64_tr_b16 v[24:25], v6 offset:24576
  ds_read_b64_tr_b16 v[26:27], v6 offset:25088
  s_waitcnt lgkmcnt(6)
  v_mfma_f32_32x32x16_bf16 v[96:111], v[44:47], a[76:79], v[96:111]
  ds_read_b64_tr_b16 v[28:29], v7 offset:24576
  ds_read_b64_tr_b16 v[30:31], v7 offset:25088
  s_waitcnt lgkmcnt(6)
  v_mfma_f32_32x32x16_bf16 v[48:63], v[16:19], a[80:83], v[48:63]
  ds_read_b64_tr_b16 v[32:33], v6 offset:18432
  ds_read_b64_tr_b16 v[34:35], v6 offset:18944
  s_waitcnt lgkmcnt(6)
  v_mfma_f32_32x32x16_bf16 v[64:79], v[20:23], a[80:83], v[64:79]
  ds_read_b64_tr_b16 v[36:37], v7 offset:18432
  ds_read_b64_tr_b16 v[38:39], v7 offset:18944
  s_waitcnt lgkmcnt(6)
  v_mfma_f32_32x32x16_bf16 v[80:95], v[24:27], a[80:83], v[80:95]
  ds_read_b64_tr_b16 v[40:41], v6 offset:26624
  ds_read_b64_tr_b16 v[42:43], v6 offset:27136
  s_waitcnt lgkmcnt(6)
  v_mfma_f32_32x32x16_bf16 v[96:111], v[28:31], a[80:83], v[96:111]
  ds_read_b64_tr_b16 v[44:45], v7 offset:26624
  ds_read_b64_tr_b16 v[46:47], v7 offset:27136
  s_waitcnt lgkmcnt(6)
  v_mfma_f32_32x32x16_bf16 v[48:63], v[32:35], a[84:87], v[48:63]
  s_waitcnt vmcnt(24)
  s_barrier
  ds_read_b64_tr_b16 v[16:17], v6 offset:20480
  ds_read_b64_tr_b16 v[18:19], v6 offset:20992
  s_waitcnt lgkmcnt(6)
  v_mfma_f32_32x32x16_bf16 v[64:79], v[36:39], a[84:87], v[64:79]
  ds_read_b64_tr_b16 v[20:21], v7 offset:20480
  ds_read_b64_tr_b16 v[22:23], v7 offset:20992
  s_add_u32 m0, s63, 65536
  s_nop 0
  buffer_load_dwordx4 v1, s[8:11], s60 offen lds
  s_waitcnt lgkmcnt(6)
  v_mfma_f32_32x32x16_bf16 v[80:95], v[40:43], a[84:87], v[80:95]
  ds_read_b64_tr_b16 v[24:25], v6 offset:28672
  ds_read_b64_tr_b16 v[26:27], v6 offset:29184
  s_add_u32 m0, s63, 66560
  s_add_u32 s58, s60, s62
  buffer_load_dwordx4 v1, s[8:11], s58 offen lds
  s_add_u32 s60, s60, s71
  s_waitcnt lgkmcnt(6)
  v_mfma_f32_32x32x16_bf16 v[96:111], v[44:47], a[84:87], v[96:111]
  ds_read_b64_tr_b16 v[28:29], v7 offset:28672
  ds_read_b64_tr_b16 v[30:31], v7 offset:29184
  s_add_u32 m0, s63, 73728
  s_nop 0
  buffer_load_dwordx4 v1, s[12:15], s61 offen lds
  s_waitcnt lgkmcnt(6)
  v_mfma_f32_32x32x16_bf16 v[48:63], v[16:19], a[88:91], v[48:63]
  ds_read_b64_tr_b16 v[32:33], v6 offset:22528
  ds_read_b64_tr_b16 v[34:35], v6 offset:23040
  s_add_u32 m0, s63, 74752
  s_add_u32 s58, s61, s62
  buffer_load_dwordx4 v1, s[12:15], s58 offen lds
  s_add_u32 s61, s61, s71
  s_waitcnt lgkmcnt(6)
  v_mfma_f32_32x32x16_bf16 v[64:79], v[20:23], a[88:91], v[64:79]
  ds_read_b64_tr_b16 v[36:37], v7 offset:22528
  ds_read_b64_tr_b16 v[38:39], v7 offset:23040
  s_waitcnt lgkmcnt(6)
  v_mfma_f32_32x32x16_bf16 v[80:95], v[24:27], a[88:91], v[80:95]
  ds_read_b64_tr_b16 v[40:41], v6 offset:30720
  ds_read_b64_tr_b16 v[42:43], v6 offset:31232
  s_waitcnt lgkmcnt(6)
  v_mfma_f32_32x32x16_bf16 v[96:111], v[28:31], a[88:91], v[96:111]
  ds_read_b64_tr_b16 v[44:45], v7 offset:30720
  ds_read_b64_tr_b16 v[46:47], v7 offset:31232
  s_waitcnt lgkmcnt(6)
  v_mfma_f32_32x32x16_bf16 v[48:63], v[32:35], a[92:95], v[48:63]
  ds_read_b64_tr_b16 v[16:17], v6 offset:32768
  ds_read_b64_tr_b16 v[18:19], v6 offset:33280
  s_waitcnt lgkmcnt(6)
  v_mfma_f32_32x32x16_bf16 v[64:79], v[36:39], a[92:95], v[64:79]
  ds_read_b64_tr_b16 v[20:21], v7 offset:32768
  ds_read_b64_tr_b16 v[22:23], v7 offset:33280
  s_waitcnt lgkmcnt(6)
  v_mfma_f32_32x32x16_bf16 v[80:95], v[40:43], a[92:95], v[80:95]
  ds_read_b64_tr_b16 v[24:25], v6 offset:40960
  ds_read_b64_tr_b16 v[26:27], v6 offset:41472
  s_waitcnt lgkmcnt(6)
  v_mfma_f32_32x32x16_bf16 v[96:111], v[44:47], a[92:95], v[96:111]
  ds_read_b64_tr_b16 v[28:29], v7 offset:40960
  ds_read_b64_tr_b16 v[30:31], v7 offset:41472
  s_waitcnt lgkmcnt(6)
  v_mfma_f32_32x32x16_bf16 v[48:63], v[16:19], a[96:99], v[48:63]
  ds_read_b64_tr_b16 v[32:33], v6 offset:34816
  ds_read_b64_tr_b16 v[34:35], v6 offset:35328
  s_waitcnt lgkmcnt(6)
  v_mfma_f32_32x32x16_bf16 v[64:79], v[20:23], a[96:99], v[64:79]
  ds_read_b64_tr_b16 v[36:37], v7 offset:34816
  ds_read_b64_tr_b16 v[38:39], v7 offset:35328
  s_waitcnt lgkmcnt(6)
  v_mfma_f32_32x32x16_bf16 v[80:95], v[24:27], a[96:99], v[80:95]
  ds_read_b64_tr_b16 v[40:41], v6 offset:43008
  ds_read_b64_tr_b16 v[42:43], v6 offset:43520
  s_waitcnt lgkmcnt(6)
  v_mfma_f32_32x32x16_bf16 v[96:111], v[28:31], a[96:99], v[96:111]
  ds_read_b64_tr_b16 v[44:45], v7 offset:43008
  ds_read_b64_tr_b16 v[46:47], v7 offset:43520
  s_waitcnt lgkmcnt(6)
  v_mfma_f32_32x32x16_bf16 v[48:63], v[32:35], a[100:103], v[48:63]
  s_waitcnt vmcnt(24)
  s_barrier
  ds_read_b64_tr_b16 v[16:17], v6 offset:36864
  ds_read_b64_tr_b16 v[18:19], v6 offset:37376
  s_waitcnt lgkmcnt(6)
  v_mfma_f32_32x32x16_bf16 v[64:79], v[36:39], a[100:103], v[64:79]
  ds_read_b64_tr_b16 v[20:21], v7 offset:36864
  ds_read_b64_tr_b16 v[22:23], v7 offset:37376
  s_add_u32 m0, s63, 81920
  s_nop 0
  buffer_load_dwordx4 v1, s[8:11], s60 offen lds
  s_waitcnt lgkmcnt(6)
  v_mfma_f32_32x32x16_bf16 v[80:95], v[40:43], a[100:103], v[80:95]
  ds_read_b64_tr_b16 v[24:25], v6 offset:45056
  ds_read_b64_tr_b16 v[26:27], v6 offset:45568
  s_add_u32 m0, s63, 82944
  s_add_u32 s58, s60, s62
  buffer_load_dwordx4 v1, s[8:11], s58 offen lds
  s_add_u32 s60, s60, s71
  s_waitcnt lgkmcnt(6)
  v_mfma_f32_32x32x16_bf16 v[96:111], v[44:47], a[100:103], v[96:111]
  ds_read_b64_tr_b16 v[28:29], v7 offset:45056
  ds_read_b64_tr_b16 v[30:31], v7 offset:45568
  s_add_u32 m0, s63, 90112
  s_nop 0
  buffer_load_dwordx4 v1, s[12:15], s61 offen lds
  s_waitcnt lgkmcnt(6)
  v_mfma_f32_32x32x16_bf16 v[48:63], v[16:19], a[104:107], v[48:63]
  ds_read_b64_tr_b16 v[32:33], v6 offset:38912
  ds_read_b64_tr_b16 v[34:35], v6 offset:39424
  s_add_u32 m0, s63, 91136
  s_add_u32 s58, s61, s62
  buffer_load_dwordx4 v1, s[12:15], s58 offen lds
  s_add_u32 s61, s61, s71
  s_waitcnt lgkmcnt(6)
  v_mfma_f32_32x32x16_bf16 v[64:79], v[20:23], a[104:107], v[64:79]
  ds_read_b64_tr_b16 v[36:37], v7 offset:38912
  ds_read_b64_tr_b16 v[38:39], v7 offset:39424
  s_waitcnt lgkmcnt(6)
  v_mfma_f32_32x32x16_bf16 v[80:95], v[24:27], a[104:107], v[80:95]
  ds_read_b64_tr_b16 v[40:41], v6 offset:47104
  ds_read_b64_tr_b16 v[42:43], v6 offset:47616
  s_waitcnt lgkmcnt(6)
  v_mfma_f32_32x32x16_bf16 v[96:111], v[28:31], a[104:107], v[96:111]
  ds_read_b64_tr_b16 v[44:45], v7 offset:47104
  ds_read_b64_tr_b16 v[46:47], v7 offset:47616
  s_waitcnt lgkmcnt(6)
  v_mfma_f32_32x32x16_bf16 v[48:63], v[32:35], a[108:111], v[48:63]
  ds_read_b64_tr_b16 v[16:17], v6 offset:49152
  ds_read_b64_tr_b16 v[18:19], v6 offset:49664
  s_waitcnt lgkmcnt(6)
  v_mfma_f32_32x32x16_bf16 v[64:79], v[36:39], a[108:111], v[64:79]
  ds_read_b64_tr_b16 v[20:21], v7 offset:49152
  ds_read_b64_tr_b16 v[22:23], v7 offset:49664
  s_waitcnt lgkmcnt(6)
  v_mfma_f32_32x32x16_bf16 v[80:95], v[40:43], a[108:111], v[80:95]
  ds_read_b64_tr_b16 v[24:25], v6 offset:57344
  ds_read_b64_tr_b16 v[26:27], v6 offset:57856
  s_waitcnt lgkmcnt(6)
  v_mfma_f32_32x32x16_bf16 v[96:111], v[44:47], a[108:111], v[96:111]
  ds_read_b64_tr_b16 v[28:29], v7 offset:57344
  ds_read_b64_tr_b16 v[30:31], v7 offset:57856
  s_waitcnt lgkmcnt(6)
  v_mfma_f32_32x32x16_bf16 v[48:63], v[16:19], a[112:115], v[48:63]
  ds_read_b64_tr_b16 v[32:33], v6 offset:51200
  ds_read_b64_tr_b16 v[34:35], v6 offset:51712
  s_waitcnt lgkmcnt(6)
  v_mfma_f32_32x32x16_bf16 v[64:79], v[20:23], a[112:115], v[64:79]
  ds_read_b64_tr_b16 v[36:37], v7 offset:51200
  ds_read_b64_tr_b16 v[38:39], v7 offset:51712
  s_waitcnt lgkmcnt(6)
  v_mfma_f32_32x32x16_bf16 v[80:95], v[24:27], a[112:115], v[80:95]
  ds_read_b64_tr_b16 v[40:41], v6 offset:59392
  ds_read_b64_tr_b16 v[42:43], v6 offset:59904
  s_waitcnt lgkmcnt(6)
  v_mfma_f32_32x32x16_bf16 v[96:111], v[28:31], a[112:115], v[96:111]
  ds_read_b64_tr_b16 v[44:45], v7 offset:59392
  ds_read_b64_tr_b16 v[46:47], v7 offset:59904
  s_waitcnt lgkmcnt(6)
  v_mfma_f32_32x32x16_bf16 v[48:63], v[32:35], a[116:119], v[48:63]
  s_waitcnt vmcnt(24)
  s_barrier
  ds_read_b64_tr_b16 v[16:17], v6 offset:53248
  ds_read_b64_tr_b16 v[18:19], v6 offset:53760
  s_waitcnt lgkmcnt(6)
  v_mfma_f32_32x32x16_bf16 v[64:79], v[36:39], a[116:119], v[64:79]
  ds_read_b64_tr_b16 v[20:21], v7 offset:53248
  ds_read_b64_tr_b16 v[22:23], v7 offset:53760
  s_add_u32 m0, s63, 98304
  s_nop 0
  buffer_load_dwordx4 v1, s[8:11], s60 offen lds
  s_waitcnt lgkmcnt(6)
  v_mfma_f32_32x32x16_bf16 v[80:95], v[40:43], a[116:119], v[80:95]
  ds_read_b64_tr_b16 v[24:25], v6 offset:61440
  ds_read_b64_tr_b16 v[26:27], v6 offset:61952
  s_add_u32 m0, s63, 99328
  s_add_u32 s58, s60, s62
  buffer_load_dwordx4 v1, s[8:11], s58 offen lds
  s_add_u32 s60, s60, s71
  s_waitcnt lgkmcnt(6)
  v_mfma_f32_32x32x16_bf16 v[96:111], v[44:47], a[116:119], v[96:111]
  ds_read_b64_tr_b16 v[28:29], v7 offset:61440
  ds_read_b64_tr_b16 v[30:31], v7 offset:61952
  s_add_u32 m0, s63, 106496
  s_nop 0
  buffer_load_dwordx4 v1, s[12:15], s61 offen lds
  s_waitcnt lgkmcnt(6)
  v_mfma_f32_32x32x16_bf16 v[48:63], v[16:19], a[120:123], v[48:63]
  ds_read_b64_tr_b16 v[32:33], v6 offset:55296
  ds_read_b64_tr_b16 v[34:35], v6 offset:55808
  s_add_u32 m0, s63, 107520
  s_add_u32 s58, s61, s62
  buffer_load_dwordx4 v1, s[12:15], s58 offen lds
  s_add_u32 s61, s61, s71
  s_waitcnt lgkmcnt(6)
  v_mfma_f32_32x32x16_bf16 v[64:79], v[20:23], a[120:123], v[64:79]
  ds_read_b64_tr_b16 v[36:37], v7 offset:55296
  ds_read_b64_tr_b16 v[38:39], v7 offset:55808
  s_waitcnt lgkmcnt(6)
  v_mfma_f32_32x32x16_bf16 v[80:95], v[24:27], a[120:123], v[80:95]
  ds_read_b64_tr_b16 v[40:41], v6 offset:63488
  ds_read_b64_tr_b16 v[42:43], v6 offset:64000
  s_waitcnt lgkmcnt(6)
  v_mfma_f32_32x32x16_bf16 v[96:111], v[28:31], a[120:123], v[96:111]
  ds_read_b64_tr_b16 v[44:45], v7 offset:63488
  ds_read_b64_tr_b16 v[46:47], v7 offset:64000
  s_waitcnt lgkmcnt(6)
  v_mfma_f32_32x32x16_bf16 v[48:63], v[32:35], a[124:127], v[48:63]
  ds_read_b64_tr_b16 v[16:17], v8 offset:0
  ds_read_b64_tr_b16 v[18:19], v8 offset:512
  s_waitcnt lgkmcnt(6)
  v_mfma_f32_32x32x16_bf16 v[64:79], v[36:39], a[124:127], v[64:79]
  ds_read_b64_tr_b16 v[20:21], v9 offset:0
  ds_read_b64_tr_b16 v[22:23], v9 offset:512
  s_waitcnt lgkmcnt(6)
  v_mfma_f32_32x32x16_bf16 v[80:95], v[40:43], a[124:127], v[80:95]
  ds_read_b64_tr_b16 v[24:25], v8 offset:8192
  ds_read_b64_tr_b16 v[26:27], v8 offset:8704
  s_waitcnt lgkmcnt(6)
  v_mfma_f32_32x32x16_bf16 v[96:111], v[44:47], a[124:127], v[96:111]
  ds_read_b64_tr_b16 v[28:29], v9 offset:8192
  ds_read_b64_tr_b16 v[30:31], v9 offset:8704
  s_waitcnt lgkmcnt(6)
  v_mfma_f32_32x32x16_bf16 v[48:63], v[16:19], a[128:131], v[48:63]
  ds_read_b64_tr_b16 v[32:33], v8 offset:2048
  ds_read_b64_tr_b16 v[34:35], v8 offset:2560
  s_waitcnt lgkmcnt(6)
  v_mfma_f32_32x32x16_bf16 v[64:79], v[20:23], a[128:131], v[64:79]
  ds_read_b64_tr_b16 v[36:37], v9 offset:2048
  ds_read_b64_tr_b16 v[38:39], v9 offset:2560
  s_waitcnt lgkmcnt(6)
  v_mfma_f32_32x32x16_bf16 v[80:95], v[24:27], a[128:131], v[80:95]
  ds_read_b64_tr_b16 v[40:41], v8 offset:10240
  ds_read_b64_tr_b16 v[42:43], v8 offset:10752
  s_waitcnt lgkmcnt(6)
  v_mfma_f32_32x32x16_bf16 v[96:111], v[28:31], a[128:131], v[96:111]
  ds_read_b64_tr_b16 v[44:45], v9 offset:10240
  ds_read_b64_tr_b16 v[46:47], v9 offset:10752
  s_waitcnt lgkmcnt(6)
  v_mfma_f32_32x32x16_bf16 v[48:63], v[32:35], a[132:135], v[48:63]
  s_waitcnt vmcnt(24)
  s_barrier
  ds_read_b64_tr_b16 v[16:17], v8 offset:4096
  ds_read_b64_tr_b16 v[18:19], v8 offset:4608
  s_waitcnt lgkmcnt(6)
  v_mfma_f32_32x32x16_bf16 v[64:79], v[36:39], a[132:135], v[64:79]
  ds_read_b64_tr_b16 v[20:21], v9 offset:4096
  ds_read_b64_tr_b16 v[22:23], v9 offset:4608
  s_add_u32 m0, s63, 114688
  s_nop 0
  buffer_load_dwordx4 v1, s[8:11], s60 offen lds
  s_waitcnt lgkmcnt(6)
  v_mfma_f32_32x32x16_bf16 v[80:95], v[40:43], a[132:135], v[80:95]
  ds_read_b64_tr_b16 v[24:25], v8 offset:12288
  ds_read_b64_tr_b16 v[26:27], v8 offset:12800
  s_add_u32 m0, s63, 115712
  s_add_u32 s58, s60, s62
  buffer_load_dwordx4 v1, s[8:11], s58 offen lds
  s_add_u32 s60, s60, s71
  s_waitcnt lgkmcnt(6)
  v_mfma_f32_32x32x16_bf16 v[96:111], v[44:47], a[132:135], v[96:111]
  ds_read_b64_tr_b16 v[28:29], v9 offset:12288
  ds_read_b64_tr_b16 v[30:31], v9 offset:12800
  s_add_u32 m0, s63, 122880
  s_nop 0
  buffer_load_dwordx4 v1, s[12:15], s61 offen lds
  s_waitcnt lgkmcnt(6)
  v_mfma_f32_32x32x16_bf16 v[48:63], v[16:19], a[136:139], v[48:63]
  ds_read_b64_tr_b16 v[32:33], v8 offset:6144
  ds_read_b64_tr_b16 v[34:35], v8 offset:6656
  s_add_u32 m0, s63, 123904
  s_add_u32 s58, s61, s62
  buffer_load_dwordx4 v1, s[12:15], s58 offen lds
  s_add_u32 s61, s61, s71
  s_waitcnt lgkmcnt(6)
  v_mfma_f32_32x32x16_bf16 v[64:79], v[20:23], a[136:139], v[64:79]
  ds_read_b64_tr_b16 v[36:37], v9 offset:6144
  ds_read_b64_tr_b16 v[38:39], v9 offset:6656
  s_waitcnt lgkmcnt(6)
  v_mfma_f32_32x32x16_bf16 v[80:95], v[24:27], a[136:139], v[80:95]
  ds_read_b64_tr_b16 v[40:41], v8 offset:14336
  ds_read_b64_tr_b16 v[42:43], v8 offset:14848
  s_waitcnt lgkmcnt(6)
  v_mfma_f32_32x32x16_bf16 v[96:111], v[28:31], a[136:139], v[96:111]
  ds_read_b64_tr_b16 v[44:45], v9 offset:14336
  ds_read_b64_tr_b16 v[46:47], v9 offset:14848
  s_waitcnt lgkmcnt(6)
  v_mfma_f32_32x32x16_bf16 v[48:63], v[32:35], a[140:143], v[48:63]
  ds_read_b64_tr_b16 v[16:17], v4 offset:0
  ds_read_b64_tr_b16 v[18:19], v4 offset:512
  s_waitcnt lgkmcnt(6)
  v_mfma_f32_32x32x16_bf16 v[64:79], v[36:39], a[140:143], v[64:79]
  ds_read_b64_tr_b16 v[20:21], v5 offset:0
  ds_read_b64_tr_b16 v[22:23], v5 offset:512
  s_waitcnt lgkmcnt(6)
  v_mfma_f32_32x32x16_bf16 v[80:95], v[40:43], a[140:143], v[80:95]
  ds_read_b64_tr_b16 v[24:25], v4 offset:8192
  ds_read_b64_tr_b16 v[26:27], v4 offset:8704
  s_waitcnt lgkmcnt(6)
  v_mfma_f32_32x32x16_bf16 v[96:111], v[44:47], a[140:143], v[96:111]
  ds_read_b64_tr_b16 v[28:29], v5 offset:8192
  ds_read_b64_tr_b16 v[30:31], v5 offset:8704
  s_cmp_eq_u32 s64, 2
  s_cbranch_scc0 L_ep_store
  s_mov_b32 s72, 0xc0135761
  s_mov_b32 s73, 0xbdd2d3e8
  v_mov_b32 v152, s72
  v_mul_f32 v112, v48, v48
  v_mul_f32 v113, v49, v49
  v_mul_f32 v114, v50, v50
  v_mul_f32 v115, v51, v51
  v_fma_f32 v112, v112, s73, v152
  v_fma_f32 v113, v113, s73, v152
  v_fma_f32 v114, v114, s73, v152
  v_fma_f32 v115, v115, s73, v152
  v_mul_f32 v112, v112, v48
  v_mul_f32 v113, v113, v49
  v_mul_f32 v114, v114, v50
  v_mul_f32 v115, v115, v51
  v_exp_f32 v112, v112
  v_exp_f32 v113, v113
  v_exp_f32 v114, v114
  v_exp_f32 v115, v115
  v_mul_f32 v48, v48, v80
  v_mul_f32 v49, v49, v81
  v_mul_f32 v50, v50, v82
  v_mul_f32 v51, v51, v83
  v_add_f32 v112, 1.0, v112
  v_add_f32 v113, 1.0, v113
  v_add_f32 v114, 1.0, v114
  v_add_f32 v115, 1.0, v115
  v_rcp_f32 v112, v112
  v_rcp_f32 v113, v113
  v_rcp_f32 v114, v114
  v_rcp_f32 v115, v115
  s_nop 0
  v_mul_f32 v48, v48, v112
  v_mul_f32 v49, v49, v113
  v_mul_f32 v50, v50, v114
  v_mul_f32 v51, v51, v115
  v_mul_f32 v112, v52, v52
  v_mul_f32 v113, v53, v53
  v_mul_f32 v114, v54, v54
  v_mul_f32 v115, v55, v55
  v_fma_f32 v112, v112, s73, v152
  v_fma_f32 v113, v113, s73, v152
  v_fma_f32 v114, v114, s73, v152
  v_fma_f32 v115, v115, s73, v152
  v_mul_f32 v112, v112, v52
  v_mul_f32 v113, v113, v53
  v_mul_f32 v114, v114, v54
  v_mul_f32 v115, v115, v55
  v_exp_f32 v112, v112
  v_exp_f32 v113, v113
  v_exp_f32 v114, v114
  v_exp_f32 v115, v115
  v_mul_f32 v52, v52, v84
  v_mul_f32 v53, v53, v85
  v_mul_f32 v54, v54, v86
  v_mul_f32 v55, v55, v87
  v_add_f32 v112, 1.0, v112
  v_add_f32 v113, 1.0, v113
  v_add_f32 v114, 1.0, v114
  v_add_f32 v115, 1.0, v115
  v_rcp_f32 v112, v112
  v_rcp_f32 v113, v113
  v_rcp_f32 v114, v114
  v_rcp_f32 v115, v115
  s_nop 0
  v_mul_f32 v52, v52, v112
  v_mul_f32 v53, v53, v113
  v_mul_f32 v54, v54, v114
  v_mul_f32 v55, v55, v115
  v_mul_f32 v112, v56, v56
  v_mul_f32 v113, v57, v57
  v_mul_f32 v114, v58, v58
  v_mul_f32 v115, v59, v59
  v_fma_f32 v112, v112, s73, v152
  v_fma_f32 v113, v113, s73, v152
  v_fma_f32 v114, v114, s73, v152
  v_fma_f32 v115, v115, s73, v152
  v_mul_f32 v112, v112, v56
  v_mul_f32 v113, v113, v57
  v_mul_f32 v114, v114, v58
  v_mul_f32 v115, v115, v59
  v_exp_f32 v112, v112
  v_exp_f32 v113, v113
  v_exp_f32 v114, v114
  v_exp_f32 v115, v115
  v_mul_f32 v56, v56, v88
  v_mul_f32 v57, v57, v89
  v_mul_f32 v58, v58, v90
  v_mul_f32 v59, v59, v91
  v_add_f32 v112, 1.0, v112
  v_add_f32 v113, 1.0, v113
  v_add_f32 v114, 1.0, v114
  v_add_f32 v115, 1.0, v115
  v_rcp_f32 v112, v112
  v_rcp_f32 v113, v113
  v_rcp_f32 v114, v114
  v_rcp_f32 v115, v115
  s_nop 0
  v_mul_f32 v56, v56, v112
  v_mul_f32 v57, v57, v113
  v_mul_f32 v58, v58, v114
  v_mul_f32 v59, v59, v115
  v_mul_f32 v112, v60, v60
  v_mul_f32 v113, v61, v61
  v_mul_f32 v114, v62, v62
  v_mul_f32 v115, v63, v63
  v_fma_f32 v112, v112, s73, v152
  v_fma_f32 v113, v113, s73, v152
  v_fma_f32 v114, v114, s73, v152
  v_fma_f32 v115, v115, s73, v152
  v_mul_f32 v112, v112, v60
  v_mul_f32 v113, v113, v61
  v_mul_f32 v114, v114, v62
  v_mul_f32 v115, v115, v63
  v_exp_f32 v112, v112
  v_exp_f32 v113, v113
  v_exp_f32 v114, v114
  v_exp_f32 v115, v115
  v_mul_f32 v60, v60, v92
  v_mul_f32 v61, v61, v93
  v_mul_f32 v62, v62, v94
  v_mul_f32 v63, v63, v95
  v_add_f32 v112, 1.0, v112
  v_add_f32 v113, 1.0, v113
  v_add_f32 v114, 1.0, v114
  v_add_f32 v115, 1.0, v115
  v_rcp_f32 v112, v112
  v_rcp_f32 v113, v113
  v_rcp_f32 v114, v114
  v_rcp_f32 v115, v115
  s_nop 0
  v_mul_f32 v60, v60, v112
  v_mul_f32 v61, v61, v113
  v_mul_f32 v62, v62, v114
  v_mul_f32 v63, v63, v115
  v_cvt_pk_bf16_f32 v120, v48, v49
  v_cvt_pk_bf16_f32 v121, v50, v51
  v_cvt_pk_bf16_f32 v122, v56, v57
  v_cvt_pk_bf16_f32 v123, v58, v59
  buffer_store_dwordx4 v[120:123], v3, s[4:7], s65 offen offset:0 sc1
  v_cvt_pk_bf16_f32 v124, v52, v53
  v_cvt_pk_bf16_f32 v125, v54, v55
  v_cvt_pk_bf16_f32 v126, v60, v61
  v_cvt_pk_bf16_f32 v127, v62, v63
  buffer_store_dwordx4 v[124:127], v3, s[4:7], s65 offen offset:1024 sc1
  v_mul_f32 v112, v64, v64
  v_mul_f32 v113, v65, v65
  v_mul_f32 v114, v66, v66
  v_mul_f32 v115, v67, v67
  v_fma_f32 v112, v112, s73, v152
  v_fma_f32 v113, v113, s73, v152
  v_fma_f32 v114, v114, s73, v152
  v_fma_f32 v115, v115, s73, v152
  v_mul_f32 v112, v112, v64
  v_mul_f32 v113, v113, v65
  v_mul_f32 v114, v114, v66
  v_mul_f32 v115, v115, v67
  v_exp_f32 v112, v112
  v_exp_f32 v113, v113
  v_exp_f32 v114, v114
  v_exp_f32 v115, v115
  v_mul_f32 v64, v64, v96
  v_mul_f32 v65, v65, v97
  v_mul_f32 v66, v66, v98
  v_mul_f32 v67, v67, v99
  v_add_f32 v112, 1.0, v112
  v_add_f32 v113, 1.0, v113
  v_add_f32 v114, 1.0, v114
  v_add_f32 v115, 1.0, v115
  v_rcp_f32 v112, v112
  v_rcp_f32 v113, v113
  v_rcp_f32 v114, v114
  v_rcp_f32 v115, v115
  s_nop 0
  v_mul_f32 v64, v64, v112
  v_mul_f32 v65, v65, v113
  v_mul_f32 v66, v66, v114
  v_mul_f32 v67, v67, v115
  v_mul_f32 v112, v68, v68
  v_mul_f32 v113, v69, v69
  v_mul_f32 v114, v70, v70
  v_mul_f32 v115, v71, v71
  v_fma_f32 v112, v112, s73, v152
  v_fma_f32 v113, v113, s73, v152
  v_fma_f32 v114, v114, s73, v152
  v_fma_f32 v115, v115, s73, v152
  v_mul_f32 v112, v112, v68
  v_mul_f32 v113, v113, v69
  v_mul_f32 v114, v114, v70
  v_mul_f32 v115, v115, v71
  v_exp_f32 v112, v112
  v_exp_f32 v113, v113
  v_exp_f32 v114, v114
  v_exp_f32 v115, v115
  v_mul_f32 v68, v68, v100
  v_mul_f32 v69, v69, v101
  v_mul_f32 v70, v70, v102
  v_mul_f32 v71, v71, v103
  v_add_f32 v112, 1.0, v112
  v_add_f32 v113, 1.0, v113
  v_add_f32 v114, 1.0, v114
  v_add_f32 v115, 1.0, v115
  v_rcp_f32 v112, v112
  v_rcp_f32 v113, v113
  v_rcp_f32 v114, v114
  v_rcp_f32 v115, v115
  s_nop 0
  v_mul_f32 v68, v68, v112
  v_mul_f32 v69, v69, v113
  v_mul_f32 v70, v70, v114
  v_mul_f32 v71, v71, v115
  v_mul_f32 v112, v72, v72
  v_mul_f32 v113, v73, v73
  v_mul_f32 v114, v74, v74
  v_mul_f32 v115, v75, v75
  v_fma_f32 v112, v112, s73, v152
  v_fma_f32 v113, v113, s73, v152
  v_fma_f32 v114, v114, s73, v152
  v_fma_f32 v115, v115, s73, v152
  v_mul_f32 v112, v112, v72
  v_mul_f32 v113, v113, v73
  v_mul_f32 v114, v114, v74
  v_mul_f32 v115, v115, v75
  v_exp_f32 v112, v112
  v_exp_f32 v113, v113
  v_exp_f32 v114, v114
  v_exp_f32 v115, v115
  v_mul_f32 v72, v72, v104
  v_mul_f32 v73, v73, v105
  v_mul_f32 v74, v74, v106
  v_mul_f32 v75, v75, v107
  v_add_f32 v112, 1.0, v112
  v_add_f32 v113, 1.0, v113
  v_add_f32 v114, 1.0, v114
  v_add_f32 v115, 1.0, v115
  v_rcp_f32 v112, v112
  v_rcp_f32 v113, v113
  v_rcp_f32 v114, v114
  v_rcp_f32 v115, v115
  s_nop 0
  v_mul_f32 v72, v72, v112
  v_mul_f32 v73, v73, v113
  v_mul_f32 v74, v74, v114
  v_mul_f32 v75, v75, v115
  v_mul_f32 v112, v76, v76
  v_mul_f32 v113, v77, v77
  v_mul_f32 v114, v78, v78
  v_mul_f32 v115, v79, v79
  v_fma_f32 v112, v112, s73, v152
  v_fma_f32 v113, v113, s73, v152
  v_fma_f32 v114, v114, s73, v152
  v_fma_f32 v115, v115, s73, v152
  v_mul_f32 v112, v112, v76
  v_mul_f32 v113, v113, v77
  v_mul_f32 v114, v114, v78
  v_mul_f32 v115, v115, v79
  v_exp_f32 v112, v112
  v_exp_f32 v113, v113
  v_exp_f32 v114, v114
  v_exp_f32 v115, v115
  v_mul_f32 v76, v76, v108
  v_mul_f32 v77, v77, v109
  v_mul_f32 v78, v78, v110
  v_mul_f32 v79, v79, v111
  v_add_f32 v112, 1.0, v112
  v_add_f32 v113, 1.0, v113
  v_add_f32 v114, 1.0, v114
  v_add_f32 v115, 1.0, v115
  v_rcp_f32 v112, v112
  v_rcp_f32 v113, v113
  v_rcp_f32 v114, v114
  v_rcp_f32 v115, v115
  s_nop 0
  v_mul_f32 v76, v76, v112
  v_mul_f32 v77, v77, v113
  v_mul_f32 v78, v78, v114
  v_mul_f32 v79, v79, v115
  v_cvt_pk_bf16_f32 v128, v64, v65
  v_cvt_pk_bf16_f32 v129, v66, v67
  v_cvt_pk_bf16_f32 v130, v72, v73
  v_cvt_pk_bf16_f32 v131, v74, v75
  buffer_store_dwordx4 v[128:131], v3, s[4:7], s65 offen offset:2048 sc1
  v_cvt_pk_bf16_f32 v132, v68, v69
  v_cvt_pk_bf16_f32 v133, v70, v71
  v_cvt_pk_bf16_f32 v134, v76, v77
  v_cvt_pk_bf16_f32 v135, v78, v79
  buffer_store_dwordx4 v[132:135], v3, s[4:7], s65 offen offset:3072 sc1
  s_branch L_unit_end
L_unit_n:
  s_waitcnt lgkmcnt(6)
  v_mfma_f32_32x32x16_bf16 v[48:63], a[0:3], v[16:19], 0
  ds_read_b64_tr_b16 v[32:33], v4 offset:2048
  ds_read_b64_tr_b16 v[34:35], v4 offset:2560
  s_waitcnt lgkmcnt(6)
  v_mfma_f32_32x32x16_bf16 v[64:79], a[0:3], v[20:23], 0
  ds_read_b64_tr_b16 v[36:37], v5 offset:2048
  ds_read_b64_tr_b16 v[38:39], v5 offset:2560
  s_waitcnt lgkmcnt(6)
  v_mfma_f32_32x32x16_bf16 v[80:95], a[0:3], v[24:27], 0
  ds_read_b64_tr_b16 v[40:41], v4 offset:10240
  ds_read_b64_tr_b16 v[42:43], v4 offset:10752
  s_waitcnt lgkmcnt(6)
  v_mfma_f32_32x32x16_bf16 v[96:111], a[0:3], v[28:31], 0
  ds_read_b64_tr_b16 v[44:45], v5 offset:10240
  ds_read_b64_tr_b16 v[46:47], v5 offset:10752
  s_waitcnt lgkmcnt(6)
  v_mfma_f32_32x32x16_bf16 v[48:63], a[4:7], v[32:35], v[48:63]
  s_waitcnt vmcnt(24)
  s_barrier
  ds_read_b64_tr_b16 v[16:17], v4 offset:4096
  ds_read_b64_tr_b16 v[18:19], v4 offset:4608
  s_waitcnt lgkmcnt(6)
  v_mfma_f32_32x32x16_bf16 v[64:79], a[4:7], v[36:39], v[64:79]
  ds_read_b64_tr_b16 v[20:21], v5 offset:4096
  ds_read_b64_tr_b16 v[22:23], v5 offset:4608
  s_add_u32 m0, s63, 131072
  s_nop 0
  buffer_load_dwordx4 v1, s[8:11], s60 offen lds
  s_waitcnt lgkmcnt(6)
  v_mfma_f32_32x32x16_bf16 v[80:95], a[4:7], v[40:43], v[80:95]
  ds_read_b64_tr_b16 v[24:25], v4 offset:12288
  ds_read_b64_tr_b16 v[26:27], v4 offset:12800
  s_add_u32 m0, s63, 132096
  s_add_u32 s58, s60, s62
  buffer_load_dwordx4 v1, s[8:11], s58 offen lds
  s_add_u32 s60, s60, s71
  s_waitcnt lgkmcnt(6)
  v_mfma_f32_32x32x16_bf16 v[96:111], a[4:7], v[44:47], v[96:111]
  ds_read_b64_tr_b16 v[28:29], v5 offset:12288
  ds_read_b64_tr_b16 v[30:31], v5 offset:12800
  s_add_u32 m0, s63, 139264
  s_nop 0
  buffer_load_dwordx4 v1, s[12:15], s61 offen lds
  s_waitcnt lgkmcnt(6)
  v_mfma_f32_32x32x16_bf16 v[48:63], a[8:11], v[16:19], v[48:63]
  ds_read_b64_tr_b16 v[32:33], v4 offset:6144
  ds_read_b64_tr_b16 v[34:35], v4 offset:6656
  s_add_u32 m0, s63, 140288
  s_add_u32 s58, s61, s62
  buffer_load_dwordx4 v1, s[12:15], s58 offen lds
  s_add_u32 s61, s61, s71
  s_waitcnt lgkmcnt(6)
  v_mfma_f32_32x32x16_bf16 v[64:79], a[8:11], v[20:23], v[64:79]
  ds_read_b64_tr_b16 v[36:37], v5 offset:6144
  ds_read_b64_tr_b16 v[38:39], v5 offset:6656
  s_waitcnt lgkmcnt(6)
  v_mfma_f32_32x32x16_bf16 v[80:95], a[8:11], v[24:27], v[80:95]
  ds_read_b64_tr_b16 v[40:41], v4 offset:14336
  ds_read_b64_tr_b16 v[42:43], v4 offset:14848
  s_waitcnt lgkmcnt(6)
  v_mfma_f32_32x32x16_bf16 v[96:111], a[8:11], v[28:31], v[96:111]
  ds_read_b64_tr_b16 v[44:45], v5 offset:14336
  ds_read_b64_tr_b16 v[46:47], v5 offset:14848
  s_waitcnt lgkmcnt(6)
  v_mfma_f32_32x32x16_bf16 v[48:63], a[12:15], v[32:35], v[48:63]
  ds_read_b64_tr_b16 v[16:17], v4 offset:16384
  ds_read_b64_tr_b16 v[18:19], v4 offset:16896
  s_waitcnt lgkmcnt(6)
  v_mfma_f32_32x32x16_bf16 v[64:79], a[12:15], v[36:39], v[64:79]
  ds_read_b64_tr_b16 v[20:21], v5 offset:16384
  ds_read_b64_tr_b16 v[22:23], v5 offset:16896
  s_waitcnt lgkmcnt(6)
  v_mfma_f32_32x32x16_bf16 v[80:95], a[12:15], v[40:43], v[80:95]
  ds_read_b64_tr_b16 v[24:25], v4 offset:24576
  ds_read_b64_tr_b16 v[26:27], v4 offset:25088
  s_waitcnt lgkmcnt(6)
  v_mfma_f32_32x32x16_bf16 v[96:111], a[12:15], v[44:47], v[96:111]
  ds_read_b64_tr_b16 v[28:29], v5 offset:24576
  ds_read_b64_tr_b16 v[30:31], v5 offset:25088
  s_waitcnt lgkmcnt(6)
  v_mfma_f32_32x32x16_bf16 v[48:63], a[16:19], v[16:19], v[48:63]
  ds_read_b64_tr_b16 v[32:33], v4 offset:18432
  ds_read_b64_tr_b16 v[34:35], v4 offset:18944
  s_waitcnt lgkmcnt(6)
  v_mfma_f32_32x32x16_bf16 v[64:79], a[16:19], v[20:23], v[64:79]
  ds_read_b64_tr_b16 v[36:37], v5 offset:18432
  ds_read_b64_tr_b16 v[38:39], v5 offset:18944
  s_waitcnt lgkmcnt(6)
  v_mfma_f32_32x32x16_bf16 v[80:95], a[16:19], v[24:27], v[80:95]
  ds_read_b64_tr_b16 v[40:41], v4 offset:26624
  ds_read_b64_tr_b16 v[42:43], v4 offset:27136
  s_waitcnt lgkmcnt(6)
  v_mfma_f32_32x32x16_bf16 v[96:111], a[16:19], v[28:31], v[96:111]
  ds_read_b64_tr_b16 v[44:45], v5 offset:26624
  ds_read_b64_tr_b16 v[46:47], v5 offset:27136
  s_waitcnt lgkmcnt(6)
  v_mfma_f32_32x32x16_bf16 v[48:63], a[20:23], v[32:35], v[48:63]
  s_waitcnt vmcnt(24)
  s_barrier
  s_lshr_b32 m0, s54, 1
  s_and_b32 s56, s54, 1
  s_movrels_b32 s55, s84
  s_lshl_b32 s56, s56, 4
  s_lshr_b32 s55, s55, s56
  s_bfe_u32 s74, s55, 0x80008
  s_and_b32 s55, s55, 255
  s_lshl_b32 s58, s52, 2
  s_add_u32 s58, s58, s20
  s_lshl_b32 s70, s52, 10
  s_add_u32 s70, s70, 0x3204000
  s_cmp_lg_u32 s74, s52
  s_cbranch_scc1 L_up_none_n
  s_cmp_ge_u32 s55, 136
  s_cbranch_scc1 L_up_q_n
  s_cmp_ge_u32 s55, 64
  s_cbranch_scc1 L_up_g_n
  s_and_b32 s68, s55, 1
  s_lshr_b32 s56, s55, 1
  s_cmp_eq_u32 s68, 0
  s_cselect_b32 s8, s30, s32
  s_cselect_b32 s9, s31, s33
  s_lshl_b32 s69, s56, 20
  s_lshl_b32 s57, s58, 14
  s_add_u32 s69, s69, s57
  s_lshl_b32 s57, s68, 13
  s_add_u32 s69, s69, s57
  s_add_u32 s69, s69, 0x400000
  s_lshl_b32 s57, s68, 5
  s_add_u32 s57, s57, s56
  s_branch L_up_qkv_n
L_up_q_n:
  s_sub_u32 s56, s55, 136
  s_mov_b32 s68, 0
  s_mov_b32 s8, s28
  s_mov_b32 s9, s29
  s_lshl_b32 s69, s56, 19
  s_lshl_b32 s57, s58, 13
  s_add_u32 s69, s69, s57
  s_add_u32 s69, s69, 0x4000000
  s_add_u32 s57, s56, 64
L_up_qkv_n:
  s_and_b32 s9, s9, 0xffff
  s_mov_b32 s10, 0x480000
  s_mov_b32 s12, s8
  s_mov_b32 s13, s9
  s_mov_b32 s14, s10
  s_lshl_b32 s60, s56, 8
  s_lshl_b32 s56, s20, 17
  s_add_u32 s60, s60, s56
  s_add_u32 s61, s60, 128
  s_mov_b32 s62, 65536
  v_mov_b32 v1, v10
  s_branch L_up_fin_n
L_up_g_n:
  s_sub_u32 s56, s55, 64
  s_mov_b32 s68, 2
  s_mov_b32 s8, s40
  s_and_b32 s9, s41, 0xffff
  s_mov_b32 s10, 0x510000
  s_mov_b32 s12, s42
  s_and_b32 s13, s43, 0xffff
  s_mov_b32 s14, s10
  s_mul_i32 s69, s58, 294912
  s_lshl_b32 s57, s56, 12
  s_add_u32 s69, s69, s57
  s_add_u32 s69, s69, 0x5000000
  s_lshl_b32 s60, s56, 7
  s_mul_i32 s57, s20, 147456
  s_add_u32 s60, s60, s57
  s_mov_b32 s61, s60
  s_mov_b32 s62, 73728
  v_mov_b32 v1, v11
  s_add_u32 s57, s56, 96
  s_branch L_up_fin_n
L_up_none_n:
  s_mov_b32 s68, 3
  s_mov_b32 s60, 0x40000000
  s_mov_b32 s61, 0x40000000
  s_mov_b32 s62, 0
  s_mov_b32 s57, 255
  s_sub_u32 s54, s54, 1
L_up_fin_n:
  s_lshl_b32 s57, s57, 2
  s_add_u32 s70, s70, s57
  s_lshl_b32 s71, s62, 3
  s_add_u32 s54, s54, 1
  ds_read_b64_tr_b16 v[16:17], v4 offset:20480
  ds_read_b64_tr_b16 v[18:19], v4 offset:20992
  s_waitcnt lgkmcnt(6)
  v_mfma_f32_32x32x16_bf16 v[64:79], a[20:23], v[36:39], v[64:79]
  ds_read_b64_tr_b16 v[20:21], v5 offset:20480
  ds_read_b64_tr_b16 v[22:23], v5 offset:20992
  s_add_u32 m0, s63, 0
  s_nop 0
  buffer_load_dwordx4 v1, s[8:11], s60 offen lds
  s_waitcnt lgkmcnt(6)
  v_mfma_f32_32x32x16_bf16 v[80:95], a[20:23], v[40:43], v[80:95]
  ds_read_b64_tr_b16 v[24:25], v4 offset:28672
  ds_read_b64_tr_b16 v[26:27], v4 offset:29184
  s_add_u32 m0, s63, 1024
  s_add_u32 s58, s60, s62
  buffer_load_dwordx4 v1, s[8:11], s58 offen lds
  s_add_u32 s60, s60, s71
  s_waitcnt lgkmcnt(6)
  v_mfma_f32_32x32x16_bf16 v[96:111], a[20:23], v[44:47], v[96:111]
  ds_read_b64_tr_b16 v[28:29], v5 offset:28672
  ds_read_b64_tr_b16 v[30:31], v5 offset:29184
  s_add_u32 m0, s63, 8192
  s_nop 0
  buffer_load_dwordx4 v1, s[12:15], s61 offen lds
  s_waitcnt lgkmcnt(6)
  v_mfma_f32_32x32x16_bf16 v[48:63], a[24:27], v[16:19], v[48:63]
  ds_read_b64_tr_b16 v[32:33], v4 offset:22528
  ds_read_b64_tr_b16 v[34:35], v4 offset:23040
  s_add_u32 m0, s63, 9216
  s_add_u32 s58, s61, s62
  buffer_load_dwordx4 v1, s[12:15], s58 offen lds
  s_add_u32 s61, s61, s71
  s_waitcnt lgkmcnt(6)
  v_mfma_f32_32x32x16_bf16 v[64:79], a[24:27], v[20:23], v[64:79]
  ds_read_b64_tr_b16 v[36:37], v5 offset:22528
  ds_read_b64_tr_b16 v[38:39], v5 offset:23040
  s_waitcnt lgkmcnt(6)
  v_mfma_f32_32x32x16_bf16 v[80:95], a[24:27], v[24:27], v[80:95]
  ds_read_b64_tr_b16 v[40:41], v4 offset:30720
  ds_read_b64_tr_b16 v[42:43], v4 offset:31232
  s_waitcnt lgkmcnt(6)
  v_mfma_f32_32x32x16_bf16 v[96:111], a[24:27], v[28:31], v[96:111]
  ds_read_b64_tr_b16 v[44:45], v5 offset:30720
  ds_read_b64_tr_b16 v[46:47], v5 offset:31232
  s_waitcnt lgkmcnt(6)
  v_mfma_f32_32x32x16_bf16 v[48:63], a[28:31], v[32:35], v[48:63]
  ds_read_b64_tr_b16 v[16:17], v4 offset:32768
  ds_read_b64_tr_b16 v[18:19], v4 offset:33280
  s_waitcnt lgkmcnt(6)
  v_mfma_f32_32x32x16_bf16 v[64:79], a[28:31], v[36:39], v[64:79]
  ds_read_b64_tr_b16 v[20:21], v5 offset:32768
  ds_read_b64_tr_b16 v[22:23], v5 offset:33280
  s_waitcnt lgkmcnt(6)
  v_mfma_f32_32x32x16_bf16 v[80:95], a[28:31], v[40:43], v[80:95]
  ds_read_b64_tr_b16 v[24:25], v4 offset:40960
  ds_read_b64_tr_b16 v[26:27], v4 offset:41472
  s_waitcnt lgkmcnt(6)
  v_mfma_f32_32x32x16_bf16 v[96:111], a[28:31], v[44:47], v[96:111]
  ds_read_b64_tr_b16 v[28:29], v5 offset:40960
  ds_read_b64_tr_b16 v[30:31], v5 offset:41472
  s_waitcnt lgkmcnt(6)
  v_mfma_f32_32x32x16_bf16 v[48:63], a[32:35], v[16:19], v[48:63]
  ds_read_b64_tr_b16 v[32:33], v4 offset:34816
  ds_read_b64_tr_b16 v[34:35], v4 offset:35328
  s_waitcnt lgkmcnt(6)
  v_mfma_f32_32x32x16_bf16 v[64:79], a[32:35], v[20:23], v[64:79]
  ds_read_b64_tr_b16 v[36:37], v5 offset:34816
  ds_read_b64_tr_b16 v[38:39], v5 offset:35328
  s_waitcnt lgkmcnt(6)
  v_mfma_f32_32x32x16_bf16 v[80:95], a[32:35], v[24:27], v[80:95]
  ds_read_b64_tr_b16 v[40:41], v4 offset:43008
  ds_read_b64_tr_b16 v[42:43], v4 offset:43520
  s_waitcnt lgkmcnt(6)
  v_mfma_f32_32x32x16_bf16 v[96:111], a[32:35], v[28:31], v[96:111]
  ds_read_b64_tr_b16 v[44:45], v5 offset:43008
  ds_read_b64_tr_b16 v[46:47], v5 offset:43520
  s_waitcnt lgkmcnt(6)
  v_mfma_f32_32x32x16_bf16 v[48:63], a[36:39], v[32:35], v[48:63]
  s_waitcnt vmcnt(24)
  s_barrier
  ds_read_b64_tr_b16 v[16:17], v4 offset:36864
  ds_read_b64_tr_b16 v[18:19], v4 offset:37376
  s_waitcnt lgkmcnt(6)
  v_mfma_f32_32x32x16_bf16 v[64:79], a[36:39], v[36:39], v[64:79]
  ds_read_b64_tr_b16 v[20:21], v5 offset:36864
  ds_read_b64_tr_b16 v[22:23], v5 offset:37376
  s_add_u32 m0, s63, 16384
  s_nop 0
  buffer_load_dwordx4 v1, s[8:11], s60 offen lds
  s_waitcnt lgkmcnt(6)
  v_mfma_f32_32x32x16_bf16 v[80:95], a[36:39], v[40:43], v[80:95]
  ds_read_b64_tr_b16 v[24:25], v4 offset:45056
  ds_read_b64_tr_b16 v[26:27], v4 offset:45568
  s_add_u32 m0, s63, 17408
  s_add_u32 s58, s60, s62
  buffer_load_dwordx4 v1, s[8:11], s58 offen lds
  s_add_u32 s60, s60, s71
  s_waitcnt lgkmcnt(6)
  v_mfma_f32_32x32x16_bf16 v[96:111], a[36:39], v[44:47], v[96:111]
  ds_read_b64_tr_b16 v[28:29], v5 offset:45056
  ds_read_b64_tr_b16 v[30:31], v5 offset:45568
  s_add_u32 m0, s63, 24576
  s_nop 0
  buffer_load_dwordx4 v1, s[12:15], s61 offen lds
  s_waitcnt lgkmcnt(6)
  v_mfma_f32_32x32x16_bf16 v[48:63], a[40:43], v[16:19], v[48:63]
  ds_read_b64_tr_b16 v[32:33], v4 offset:38912
  ds_read_b64_tr_b16 v[34:35], v4 offset:39424
  s_add_u32 m0, s63, 25600
  s_add_u32 s58, s61, s62
  buffer_load_dwordx4 v1, s[12:15], s58 offen lds
  s_add_u32 s61, s61, s71
  s_waitcnt lgkmcnt(6)
  v_mfma_f32_32x32x16_bf16 v[64:79], a[40:43], v[20:23], v[64:79]
  ds_read_b64_tr_b16 v[36:37], v5 offset:38912
  ds_read_b64_tr_b16 v[38:39], v5 offset:39424
  s_waitcnt lgkmcnt(6)
  v_mfma_f32_32x32x16_bf16 v[80:95], a[40:43], v[24:27], v[80:95]
  ds_read_b64_tr_b16 v[40:41], v4 offset:47104
  ds_read_b64_tr_b16 v[42:43], v4 offset:47616
  s_waitcnt lgkmcnt(6)
  v_mfma_f32_32x32x16_bf16 v[96:111], a[40:43], v[28:31], v[96:111]
  ds_read_b64_tr_b16 v[44:45], v5 offset:47104
  ds_read_b64_tr_b16 v[46:47], v5 offset:47616
  s_waitcnt lgkmcnt(6)
  v_mfma_f32_32x32x16_bf16 v[48:63], a[44:47], v[32:35], v[48:63]
  ds_read_b64_tr_b16 v[16:17], v4 offset:49152
  ds_read_b64_tr_b16 v[18:19], v4 offset:49664
  s_waitcnt lgkmcnt(6)
  v_mfma_f32_32x32x16_bf16 v[64:79], a[44:47], v[36:39], v[64:79]
  ds_read_b64_tr_b16 v[20:21], v5 offset:49152
  ds_read_b64_tr_b16 v[22:23], v5 offset:49664
  s_waitcnt lgkmcnt(6)
  v_mfma_f32_32x32x16_bf16 v[80:95], a[44:47], v[40:43], v[80:95]
  ds_read_b64_tr_b16 v[24:25], v4 offset:57344
  ds_read_b64_tr_b16 v[26:27], v4 offset:57856
  s_waitcnt lgkmcnt(6)
  v_mfma_f32_32x32x16_bf16 v[96:111], a[44:47], v[44:47], v[96:111]
  ds_read_b64_tr_b16 v[28:29], v5 offset:57344
  ds_read_b64_tr_b16 v[30:31], v5 offset:57856
  s_waitcnt lgkmcnt(6)
  v_mfma_f32_32x32x16_bf16 v[48:63], a[48:51], v[16:19], v[48:63]
  ds_read_b64_tr_b16 v[32:33], v4 offset:51200
  ds_read_b64_tr_b16 v[34:35], v4 offset:51712
  s_waitcnt lgkmcnt(6)
  v_mfma_f32_32x32x16_bf16 v[64:79], a[48:51], v[20:23], v[64:79]
  ds_read_b64_tr_b16 v[36:37], v5 offset:51200
  ds_read_b64_tr_b16 v[38:39], v5 offset:51712
  s_waitcnt lgkmcnt(6)
  v_mfma_f32_32x32x16_bf16 v[80:95], a[48:51], v[24:27], v[80:95]
  ds_read_b64_tr_b16 v[40:41], v4 offset:59392
  ds_read_b64_tr_b16 v[42:43], v4 offset:59904
  s_waitcnt lgkmcnt(6)
  v_mfma_f32_32x32x16_bf16 v[96:111], a[48:51], v[28:31], v[96:111]
  ds_read_b64_tr_b16 v[44:45], v5 offset:59392
  ds_read_b64_tr_b16 v[46:47], v5 offset:59904
  s_waitcnt lgkmcnt(6)
  v_mfma_f32_32x32x16_bf16 v[48:63], a[52:55], v[32:35], v[48:63]
  s_waitcnt vmcnt(24)
  s_barrier
  ds_read_b64_tr_b16 v[16:17], v4 offset:53248
  ds_read_b64_tr_b16 v[18:19], v4 offset:53760
  s_waitcnt lgkmcnt(6)
  v_mfma_f32_32x32x16_bf16 v[64:79], a[52:55], v[36:39], v[64:79]
  ds_read_b64_tr_b16 v[20:21], v5 offset:53248
  ds_read_b64_tr_b16 v[22:23], v5 offset:53760
  s_add_u32 m0, s63, 32768
  s_nop 0
  buffer_load_dwordx4 v1, s[8:11], s60 offen lds
  s_waitcnt lgkmcnt(6)
  v_mfma_f32_32x32x16_bf16 v[80:95], a[52:55], v[40:43], v[80:95]
  ds_read_b64_tr_b16 v[24:25], v4 offset:61440
  ds_read_b64_tr_b16 v[26:27], v4 offset:61952
  s_add_u32 m0, s63, 33792
  s_add_u32 s58, s60, s62
  buffer_load_dwordx4 v1, s[8:11], s58 offen lds
  s_add_u32 s60, s60, s71
  s_waitcnt lgkmcnt(6)
  v_mfma_f32_32x32x16_bf16 v[96:111], a[52:55], v[44:47], v[96:111]
  ds_read_b64_tr_b16 v[28:29], v5 offset:61440
  ds_read_b64_tr_b16 v[30:31], v5 offset:61952
  s_add_u32 m0, s63, 40960
  s_nop 0
  buffer_load_dwordx4 v1, s[12:15], s61 offen lds
  s_waitcnt lgkmcnt(6)
  v_mfma_f32_32x32x16_bf16 v[48:63], a[56:59], v[16:19], v[48:63]
  ds_read_b64_tr_b16 v[32:33], v4 offset:55296
  ds_read_b64_tr_b16 v[34:35], v4 offset:55808
  s_add_u32 m0, s63, 41984
  s_add_u32 s58, s61, s62
  buffer_load_dwordx4 v1, s[12:15], s58 offen lds
  s_add_u32 s61, s61, s71
  s_waitcnt lgkmcnt(6)
  v_mfma_f32_32x32x16_bf16 v[64:79], a[56:59], v[20:23], v[64:79]
  ds_read_b64_tr_b16 v[36:37], v5 offset:55296
  ds_read_b64_tr_b16 v[38:39], v5 offset:55808
  s_waitcnt lgkmcnt(6)
  v_mfma_f32_32x32x16_bf16 v[80:95], a[56:59], v[24:27], v[80:95]
  ds_read_b64_tr_b16 v[40:41], v4 offset:63488
  ds_read_b64_tr_b16 v[42:43], v4 offset:64000
  s_waitcnt lgkmcnt(6)
  v_mfma_f32_32x32x16_bf16 v[96:111], a[56:59], v[28:31], v[96:111]
  ds_read_b64_tr_b16 v[44:45], v5 offset:63488
  ds_read_b64_tr_b16 v[46:47], v5 offset:64000
  s_waitcnt lgkmcnt(6)
  v_mfma_f32_32x32x16_bf16 v[48:63], a[60:63], v[32:35], v[48:63]
  ds_read_b64_tr_b16 v[16:17], v6 offset:0
  ds_read_b64_tr_b16 v[18:19], v6 offset:512
  s_waitcnt lgkmcnt(6)
  v_mfma_f32_32x32x16_bf16 v[64:79], a[60:63], v[36:39], v[64:79]
  ds_read_b64_tr_b16 v[20:21], v7 offset:0
  ds_read_b64_tr_b16 v[22:23], v7 offset:512
  s_waitcnt lgkmcnt(6)
  v_mfma_f32_32x32x16_bf16 v[80:95], a[60:63], v[40:43], v[80:95]
  ds_read_b64_tr_b16 v[24:25], v6 offset:8192
  ds_read_b64_tr_b16 v[26:27], v6 offset:8704
  s_waitcnt lgkmcnt(6)
  v_mfma_f32_32x32x16_bf16 v[96:111], a[60:63], v[44:47], v[96:111]
  ds_read_b64_tr_b16 v[28:29], v7 offset:8192
  ds_read_b64_tr_b16 v[30:31], v7 offset:8704
  s_waitcnt lgkmcnt(6)
  v_mfma_f32_32x32x16_bf16 v[48:63], a[64:67], v[16:19], v[48:63]
  ds_read_b64_tr_b16 v[32:33], v6 offset:2048
  ds_read_b64_tr_b16 v[34:35], v6 offset:2560
  s_waitcnt lgkmcnt(6)
  v_mfma_f32_32x32x16_bf16 v[64:79], a[64:67], v[20:23], v[64:79]
  ds_read_b64_tr_b16 v[36:37], v7 offset:2048
  ds_read_b64_tr_b16 v[38:39], v7 offset:2560
  s_waitcnt lgkmcnt(6)
  v_mfma_f32_32x32x16_bf16 v[80:95], a[64:67], v[24:27], v[80:95]
  ds_read_b64_tr_b16 v[40:41], v6 offset:10240
  ds_read_b64_tr_b16 v[42:43], v6 offset:10752
  s_waitcnt lgkmcnt(6)
  v_mfma_f32_32x32x16_bf16 v[96:111], a[64:67], v[28:31], v[96:111]
  ds_read_b64_tr_b16 v[44:45], v7 offset:10240
  ds_read_b64_tr_b16 v[46:47], v7 offset:10752
  s_waitcnt lgkmcnt(6)
  v_mfma_f32_32x32x16_bf16 v[48:63], a[68:71], v[32:35], v[48:63]
  s_waitcnt vmcnt(16)
  s_barrier
  s_cmp_lg_u32 s20, 0
  s_cbranch_scc1 L_nofl_n
  s_mov_b64 exec, 1
  buffer_store_dword v6, v3, s[4:7], s67 offen sc1
  s_mov_b64 exec, -1
L_nofl_n:
  ds_read_b64_tr_b16 v[16:17], v6 offset:4096
  ds_read_b64_tr_b16 v[18:19], v6 offset:4608
  s_waitcnt lgkmcnt(6)
  v_mfma_f32_32x32x16_bf16 v[64:79], a[68:71], v[36:39], v[64:79]
  ds_read_b64_tr_b16 v[20:21], v7 offset:4096
  ds_read_b64_tr_b16 v[22:23], v7 offset:4608
  s_add_u32 m0, s63, 49152
  s_nop 0
  buffer_load_dwordx4 v1, s[8:11], s60 offen lds
  s_waitcnt lgkmcnt(6)
  v_mfma_f32_32x32x16_bf16 v[80:95], a[68:71], v[40:43], v[80:95]
  ds_read_b64_tr_b16 v[24:25], v6 offset:12288
  ds_read_b64_tr_b16 v[26:27], v6 offset:12800
  s_add_u32 m0, s63, 50176
  s_add_u32 s58, s60, s62
  buffer_load_dwordx4 v1, s[8:11], s58 offen lds
  s_add_u32 s60, s60, s71
  s_waitcnt lgkmcnt(6)
  v_mfma_f32_32x32x16_bf16 v[96:111], a[68:71], v[44:47], v[96:111]
  ds_read_b64_tr_b16 v[28:29], v7 offset:12288
  ds_read_b64_tr_b16 v[30:31], v7 offset:12800
  s_add_u32 m0, s63, 57344
  s_nop 0
  buffer_load_dwordx4 v1, s[12:15], s61 offen lds
  s_waitcnt lgkmcnt(6)
  v_mfma_f32_32x32x16_bf16 v[48:63], a[72:75], v[16:19], v[48:63]
  ds_read_b64_tr_b16 v[32:33], v6 offset:6144
  ds_read_b64_tr_b16 v[34:35], v6 offset:6656
  s_add_u32 m0, s63, 58368
  s_add_u32 s58, s61, s62
  buffer_load_dwordx4 v1, s[12:15], s58 offen lds
  s_add_u32 s61, s61, s71
  s_waitcnt lgkmcnt(6)
  v_mfma_f32_32x32x16_bf16 v[64:79], a[72:75], v[20:23], v[64:79]
  ds_read_b64_tr_b16 v[36:37], v7 offset:6144
  ds_read_b64_tr_b16 v[38:39], v7 offset:6656
  s_waitcnt lgkmcnt(6)
  v_mfma_f32_32x32x16_bf16 v[80:95], a[72:75], v[24:27], v[80:95]
  ds_read_b64_tr_b16 v[40:41], v6 offset:14336
  ds_read_b64_tr_b16 v[42:43], v6 offset:14848
  s_waitcnt lgkmcnt(6)
  v_mfma_f32_32x32x16_bf16 v[96:111], a[72:75], v[28:31], v[96:111]
  ds_read_b64_tr_b16 v[44:45], v7 offset:14336
  ds_read_b64_tr_b16 v[46:47], v7 offset:14848
  s_waitcnt lgkmcnt(6)
  v_mfma_f32_32x32x16_bf16 v[48:63], a[76:79], v[32:35], v[48:63]
  ds_read_b64_tr_b16 v[16:17], v6 offset:16384
  ds_read_b64_tr_b16 v[18:19], v6 offset:16896
  s_waitcnt lgkmcnt(6)
  v_mfma_f32_32x32x16_bf16 v[64:79], a[76:79], v[36:39], v[64:79]
  ds_read_b64_tr_b16 v[20:21], v7 offset:16384
  ds_read_b64_tr_b16 v[22:23], v7 offset:16896
  s_waitcnt lgkmcnt(6)
  v_mfma_f32_32x32x16_bf16 v[80:95], a[76:79], v[40:43], v[80:95]
  ds_read_b64_tr_b16 v[24:25], v6 offset:24576
  ds_read_b64_tr_b16 v[26:27], v6 offset:25088
  s_waitcnt lgkmcnt(6)
  v_mfma_f32_32x32x16_bf16 v[96:111], a[76:79], v[44:47], v[96:111]
  ds_read_b64_tr_b16 v[28:29], v7 offset:24576
  ds_read_b64_tr_b16 v[30:31], v7 offset:25088
  s_waitcnt lgkmcnt(6)
  v_mfma_f32_32x32x16_bf16 v[48:63], a[80:83], v[16:19], v[48:63]
  ds_read_b64_tr_b16 v[32:33], v6 offset:18432
  ds_read_b64_tr_b16 v[34:35], v6 offset:18944
  s_waitcnt lgkmcnt(6)
  v_mfma_f32_32x32x16_bf16 v[64:79], a[80:83], v[20:23], v[64:79]
  ds_read_b64_tr_b16 v[36:37], v7 offset:18432
  ds_read_b64_tr_b16 v[38:39], v7 offset:18944
  s_waitcnt lgkmcnt(6)
  v_mfma_f32_32x32x16_bf16 v[80:95], a[80:83], v[24:27], v[80:95]
  ds_read_b64_tr_b16 v[40:41], v6 offset:26624
  ds_read_b64_tr_b16 v[42:43], v6 offset:27136
  s_waitcnt lgkmcnt(6)
  v_mfma_f32_32x32x16_bf16 v[96:111], a[80:83], v[28:31], v[96:111]
  ds_read_b64_tr_b16 v[44:45], v7 offset:26624
  ds_read_b64_tr_b16 v[46:47], v7 offset:27136
  s_waitcnt lgkmcnt(6)
  v_mfma_f32_32x32x16_bf16 v[48:63], a[84:87], v[32:35], v[48:63]
  s_waitcnt vmcnt(24)
  s_barrier
  ds_read_b64_tr_b16 v[16:17], v6 offset:20480
  ds_read_b64_tr_b16 v[18:19], v6 offset:20992
  s_waitcnt lgkmcnt(6)
  v_mfma_f32_32x32x16_bf16 v[64:79], a[84:87], v[36:39], v[64:79]
  ds_read_b64_tr_b16 v[20:21], v7 offset:20480
  ds_read_b64_tr_b16 v[22:23], v7 offset:20992
  s_add_u32 m0, s63, 65536
  s_nop 0
  buffer_load_dwordx4 v1, s[8:11], s60 offen lds
  s_waitcnt lgkmcnt(6)
  v_mfma_f32_32x32x16_bf16 v[80:95], a[84:87], v[40:43], v[80:95]
  ds_read_b64_tr_b16 v[24:25], v6 offset:28672
  ds_read_b64_tr_b16 v[26:27], v6 offset:29184
  s_add_u32 m0, s63, 66560
  s_add_u32 s58, s60, s62
  buffer_load_dwordx4 v1, s[8:11], s58 offen lds
  s_add_u32 s60, s60, s71
  s_waitcnt lgkmcnt(6)
  v_mfma_f32_32x32x16_bf16 v[96:111], a[84:87], v[44:47], v[96:111]
  ds_read_b64_tr_b16 v[28:29], v7 offset:28672
  ds_read_b64_tr_b16 v[30:31], v7 offset:29184
  s_add_u32 m0, s63, 73728
  s_nop 0
  buffer_load_dwordx4 v1, s[12:15], s61 offen lds
  s_waitcnt lgkmcnt(6)
  v_mfma_f32_32x32x16_bf16 v[48:63], a[88:91], v[16:19], v[48:63]
  ds_read_b64_tr_b16 v[32:33], v6 offset:22528
  ds_read_b64_tr_b16 v[34:35], v6 offset:23040
  s_add_u32 m0, s63, 74752
  s_add_u32 s58, s61, s62
  buffer_load_dwordx4 v1, s[12:15], s58 offen lds
  s_add_u32 s61, s61, s71
  s_waitcnt lgkmcnt(6)
  v_mfma_f32_32x32x16_bf16 v[64:79], a[88:91], v[20:23], v[64:79]
  ds_read_b64_tr_b16 v[36:37], v7 offset:22528
  ds_read_b64_tr_b16 v[38:39], v7 offset:23040
  s_waitcnt lgkmcnt(6)
  v_mfma_f32_32x32x16_bf16 v[80:95], a[88:91], v[24:27], v[80:95]
  ds_read_b64_tr_b16 v[40:41], v6 offset:30720
  ds_read_b64_tr_b16 v[42:43], v6 offset:31232
  s_waitcnt lgkmcnt(6)
  v_mfma_f32_32x32x16_bf16 v[96:111], a[88:91], v[28:31], v[96:111]
  ds_read_b64_tr_b16 v[44:45], v7 offset:30720
  ds_read_b64_tr_b16 v[46:47], v7 offset:31232
  s_waitcnt lgkmcnt(6)
  v_mfma_f32_32x32x16_bf16 v[48:63], a[92:95], v[32:35], v[48:63]
  ds_read_b64_tr_b16 v[16:17], v6 offset:32768
  ds_read_b64_tr_b16 v[18:19], v6 offset:33280
  s_waitcnt lgkmcnt(6)
  v_mfma_f32_32x32x16_bf16 v[64:79], a[92:95], v[36:39], v[64:79]
  ds_read_b64_tr_b16 v[20:21], v7 offset:32768
  ds_read_b64_tr_b16 v[22:23], v7 offset:33280
  s_waitcnt lgkmcnt(6)
  v_mfma_f32_32x32x16_bf16 v[80:95], a[92:95], v[40:43], v[80:95]
  ds_read_b64_tr_b16 v[24:25], v6 offset:40960
  ds_read_b64_tr_b16 v[26:27], v6 offset:41472
  s_waitcnt lgkmcnt(6)
  v_mfma_f32_32x32x16_bf16 v[96:111], a[92:95], v[44:47], v[96:111]
  ds_read_b64_tr_b16 v[28:29], v7 offset:40960
  ds_read_b64_tr_b16 v[30:31], v7 offset:41472
  s_waitcnt lgkmcnt(6)
  v_mfma_f32_32x32x16_bf16 v[48:63], a[96:99], v[16:19], v[48:63]
  ds_read_b64_tr_b16 v[32:33], v6 offset:34816
  ds_read_b64_tr_b16 v[34:35], v6 offset:35328
  s_waitcnt lgkmcnt(6)
  v_mfma_f32_32x32x16_bf16 v[64:79], a[96:99], v[20:23], v[64:79]
  ds_read_b64_tr_b16 v[36:37], v7 offset:34816
  ds_read_b64_tr_b16 v[38:39], v7 offset:35328
  s_waitcnt lgkmcnt(6)
  v_mfma_f32_32x32x16_bf16 v[80:95], a[96:99], v[24:27], v[80:95]
  ds_read_b64_tr_b16 v[40:41], v6 offset:43008
  ds_read_b64_tr_b16 v[42:43], v6 offset:43520
  s_waitcnt lgkmcnt(6)
  v_mfma_f32_32x32x16_bf16 v[96:111], a[96:99], v[28:31], v[96:111]
  ds_read_b64_tr_b16 v[44:45], v7 offset:43008
  ds_read_b64_tr_b16 v[46:47], v7 offset:43520
  s_waitcnt lgkmcnt(6)
  v_mfma_f32_32x32x16_bf16 v[48:63], a[100:103], v[32:35], v[48:63]
  s_waitcnt vmcnt(24)
  s_barrier
  ds_read_b64_tr_b16 v[16:17], v6 offset:36864
  ds_read_b64_tr_b16 v[18:19], v6 offset:37376
  s_waitcnt lgkmcnt(6)
  v_mfma_f32_32x32x16_bf16 v[64:79], a[100:103], v[36:39], v[64:79]
  ds_read_b64_tr_b16 v[20:21], v7 offset:36864
  ds_read_b64_tr_b16 v[22:23], v7 offset:37376
  s_add_u32 m0, s63, 81920
  s_nop 0
  buffer_load_dwordx4 v1, s[8:11], s60 offen lds
  s_waitcnt lgkmcnt(6)
  v_mfma_f32_32x32x16_bf16 v[80:95], a[100:103], v[40:43], v[80:95]
  ds_read_b64_tr_b16 v[24:25], v6 offset:45056
  ds_read_b64_tr_b16 v[26:27], v6 offset:45568
  s_add_u32 m0, s63, 82944
  s_add_u32 s58, s60, s62
  buffer_load_dwordx4 v1, s[8:11], s58 offen lds
  s_add_u32 s60, s60, s71
  s_waitcnt lgkmcnt(6)
  v_mfma_f32_32x32x16_bf16 v[96:111], a[100:103], v[44:47], v[96:111]
  ds_read_b64_tr_b16 v[28:29], v7 offset:45056
  ds_read_b64_tr_b16 v[30:31], v7 offset:45568
  s_add_u32 m0, s63, 90112
  s_nop 0
  buffer_load_dwordx4 v1, s[12:15], s61 offen lds
  s_waitcnt lgkmcnt(6)
  v_mfma_f32_32x32x16_bf16 v[48:63], a[104:107], v[16:19], v[48:63]
  ds_read_b64_tr_b16 v[32:33], v6 offset:38912
  ds_read_b64_tr_b16 v[34:35], v6 offset:39424
  s_add_u32 m0, s63, 91136
  s_add_u32 s58, s61, s62
  buffer_load_dwordx4 v1, s[12:15], s58 offen lds
  s_add_u32 s61, s61, s71
  s_waitcnt lgkmcnt(6)
  v_mfma_f32_32x32x16_bf16 v[64:79], a[104:107], v[20:23], v[64:79]
  ds_read_b64_tr_b16 v[36:37], v7 offset:38912
  ds_read_b64_tr_b16 v[38:39], v7 offset:39424
  s_waitcnt lgkmcnt(6)
  v_mfma_f32_32x32x16_bf16 v[80:95], a[104:107], v[24:27], v[80:95]
  ds_read_b64_tr_b16 v[40:41], v6 offset:47104
  ds_read_b64_tr_b16 v[42:43], v6 offset:47616
  s_waitcnt lgkmcnt(6)
  v_mfma_f32_32x32x16_bf16 v[96:111], a[104:107], v[28:31], v[96:111]
  ds_read_b64_tr_b16 v[44:45], v7 offset:47104
  ds_read_b64_tr_b16 v[46:47], v7 offset:47616
  s_waitcnt lgkmcnt(6)
  v_mfma_f32_32x32x16_bf16 v[48:63], a[108:111], v[32:35], v[48:63]
  ds_read_b64_tr_b16 v[16:17], v6 offset:49152
  ds_read_b64_tr_b16 v[18:19], v6 offset:49664
  s_waitcnt lgkmcnt(6)
  v_mfma_f32_32x32x16_bf16 v[64:79], a[108:111], v[36:39], v[64:79]
  ds_read_b64_tr_b16 v[20:21], v7 offset:49152
  ds_read_b64_tr_b16 v[22:23], v7 offset:49664
  s_waitcnt lgkmcnt(6)
  v_mfma_f32_32x32x16_bf16 v[80:95], a[108:111], v[40:43], v[80:95]
  ds_read_b64_tr_b16 v[24:25], v6 offset:57344
  ds_read_b64_tr_b16 v[26:27], v6 offset:57856
  s_waitcnt lgkmcnt(6)
  v_mfma_f32_32x32x16_bf16 v[96:111], a[108:111], v[44:47], v[96:111]
  ds_read_b64_tr_b16 v[28:29], v7 offset:57344
  ds_read_b64_tr_b16 v[30:31], v7 offset:57856
  s_waitcnt lgkmcnt(6)
  v_mfma_f32_32x32x16_bf16 v[48:63], a[112:115], v[16:19], v[48:63]
  ds_read_b64_tr_b16 v[32:33], v6 offset:51200
  ds_read_b64_tr_b16 v[34:35], v6 offset:51712
  s_waitcnt lgkmcnt(6)
  v_mfma_f32_32x32x16_bf16 v[64:79], a[112:115], v[20:23], v[64:79]
  ds_read_b64_tr_b16 v[36:37], v7 offset:51200
  ds_read_b64_tr_b16 v[38:39], v7 offset:51712
  s_waitcnt lgkmcnt(6)
  v_mfma_f32_32x32x16_bf16 v[80:95], a[112:115], v[24:27], v[80:95]
  ds_read_b64_tr_b16 v[40:41], v6 offset:59392
  ds_read_b64_tr_b16 v[42:43], v6 offset:59904
  s_waitcnt lgkmcnt(6)
  v_mfma_f32_32x32x16_bf16 v[96:111], a[112:115], v[28:31], v[96:111]
  ds_read_b64_tr_b16 v[44:45], v7 offset:59392
  ds_read_b64_tr_b16 v[46:47], v7 offset:59904
  s_waitcnt lgkmcnt(6)
  v_mfma_f32_32x32x16_bf16 v[48:63], a[116:119], v[32:35], v[48:63]
  s_waitcnt vmcnt(24)
  s_barrier
  ds_read_b64_tr_b16 v[16:17], v6 offset:53248
  ds_read_b64_tr_b16 v[18:19], v6 offset:53760
  s_waitcnt lgkmcnt(6)
  v_mfma_f32_32x32x16_bf16 v[64:79], a[116:119], v[36:39], v[64:79]
  ds_read_b64_tr_b16 v[20:21], v7 offset:53248
  ds_read_b64_tr_b16 v[22:23], v7 offset:53760
  s_add_u32 m0, s63, 98304
  s_nop 0
  buffer_load_dwordx4 v1, s[8:11], s60 offen lds
  s_waitcnt lgkmcnt(6)
  v_mfma_f32_32x32x16_bf16 v[80:95], a[116:119], v[40:43], v[80:95]
  ds_read_b64_tr_b16 v[24:25], v6 offset:61440
  ds_read_b64_tr_b16 v[26:27], v6 offset:61952
  s_add_u32 m0, s63, 99328
  s_add_u32 s58, s60, s62
  buffer_load_dwordx4 v1, s[8:11], s58 offen lds
  s_add_u32 s60, s60, s71
  s_waitcnt lgkmcnt(6)
  v_mfma_f32_32x32x16_bf16 v[96:111], a[116:119], v[44:47], v[96:111]
  ds_read_b64_tr_b16 v[28:29], v7 offset:61440
  ds_read_b64_tr_b16 v[30:31], v7 offset:61952
  s_add_u32 m0, s63, 106496
  s_nop 0
  buffer_load_dwordx4 v1, s[12:15], s61 offen lds
  s_waitcnt lgkmcnt(6)
  v_mfma_f32_32x32x16_bf16 v[48:63], a[120:123], v[16:19], v[48:63]
  ds_read_b64_tr_b16 v[32:33], v6 offset:55296
  ds_read_b64_tr_b16 v[34:35], v6 offset:55808
  s_add_u32 m0, s63, 107520
  s_add_u32 s58, s61, s62
  buffer_load_dwordx4 v1, s[12:15], s58 offen lds
  s_add_u32 s61, s61, s71
  s_waitcnt lgkmcnt(6)
  v_mfma_f32_32x32x16_bf16 v[64:79], a[120:123], v[20:23], v[64:79]
  ds_read_b64_tr_b16 v[36:37], v7 offset:55296
  ds_read_b64_tr_b16 v[38:39], v7 offset:55808
  s_waitcnt lgkmcnt(6)
  v_mfma_f32_32x32x16_bf16 v[80:95], a[120:123], v[24:27], v[80:95]
  ds_read_b64_tr_b16 v[40:41], v6 offset:63488
  ds_read_b64_tr_b16 v[42:43], v6 offset:64000
  s_waitcnt lgkmcnt(6)
  v_mfma_f32_32x32x16_bf16 v[96:111], a[120:123], v[28:31], v[96:111]
  ds_read_b64_tr_b16 v[44:45], v7 offset:63488
  ds_read_b64_tr_b16 v[46:47], v7 offset:64000
  s_waitcnt lgkmcnt(6)
  v_mfma_f32_32x32x16_bf16 v[48:63], a[124:127], v[32:35], v[48:63]
  ds_read_b64_tr_b16 v[16:17], v8 offset:0
  ds_read_b64_tr_b16 v[18:19], v8 offset:512
  s_waitcnt lgkmcnt(6)
  v_mfma_f32_32x32x16_bf16 v[64:79], a[124:127], v[36:39], v[64:79]
  ds_read_b64_tr_b16 v[20:21], v9 offset:0
  ds_read_b64_tr_b16 v[22:23], v9 offset:512
  s_waitcnt lgkmcnt(6)
  v_mfma_f32_32x32x16_bf16 v[80:95], a[124:127], v[40:43], v[80:95]
  ds_read_b64_tr_b16 v[24:25], v8 offset:8192
  ds_read_b64_tr_b16 v[26:27], v8 offset:8704
  s_waitcnt lgkmcnt(6)
  v_mfma_f32_32x32x16_bf16 v[96:111], a[124:127], v[44:47], v[96:111]
  ds_read_b64_tr_b16 v[28:29], v9 offset:8192
  ds_read_b64_tr_b16 v[30:31], v9 offset:8704
  s_waitcnt lgkmcnt(6)
  v_mfma_f32_32x32x16_bf16 v[48:63], a[128:131], v[16:19], v[48:63]
  ds_read_b64_tr_b16 v[32:33], v8 offset:2048
  ds_read_b64_tr_b16 v[34:35], v8 offset:2560
  s_waitcnt lgkmcnt(6)
  v_mfma_f32_32x32x16_bf16 v[64:79], a[128:131], v[20:23], v[64:79]
  ds_read_b64_tr_b16 v[36:37], v9 offset:2048
  ds_read_b64_tr_b16 v[38:39], v9 offset:2560
  s_waitcnt lgkmcnt(6)
  v_mfma_f32_32x32x16_bf16 v[80:95], a[128:131], v[24:27], v[80:95]
  ds_read_b64_tr_b16 v[40:41], v8 offset:10240
  ds_read_b64_tr_b16 v[42:43], v8 offset:10752
  s_waitcnt lgkmcnt(6)
  v_mfma_f32_32x32x16_bf16 v[96:111], a[128:131], v[28:31], v[96:111]
  ds_read_b64_tr_b16 v[44:45], v9 offset:10240
  ds_read_b64_tr_b16 v[46:47], v9 offset:10752
  s_waitcnt lgkmcnt(6)
  v_mfma_f32_32x32x16_bf16 v[48:63], a[132:135], v[32:35], v[48:63]
  s_waitcnt vmcnt(24)
  s_barrier
  ds_read_b64_tr_b16 v[16:17], v8 offset:4096
  ds_read_b64_tr_b16 v[18:19], v8 offset:4608
  s_waitcnt lgkmcnt(6)
  v_mfma_f32_32x32x16_bf16 v[64:79], a[132:135], v[36:39], v[64:79]
  ds_read_b64_tr_b16 v[20:21], v9 offset:4096
  ds_read_b64_tr_b16 v[22:23], v9 offset:4608
  s_add_u32 m0, s63, 114688
  s_nop 0
  buffer_load_dwordx4 v1, s[8:11], s60 offen lds
  s_waitcnt lgkmcnt(6)
  v_mfma_f32_32x32x16_bf16 v[80:95], a[132:135], v[40:43], v[80:95]
  ds_read_b64_tr_b16 v[24:25], v8 offset:12288
  ds_read_b64_tr_b16 v[26:27], v8 offset:12800
  s_add_u32 m0, s63, 115712
  s_add_u32 s58, s60, s62
  buffer_load_dwordx4 v1, s[8:11], s58 offen lds
  s_add_u32 s60, s60, s71
  s_waitcnt lgkmcnt(6)
  v_mfma_f32_32x32x16_bf16 v[96:111], a[132:135], v[44:47], v[96:111]
  ds_read_b64_tr_b16 v[28:29], v9 offset:12288
  ds_read_b64_tr_b16 v[30:31], v9 offset:12800
  s_add_u32 m0, s63, 122880
  s_nop 0
  buffer_load_dwordx4 v1, s[12:15], s61 offen lds
  s_waitcnt lgkmcnt(6)
  v_mfma_f32_32x32x16_bf16 v[48:63], a[136:139], v[16:19], v[48:63]
  ds_read_b64_tr_b16 v[32:33], v8 offset:6144
  ds_read_b64_tr_b16 v[34:35], v8 offset:6656
  s_add_u32 m0, s63, 123904
  s_add_u32 s58, s61, s62
  buffer_load_dwordx4 v1, s[12:15], s58 offen lds
  s_add_u32 s61, s61, s71
  s_waitcnt lgkmcnt(6)
  v_mfma_f32_32x32x16_bf16 v[64:79], a[136:139], v[20:23], v[64:79]
  ds_read_b64_tr_b16 v[36:37], v9 offset:6144
  ds_read_b64_tr_b16 v[38:39], v9 offset:6656
  s_waitcnt lgkmcnt(6)
  v_mfma_f32_32x32x16_bf16 v[80:95], a[136:139], v[24:27], v[80:95]
  ds_read_b64_tr_b16 v[40:41], v8 offset:14336
  ds_read_b64_tr_b16 v[42:43], v8 offset:14848
  s_waitcnt lgkmcnt(6)
  v_mfma_f32_32x32x16_bf16 v[96:111], a[136:139], v[28:31], v[96:111]
  ds_read_b64_tr_b16 v[44:45], v9 offset:14336
  ds_read_b64_tr_b16 v[46:47], v9 offset:14848
  s_waitcnt lgkmcnt(6)
  v_mfma_f32_32x32x16_bf16 v[48:63], a[140:143], v[32:35], v[48:63]
  ds_read_b64_tr_b16 v[16:17], v4 offset:0
  ds_read_b64_tr_b16 v[18:19], v4 offset:512
  s_waitcnt lgkmcnt(6)
  v_mfma_f32_32x32x16_bf16 v[64:79], a[140:143], v[36:39], v[64:79]
  ds_read_b64_tr_b16 v[20:21], v5 offset:0
  ds_read_b64_tr_b16 v[22:23], v5 offset:512
  s_waitcnt lgkmcnt(6)
  v_mfma_f32_32x32x16_bf16 v[80:95], a[140:143], v[40:43], v[80:95]
  ds_read_b64_tr_b16 v[24:25], v4 offset:8192
  ds_read_b64_tr_b16 v[26:27], v4 offset:8704
  s_waitcnt lgkmcnt(6)
  v_mfma_f32_32x32x16_bf16 v[96:111], a[140:143], v[44:47], v[96:111]
  ds_read_b64_tr_b16 v[28:29], v5 offset:8192
  ds_read_b64_tr_b16 v[30:31], v5 offset:8704
L_ep_store:
  s_add_u32 s55, s65, 4096
  v_cvt_pk_bf16_f32 v112, v48, v49
  v_cvt_pk_bf16_f32 v113, v50, v51
  v_cvt_pk_bf16_f32 v114, v56, v57
  v_cvt_pk_bf16_f32 v115, v58, v59
  buffer_store_dwordx4 v[112:115], v2, s[4:7], s65 offen offset:0 sc1
  v_cvt_pk_bf16_f32 v116, v52, v53
  v_cvt_pk_bf16_f32 v117, v54, v55
  v_cvt_pk_bf16_f32 v118, v60, v61
  v_cvt_pk_bf16_f32 v119, v62, v63
  buffer_store_dwordx4 v[116:119], v2, s[4:7], s65 offen offset:512 sc1
  v_cvt_pk_bf16_f32 v120, v64, v65
  v_cvt_pk_bf16_f32 v121, v66, v67
  v_cvt_pk_bf16_f32 v122, v72, v73
  v_cvt_pk_bf16_f32 v123, v74, v75
  buffer_store_dwordx4 v[120:123], v2, s[4:7], s65 offen offset:2048 sc1
  v_cvt_pk_bf16_f32 v124, v68, v69
  v_cvt_pk_bf16_f32 v125, v70, v71
  v_cvt_pk_bf16_f32 v126, v76, v77
  v_cvt_pk_bf16_f32 v127, v78, v79
  buffer_store_dwordx4 v[124:127], v2, s[4:7], s65 offen offset:2560 sc1
  v_cvt_pk_bf16_f32 v128, v80, v81
  v_cvt_pk_bf16_f32 v129, v82, v83
  v_cvt_pk_bf16_f32 v130, v88, v89
  v_cvt_pk_bf16_f32 v131, v90, v91
  buffer_store_dwordx4 v[128:131], v2, s[4:7], s55 offen offset:0 sc1
  v_cvt_pk_bf16_f32 v132, v84, v85
  v_cvt_pk_bf16_f32 v133, v86, v87
  v_cvt_pk_bf16_f32 v134, v92, v93
  v_cvt_pk_bf16_f32 v135, v94, v95
  buffer_store_dwordx4 v[132:135], v2, s[4:7], s55 offen offset:512 sc1
  v_cvt_pk_bf16_f32 v136, v96, v97
  v_cvt_pk_bf16_f32 v137, v98, v99
  v_cvt_pk_bf16_f32 v138, v104, v105
  v_cvt_pk_bf16_f32 v139, v106, v107
  buffer_store_dwordx4 v[136:139], v2, s[4:7], s55 offen offset:2048 sc1
  v_cvt_pk_bf16_f32 v140, v100, v101
  v_cvt_pk_bf16_f32 v141, v102, v103
  v_cvt_pk_bf16_f32 v142, v108, v109
  v_cvt_pk_bf16_f32 v143, v110, v111
  buffer_store_dwordx4 v[140:143], v2, s[4:7], s55 offen offset:2560 sc1
L_unit_end:
  s_mov_b32 s67, s66
  s_cmp_lg_u32 s68, 3
  s_cbranch_scc1 L_unit
  s_waitcnt vmcnt(0) lgkmcnt(0)
  s_barrier
  s_cmp_lg_u32 s20, 0
  s_cbranch_scc1 L_units_done
  s_mov_b64 exec, 1
  buffer_store_dword v6, v3, s[4:7], s67 offen sc1
  s_mov_b64 exec, -1
L_units_done:
  s_mov_b32 s52, s74
  s_cmp_lt_u32 s74, 16
  s_cbranch_scc1 L_restart
  s_and_b32 s52, s21, 15
  s_cmp_ge_u32 s53, 12
  s_cbranch_scc1 L_down_done
  s_mul_i32 s67, s53, 22
  s_lshr_b32 s67, s67, 6
  s_mul_i32 s55, s67, 3
  s_sub_u32 s66, s53, s55
  s_mov_b32 s8, s44
  s_and_b32 s9, s45, 0xffff
  s_mov_b32 s10, 0x510000
  s_mov_b32 s11, 0x20000
  s_mul_i32 s62, s67, 1327104
  s_mul_i32 s55, s20, 18432
  s_add_u32 s62, s62, s55
  s_mul_i32 s55, s66, 384
  s_add_u32 s62, s62, s55
  s_mov_b32 s61, s63
  s_add_u32 m0, s61, 0
  s_add_u32 s58, s62, 0
  buffer_load_dwordx4 v12, s[8:11], s58 offen lds
  s_add_u32 m0, s61, 1024
  s_add_u32 s58, s62, 9216
  buffer_load_dwordx4 v12, s[8:11], s58 offen lds
  s_add_u32 m0, s61, 8192
  s_add_u32 s58, s62, 128
  buffer_load_dwordx4 v12, s[8:11], s58 offen lds
  s_add_u32 m0, s61, 9216
  s_add_u32 s58, s62, 9344
  buffer_load_dwordx4 v12, s[8:11], s58 offen lds
  s_add_u32 m0, s61, 16384
  s_add_u32 s58, s62, 256
  buffer_load_dwordx4 v12, s[8:11], s58 offen lds
  s_add_u32 m0, s61, 17408
  s_add_u32 s58, s62, 9472
  buffer_load_dwordx4 v12, s[8:11], s58 offen lds
  s_add_u32 s62, s62, 73728
  s_add_u32 s61, s61, 24576
  s_sub_u32 s58, s61, 147456
  s_cselect_b32 s61, s61, s58
  s_add_u32 m0, s61, 0
  s_add_u32 s58, s62, 0
  buffer_load_dwordx4 v12, s[8:11], s58 offen lds
  s_add_u32 m0, s61, 1024
  s_add_u32 s58, s62, 9216
  buffer_load_dwordx4 v12, s[8:11], s58 offen lds
  s_add_u32 m0, s61, 8192
  s_add_u32 s58, s62, 128
  buffer_load_dwordx4 v12, s[8:11], s58 offen lds
  s_add_u32 m0, s61, 9216
  s_add_u32 s58, s62, 9344
  buffer_load_dwordx4 v12, s[8:11], s58 offen lds
  s_add_u32 m0, s61, 16384
  s_add_u32 s58, s62, 256
  buffer_load_dwordx4 v12, s[8:11], s58 offen lds
  s_add_u32 m0, s61, 17408
  s_add_u32 s58, s62, 9472
  buffer_load_dwordx4 v12, s[8:11], s58 offen lds
  s_add_u32 s62, s62, 73728
  s_add_u32 s61, s61, 24576
  s_sub_u32 s58, s61, 147456
  s_cselect_b32 s61, s61, s58
  s_add_u32 m0, s61, 0
  s_add_u32 s58, s62, 0
  buffer_load_dwordx4 v12, s[8:11], s58 offen lds
  s_add_u32 m0, s61, 1024
  s_add_u32 s58, s62, 9216
  buffer_load_dwordx4 v12, s[8:11], s58 offen lds
  s_add_u32 m0, s61, 8192
  s_add_u32 s58, s62, 128
  buffer_load_dwordx4 v12, s[8:11], s58 offen lds
  s_add_u32 m0, s61, 9216
  s_add_u32 s58, s62, 9344
  buffer_load_dwordx4 v12, s[8:11], s58 offen lds
  s_add_u32 m0, s61, 16384
  s_add_u32 s58, s62, 256
  buffer_load_dwordx4 v12, s[8:11], s58 offen lds
  s_add_u32 m0, s61, 17408
  s_add_u32 s58, s62, 9472
  buffer_load_dwordx4 v12, s[8:11], s58 offen lds
  s_add_u32 s62, s62, 73728
  s_add_u32 s61, s61, 24576
  s_sub_u32 s58, s61, 147456
  s_cselect_b32 s61, s61, s58
  s_add_u32 m0, s61, 0
  s_add_u32 s58, s62, 0
  buffer_load_dwordx4 v12, s[8:11], s58 offen lds
  s_add_u32 m0, s61, 1024
  s_add_u32 s58, s62, 9216
  buffer_load_dwordx4 v12, s[8:11], s58 offen lds
  s_add_u32 m0, s61, 8192
  s_add_u32 s58, s62, 128
  buffer_load_dwordx4 v12, s[8:11], s58 offen lds
  s_add_u32 m0, s61, 9216
  s_add_u32 s58, s62, 9344
  buffer_load_dwordx4 v12, s[8:11], s58 offen lds
  s_add_u32 m0, s61, 16384
  s_add_u32 s58, s62, 256
  buffer_load_dwordx4 v12, s[8:11], s58 offen lds
  s_add_u32 m0, s61, 17408
  s_add_u32 s58, s62, 9472
  buffer_load_dwordx4 v12, s[8:11], s58 offen lds
  s_add_u32 s62, s62, 73728
  s_add_u32 s61, s61, 24576
  s_sub_u32 s58, s61, 147456
  s_cselect_b32 s61, s61, s58
  s_lshl_b32 s55, s52, 10
  s_mul_i32 s56, s67, 72
  s_add_u32 s55, s55, s56
  s_add_u32 s55, s55, 0x3204180
  v_lshrrev_b32 v226, 2, v3
  s_mov_b32 exec_lo, 0x3ffff
  s_mov_b32 exec_hi, 0x0
L_dn_p0:
  buffer_load_dword v227, v226, s[4:7], s55 offen sc1
  s_add_u32 s59, s59, 1
  s_cmp_ge_u32 s59, 0x8000
  s_waitcnt vmcnt(0)
  v_cmp_eq_u32 vcc, 0, v227
  s_cbranch_scc1 L_dn_p0_x
  s_cbranch_vccz L_dn_p0_x
  s_sleep 2
  s_branch L_dn_p0
L_dn_p0_x:
  s_mov_b64 exec, -1
  s_lshl_b32 s55, s52, 2
  s_add_u32 s55, s55, s20
  s_mul_i32 s64, s55, 294912
  s_mul_i32 s56, s67, 73728
  s_add_u32 s64, s64, s56
  s_add_u32 s64, s64, 0x5000000
  buffer_load_dwordx4 v[160:163], v3, s[4:7], s64 offen offset:0 sc1
  buffer_load_dwordx4 v[164:167], v3, s[4:7], s64 offen offset:1024 sc1
  buffer_load_dwordx4 v[168:171], v3, s[4:7], s64 offen offset:2048 sc1
  buffer_load_dwordx4 v[172:175], v3, s[4:7], s64 offen offset:3072 sc1
  s_add_u32 s64, s64, 4096
  buffer_load_dwordx4 v[176:179], v3, s[4:7], s64 offen offset:0 sc1
  buffer_load_dwordx4 v[180:183], v3, s[4:7], s64 offen offset:1024 sc1
  buffer_load_dwordx4 v[184:187], v3, s[4:7], s64 offen offset:2048 sc1
  buffer_load_dwordx4 v[188:191], v3, s[4:7], s64 offen offset:3072 sc1
  s_add_u32 s64, s64, 4096
  buffer_load_dwordx4 v[192:195], v3, s[4:7], s64 offen offset:0 sc1
  buffer_load_dwordx4 v[196:199], v3, s[4:7], s64 offen offset:1024 sc1
  buffer_load_dwordx4 v[200:203], v3, s[4:7], s64 offen offset:2048 sc1
  buffer_load_dwordx4 v[204:207], v3, s[4:7], s64 offen offset:3072 sc1
  s_add_u32 s64, s64, 4096
  v_mov_b64 v[16:17], 0
  v_mov_b64 v[18:19], 0
  v_mov_b64 v[20:21], 0
  v_mov_b64 v[22:23], 0
  v_mov_b64 v[24:25], 0
  v_mov_b64 v[26:27], 0
  v_mov_b64 v[28:29], 0
  v_mov_b64 v[30:31], 0
  v_mov_b64 v[32:33], 0
  v_mov_b64 v[34:35], 0
  v_mov_b64 v[36:37], 0
  v_mov_b64 v[38:39], 0
  v_mov_b64 v[40:41], 0
  v_mov_b64 v[42:43], 0
  v_mov_b64 v[44:45], 0
  v_mov_b64 v[46:47], 0
  v_mov_b64 v[48:49], 0
  v_mov_b64 v[50:51], 0
  v_mov_b64 v[52:53], 0
  v_mov_b64 v[54:55], 0
  v_mov_b64 v[56:57], 0
  v_mov_b64 v[58:59], 0
  v_mov_b64 v[60:61], 0
  v_mov_b64 v[62:63], 0
  v_mov_b64 v[64:65], 0
  v_mov_b64 v[66:67], 0
  v_mov_b64 v[68:69], 0
  v_mov_b64 v[70:71], 0
  v_mov_b64 v[72:73], 0
  v_mov_b64 v[74:75], 0
  v_mov_b64 v[76:77], 0
  v_mov_b64 v[78:79], 0
  v_mov_b64 v[80:81], 0
  v_mov_b64 v[82:83], 0
  v_mov_b64 v[84:85], 0
  v_mov_b64 v[86:87], 0
  v_mov_b64 v[88:89], 0
  v_mov_b64 v[90:91], 0
  v_mov_b64 v[92:93], 0
  v_mov_b64 v[94:95], 0
  v_mov_b64 v[96:97], 0
  v_mov_b64 v[98:99], 0
  v_mov_b64 v[100:101], 0
  v_mov_b64 v[102:103], 0
  v_mov_b64 v[104:105], 0
  v_mov_b64 v[106:107], 0
  v_mov_b64 v[108:109], 0
  v_mov_b64 v[110:111], 0
  s_mov_b32 s60, 0
  s_mov_b32 s65, 0
  v_mov_b32 v224, v13
  v_mov_b32 v225, v14
  s_waitcnt vmcnt(4)
  s_barrier
  ds_read_b64_tr_b16 v[112:113], v224 offset:0
  ds_read_b64_tr_b16 v[114:115], v224 offset:2048
  ds_read_b64_tr_b16 v[116:117], v225 offset:0
  ds_read_b64_tr_b16 v[118:119], v225 offset:2048
  ds_read_b64_tr_b16 v[120:121], v224 offset:8192
  ds_read_b64_tr_b16 v[122:123], v224 offset:10240
  ds_read_b64_tr_b16 v[124:125], v225 offset:8192
  ds_read_b64_tr_b16 v[126:127], v225 offset:10240
  ds_read_b64_tr_b16 v[128:129], v224 offset:16384
  ds_read_b64_tr_b16 v[130:131], v224 offset:18432
  ds_read_b64_tr_b16 v[132:133], v225 offset:16384
  ds_read_b64_tr_b16 v[134:135], v225 offset:18432
L_dn_loop:
  s_waitcnt lgkmcnt(10)
  v_mfma_f32_32x32x16_bf16 v[16:31], v[112:115], v[160:163], v[16:31]
  ds_read_b64_tr_b16 v[136:137], v224 offset:1024
  ds_read_b64_tr_b16 v[138:139], v224 offset:3072
  s_waitcnt lgkmcnt(10)
  v_mfma_f32_32x32x16_bf16 v[32:47], v[116:119], v[160:163], v[32:47]
  ds_read_b64_tr_b16 v[140:141], v225 offset:1024
  ds_read_b64_tr_b16 v[142:143], v225 offset:3072
  s_waitcnt lgkmcnt(10)
  v_mfma_f32_32x32x16_bf16 v[48:63], v[120:123], v[160:163], v[48:63]
  ds_read_b64_tr_b16 v[144:145], v224 offset:9216
  ds_read_b64_tr_b16 v[146:147], v224 offset:11264
  s_waitcnt lgkmcnt(10)
  v_mfma_f32_32x32x16_bf16 v[64:79], v[124:127], v[160:163], v[64:79]
  s_waitcnt vmcnt(10)
  s_barrier
  ds_read_b64_tr_b16 v[148:149], v225 offset:9216
  ds_read_b64_tr_b16 v[150:151], v225 offset:11264
  s_add_u32 m0, s61, 0
  s_add_u32 s58, s62, 0
  s_waitcnt lgkmcnt(10)
  v_mfma_f32_32x32x16_bf16 v[80:95], v[128:131], v[160:163], v[80:95]
  ds_read_b64_tr_b16 v[152:153], v224 offset:17408
  ds_read_b64_tr_b16 v[154:155], v224 offset:19456
  buffer_load_dwordx4 v12, s[8:11], s58 offen lds
  s_waitcnt lgkmcnt(10)
  v_mfma_f32_32x32x16_bf16 v[96:111], v[132:135], v[160:163], v[96:111]
  ds_read_b64_tr_b16 v[156:157], v225 offset:17408
  ds_read_b64_tr_b16 v[158:159], v225 offset:19456
  s_add_u32 m0, s61, 1024
  s_add_u32 s58, s62, 9216
  s_waitcnt lgkmcnt(10)
  v_mfma_f32_32x32x16_bf16 v[16:31], v[136:139], v[164:167], v[16:31]
  ds_read_b64_tr_b16 v[112:113], v224 offset:4096
  ds_read_b64_tr_b16 v[114:115], v224 offset:6144
  buffer_load_dwordx4 v12, s[8:11], s58 offen lds
  s_waitcnt lgkmcnt(10)
  v_mfma_f32_32x32x16_bf16 v[32:47], v[140:143], v[164:167], v[32:47]
  ds_read_b64_tr_b16 v[116:117], v225 offset:4096
  ds_read_b64_tr_b16 v[118:119], v225 offset:6144
  s_add_u32 m0, s61, 8192
  s_add_u32 s58, s62, 128
  s_waitcnt lgkmcnt(10)
  v_mfma_f32_32x32x16_bf16 v[48:63], v[144:147], v[164:167], v[48:63]
  ds_read_b64_tr_b16 v[120:121], v224 offset:12288
  ds_read_b64_tr_b16 v[122:123], v224 offset:14336
  buffer_load_dwordx4 v12, s[8:11], s58 offen lds
  s_waitcnt lgkmcnt(10)
  v_mfma_f32_32x32x16_bf16 v[64:79], v[148:151], v[164:167], v[64:79]
  ds_read_b64_tr_b16 v[124:125], v225 offset:12288
  ds_read_b64_tr_b16 v[126:127], v225 offset:14336
  s_add_u32 m0, s61, 9216
  s_add_u32 s58, s62, 9344
  s_waitcnt lgkmcnt(10)
  v_mfma_f32_32x32x16_bf16 v[80:95], v[152:155], v[164:167], v[80:95]
  ds_read_b64_tr_b16 v[128:129], v224 offset:20480
  ds_read_b64_tr_b16 v[130:131], v224 offset:22528
  buffer_load_dwordx4 v12, s[8:11], s58 offen lds
  s_waitcnt lgkmcnt(10)
  v_mfma_f32_32x32x16_bf16 v[96:111], v[156:159], v[164:167], v[96:111]
  ds_read_b64_tr_b16 v[132:133], v225 offset:20480
  ds_read_b64_tr_b16 v[134:135], v225 offset:22528
  s_add_u32 m0, s61, 16384
  s_add_u32 s58, s62, 256
  s_waitcnt lgkmcnt(10)
  v_mfma_f32_32x32x16_bf16 v[16:31], v[112:115], v[168:171], v[16:31]
  ds_read_b64_tr_b16 v[136:137], v224 offset:5120
  ds_read_b64_tr_b16 v[138:139], v224 offset:7168
  buffer_load_dwordx4 v12, s[8:11], s58 offen lds
  s_waitcnt lgkmcnt(10)
  v_mfma_f32_32x32x16_bf16 v[32:47], v[116:119], v[168:171], v[32:47]
  ds_read_b64_tr_b16 v[140:141], v225 offset:5120
  ds_read_b64_tr_b16 v[142:143], v225 offset:7168
  s_add_u32 m0, s61, 17408
  s_add_u32 s58, s62, 9472
  s_waitcnt lgkmcnt(10)
  v_mfma_f32_32x32x16_bf16 v[48:63], v[120:123], v[168:171], v[48:63]
  ds_read_b64_tr_b16 v[144:145], v224 offset:13312
  ds_read_b64_tr_b16 v[146:147], v224 offset:15360
  buffer_load_dwordx4 v12, s[8:11], s58 offen lds
  s_waitcnt lgkmcnt(10)
  v_mfma_f32_32x32x16_bf16 v[64:79], v[124:127], v[168:171], v[64:79]
  ds_read_b64_tr_b16 v[148:149], v225 offset:13312
  ds_read_b64_tr_b16 v[150:151], v225 offset:15360
  s_add_u32 s62, s62, 73728
  s_add_u32 s61, s61, 24576
  s_waitcnt lgkmcnt(10)
  v_mfma_f32_32x32x16_bf16 v[80:95], v[128:131], v[168:171], v[80:95]
  ds_read_b64_tr_b16 v[152:153], v224 offset:21504
  ds_read_b64_tr_b16 v[154:155], v224 offset:23552
  s_sub_u32 s58, s61, 147456
  s_cselect_b32 s61, s61, s58
  s_waitcnt lgkmcnt(10)
  v_mfma_f32_32x32x16_bf16 v[96:111], v[132:135], v[168:171], v[96:111]
  ds_read_b64_tr_b16 v[156:157], v225 offset:21504
  ds_read_b64_tr_b16 v[158:159], v225 offset:23552
  buffer_load_dwordx4 v[208:211], v3, s[4:7], s64 offen offset:0 sc1
  s_waitcnt lgkmcnt(10)
  v_mfma_f32_32x32x16_bf16 v[16:31], v[136:139], v[172:175], v[16:31]
  s_add_u32 s60, s60, 24576
  s_cmp_eq_u32 s60, 147456
  s_cselect_b32 s60, 0, s60
  v_add_u32 v224, s60, v13
  v_add_u32 v225, s60, v14
  ds_read_b64_tr_b16 v[112:113], v224 offset:0
  ds_read_b64_tr_b16 v[114:115], v224 offset:2048
  buffer_load_dwordx4 v[212:215], v3, s[4:7], s64 offen offset:1024 sc1
  s_waitcnt lgkmcnt(10)
  v_mfma_f32_32x32x16_bf16 v[32:47], v[140:143], v[172:175], v[32:47]
  ds_read_b64_tr_b16 v[116:117], v225 offset:0
  ds_read_b64_tr_b16 v[118:119], v225 offset:2048
  buffer_load_dwordx4 v[216:219], v3, s[4:7], s64 offen offset:2048 sc1
  s_waitcnt lgkmcnt(10)
  v_mfma_f32_32x32x16_bf16 v[48:63], v[144:147], v[172:175], v[48:63]
  ds_read_b64_tr_b16 v[120:121], v224 offset:8192
  ds_read_b64_tr_b16 v[122:123], v224 offset:10240
  buffer_load_dwordx4 v[220:223], v3, s[4:7], s64 offen offset:3072 sc1
  s_waitcnt lgkmcnt(10)
  v_mfma_f32_32x32x16_bf16 v[64:79], v[148:151], v[172:175], v[64:79]
  ds_read_b64_tr_b16 v[124:125], v225 offset:8192
  ds_read_b64_tr_b16 v[126:127], v225 offset:10240
  s_add_u32 s64, s64, 4096
  s_waitcnt lgkmcnt(10)
  v_mfma_f32_32x32x16_bf16 v[80:95], v[152:155], v[172:175], v[80:95]
  ds_read_b64_tr_b16 v[128:129], v224 offset:16384
  ds_read_b64_tr_b16 v[130:131], v224 offset:18432
  s_waitcnt lgkmcnt(10)
  v_mfma_f32_32x32x16_bf16 v[96:111], v[156:159], v[172:175], v[96:111]
  ds_read_b64_tr_b16 v[132:133], v225 offset:16384
  ds_read_b64_tr_b16 v[134:135], v225 offset:18432
  s_waitcnt lgkmcnt(10)
  v_mfma_f32_32x32x16_bf16 v[16:31], v[112:115], v[176:179], v[16:31]
  ds_read_b64_tr_b16 v[136:137], v224 offset:1024
  ds_read_b64_tr_b16 v[138:139], v224 offset:3072
  s_waitcnt lgkmcnt(10)
  v_mfma_f32_32x32x16_bf16 v[32:47], v[116:119], v[176:179], v[32:47]
  ds_read_b64_tr_b16 v[140:141], v225 offset:1024
  ds_read_b64_tr_b16 v[142:143], v225 offset:3072
  s_waitcnt lgkmcnt(10)
  v_mfma_f32_32x32x16_bf16 v[48:63], v[120:123], v[176:179], v[48:63]
  ds_read_b64_tr_b16 v[144:145], v224 offset:9216
  ds_read_b64_tr_b16 v[146:147], v224 offset:11264
  s_waitcnt lgkmcnt(10)
  v_mfma_f32_32x32x16_bf16 v[64:79], v[124:127], v[176:179], v[64:79]
  s_waitcnt vmcnt(10)
  s_barrier
  ds_read_b64_tr_b16 v[148:149], v225 offset:9216
  ds_read_b64_tr_b16 v[150:151], v225 offset:11264
  s_add_u32 m0, s61, 0
  s_add_u32 s58, s62, 0
  s_waitcnt lgkmcnt(10)
  v_mfma_f32_32x32x16_bf16 v[80:95], v[128:131], v[176:179], v[80:95]
  ds_read_b64_tr_b16 v[152:153], v224 offset:17408
  ds_read_b64_tr_b16 v[154:155], v224 offset:19456
  buffer_load_dwordx4 v12, s[8:11], s58 offen lds
  s_waitcnt lgkmcnt(10)
  v_mfma_f32_32x32x16_bf16 v[96:111], v[132:135], v[176:179], v[96:111]
  ds_read_b64_tr_b16 v[156:157], v225 offset:17408
  ds_read_b64_tr_b16 v[158:159], v225 offset:19456
  s_add_u32 m0, s61, 1024
  s_add_u32 s58, s62, 9216
  s_waitcnt lgkmcnt(10)
  v_mfma_f32_32x32x16_bf16 v[16:31], v[136:139], v[180:183], v[16:31]
  ds_read_b64_tr_b16 v[112:113], v224 offset:4096
  ds_read_b64_tr_b16 v[114:115], v224 offset:6144
  buffer_load_dwordx4 v12, s[8:11], s58 offen lds
  s_waitcnt lgkmcnt(10)
  v_mfma_f32_32x32x16_bf16 v[32:47], v[140:143], v[180:183], v[32:47]
  ds_read_b64_tr_b16 v[116:117], v225 offset:4096
  ds_read_b64_tr_b16 v[118:119], v225 offset:6144
  s_add_u32 m0, s61, 8192
  s_add_u32 s58, s62, 128
  s_waitcnt lgkmcnt(10)
  v_mfma_f32_32x32x16_bf16 v[48:63], v[144:147], v[180:183], v[48:63]
  ds_read_b64_tr_b16 v[120:121], v224 offset:12288
  ds_read_b64_tr_b16 v[122:123], v224 offset:14336
  buffer_load_dwordx4 v12, s[8:11], s58 offen lds
  s_waitcnt lgkmcnt(10)
  v_mfma_f32_32x32x16_bf16 v[64:79], v[148:151], v[180:183], v[64:79]
  ds_read_b64_tr_b16 v[124:125], v225 offset:12288
  ds_read_b64_tr_b16 v[126:127], v225 offset:14336
  s_add_u32 m0, s61, 9216
  s_add_u32 s58, s62, 9344
  s_waitcnt lgkmcnt(10)
  v_mfma_f32_32x32x16_bf16 v[80:95], v[152:155], v[180:183], v[80:95]
  ds_read_b64_tr_b16 v[128:129], v224 offset:20480
  ds_read_b64_tr_b16 v[130:131], v224 offset:22528
  buffer_load_dwordx4 v12, s[8:11], s58 offen lds
  s_waitcnt lgkmcnt(10)
  v_mfma_f32_32x32x16_bf16 v[96:111], v[156:159], v[180:183], v[96:111]
  ds_read_b64_tr_b16 v[132:133], v225 offset:20480
  ds_read_b64_tr_b16 v[134:135], v225 offset:22528
  s_add_u32 m0, s61, 16384
  s_add_u32 s58, s62, 256
  s_waitcnt lgkmcnt(10)
  v_mfma_f32_32x32x16_bf16 v[16:31], v[112:115], v[184:187], v[16:31]
  ds_read_b64_tr_b16 v[136:137], v224 offset:5120
  ds_read_b64_tr_b16 v[138:139], v224 offset:7168
  buffer_load_dwordx4 v12, s[8:11], s58 offen lds
  s_waitcnt lgkmcnt(10)
  v_mfma_f32_32x32x16_bf16 v[32:47], v[116:119], v[184:187], v[32:47]
  ds_read_b64_tr_b16 v[140:141], v225 offset:5120
  ds_read_b64_tr_b16 v[142:143], v225 offset:7168
  s_add_u32 m0, s61, 17408
  s_add_u32 s58, s62, 9472
  s_waitcnt lgkmcnt(10)
  v_mfma_f32_32x32x16_bf16 v[48:63], v[120:123], v[184:187], v[48:63]
  ds_read_b64_tr_b16 v[144:145], v224 offset:13312
  ds_read_b64_tr_b16 v[146:147], v224 offset:15360
  buffer_load_dwordx4 v12, s[8:11], s58 offen lds
  s_waitcnt lgkmcnt(10)
  v_mfma_f32_32x32x16_bf16 v[64:79], v[124:127], v[184:187], v[64:79]
  ds_read_b64_tr_b16 v[148:149], v225 offset:13312
  ds_read_b64_tr_b16 v[150:151], v225 offset:15360
  s_add_u32 s62, s62, 73728
  s_add_u32 s61, s61, 24576
  s_waitcnt lgkmcnt(10)
  v_mfma_f32_32x32x16_bf16 v[80:95], v[128:131], v[184:187], v[80:95]
  ds_read_b64_tr_b16 v[152:153], v224 offset:21504
  ds_read_b64_tr_b16 v[154:155], v224 offset:23552
  s_sub_u32 s58, s61, 147456
  s_cselect_b32 s61, s61, s58
  s_waitcnt lgkmcnt(10)
  v_mfma_f32_32x32x16_bf16 v[96:111], v[132:135], v[184:187], v[96:111]
  ds_read_b64_tr_b16 v[156:157], v225 offset:21504
  ds_read_b64_tr_b16 v[158:159], v225 offset:23552
  buffer_load_dwordx4 v[160:163], v3, s[4:7], s64 offen offset:0 sc1
  s_waitcnt lgkmcnt(10)
  v_mfma_f32_32x32x16_bf16 v[16:31], v[136:139], v[188:191], v[16:31]
  s_add_u32 s60, s60, 24576
  s_cmp_eq_u32 s60, 147456
  s_cselect_b32 s60, 0, s60
  v_add_u32 v224, s60, v13
  v_add_u32 v225, s60, v14
  ds_read_b64_tr_b16 v[112:113], v224 offset:0
  ds_read_b64_tr_b16 v[114:115], v224 offset:2048
  buffer_load_dwordx4 v[164:167], v3, s[4:7], s64 offen offset:1024 sc1
  s_waitcnt lgkmcnt(10)
  v_mfma_f32_32x32x16_bf16 v[32:47], v[140:143], v[188:191], v[32:47]
  ds_read_b64_tr_b16 v[116:117], v225 offset:0
  ds_read_b64_tr_b16 v[118:119], v225 offset:2048
  buffer_load_dwordx4 v[168:171], v3, s[4:7], s64 offen offset:2048 sc1
  s_waitcnt lgkmcnt(10)
  v_mfma_f32_32x32x16_bf16 v[48:63], v[144:147], v[188:191], v[48:63]
  ds_read_b64_tr_b16 v[120:121], v224 offset:8192
  ds_read_b64_tr_b16 v[122:123], v224 offset:10240
  buffer_load_dwordx4 v[172:175], v3, s[4:7], s64 offen offset:3072 sc1
  s_waitcnt lgkmcnt(10)
  v_mfma_f32_32x32x16_bf16 v[64:79], v[148:151], v[188:191], v[64:79]
  ds_read_b64_tr_b16 v[124:125], v225 offset:8192
  ds_read_b64_tr_b16 v[126:127], v225 offset:10240
  s_add_u32 s64, s64, 4096
  s_waitcnt lgkmcnt(10)
  v_mfma_f32_32x32x16_bf16 v[80:95], v[152:155], v[188:191], v[80:95]
  ds_read_b64_tr_b16 v[128:129], v224 offset:16384
  ds_read_b64_tr_b16 v[130:131], v224 offset:18432
  s_waitcnt lgkmcnt(10)
  v_mfma_f32_32x32x16_bf16 v[96:111], v[156:159], v[188:191], v[96:111]
  ds_read_b64_tr_b16 v[132:133], v225 offset:16384
  ds_read_b64_tr_b16 v[134:135], v225 offset:18432
  s_cmp_eq_u32 s65, 4
  s_cbranch_scc1 L_dn_fin
  s_waitcnt lgkmcnt(10)
  v_mfma_f32_32x32x16_bf16 v[16:31], v[112:115], v[192:195], v[16:31]
  ds_read_b64_tr_b16 v[136:137], v224 offset:1024
  ds_read_b64_tr_b16 v[138:139], v224 offset:3072
  s_waitcnt lgkmcnt(10)
  v_mfma_f32_32x32x16_bf16 v[32:47], v[116:119], v[192:195], v[32:47]
  ds_read_b64_tr_b16 v[140:141], v225 offset:1024
  ds_read_b64_tr_b16 v[142:143], v225 offset:3072
  s_waitcnt lgkmcnt(10)
  v_mfma_f32_32x32x16_bf16 v[48:63], v[120:123], v[192:195], v[48:63]
  ds_read_b64_tr_b16 v[144:145], v224 offset:9216
  ds_read_b64_tr_b16 v[146:147], v224 offset:11264
  s_waitcnt lgkmcnt(10)
  v_mfma_f32_32x32x16_bf16 v[64:79], v[124:127], v[192:195], v[64:79]
  s_waitcnt vmcnt(10)
  s_barrier
  ds_read_b64_tr_b16 v[148:149], v225 offset:9216
  ds_read_b64_tr_b16 v[150:151], v225 offset:11264
  s_add_u32 m0, s61, 0
  s_add_u32 s58, s62, 0
  s_waitcnt lgkmcnt(10)
  v_mfma_f32_32x32x16_bf16 v[80:95], v[128:131], v[192:195], v[80:95]
  ds_read_b64_tr_b16 v[152:153], v224 offset:17408
  ds_read_b64_tr_b16 v[154:155], v224 offset:19456
  buffer_load_dwordx4 v12, s[8:11], s58 offen lds
  s_waitcnt lgkmcnt(10)
  v_mfma_f32_32x32x16_bf16 v[96:111], v[132:135], v[192:195], v[96:111]
  ds_read_b64_tr_b16 v[156:157], v225 offset:17408
  ds_read_b64_tr_b16 v[158:159], v225 offset:19456
  s_add_u32 m0, s61, 1024
  s_add_u32 s58, s62, 9216
  s_waitcnt lgkmcnt(10)
  v_mfma_f32_32x32x16_bf16 v[16:31], v[136:139], v[196:199], v[16:31]
  ds_read_b64_tr_b16 v[112:113], v224 offset:4096
  ds_read_b64_tr_b16 v[114:115], v224 offset:6144
  buffer_load_dwordx4 v12, s[8:11], s58 offen lds
  s_waitcnt lgkmcnt(10)
  v_mfma_f32_32x32x16_bf16 v[32:47], v[140:143], v[196:199], v[32:47]
  ds_read_b64_tr_b16 v[116:117], v225 offset:4096
  ds_read_b64_tr_b16 v[118:119], v225 offset:6144
  s_add_u32 m0, s61, 8192
  s_add_u32 s58, s62, 128
  s_waitcnt lgkmcnt(10)
  v_mfma_f32_32x32x16_bf16 v[48:63], v[144:147], v[196:199], v[48:63]
  ds_read_b64_tr_b16 v[120:121], v224 offset:12288
  ds_read_b64_tr_b16 v[122:123], v224 offset:14336
  buffer_load_dwordx4 v12, s[8:11], s58 offen lds
  s_waitcnt lgkmcnt(10)
  v_mfma_f32_32x32x16_bf16 v[64:79], v[148:151], v[196:199], v[64:79]
  ds_read_b64_tr_b16 v[124:125], v225 offset:12288
  ds_read_b64_tr_b16 v[126:127], v225 offset:14336
  s_add_u32 m0, s61, 9216
  s_add_u32 s58, s62, 9344
  s_waitcnt lgkmcnt(10)
  v_mfma_f32_32x32x16_bf16 v[80:95], v[152:155], v[196:199], v[80:95]
  ds_read_b64_tr_b16 v[128:129], v224 offset:20480
  ds_read_b64_tr_b16 v[130:131], v224 offset:22528
  buffer_load_dwordx4 v12, s[8:11], s58 offen lds
  s_waitcnt lgkmcnt(10)
  v_mfma_f32_32x32x16_bf16 v[96:111], v[156:159], v[196:199], v[96:111]
  ds_read_b64_tr_b16 v[132:133], v225 offset:20480
  ds_read_b64_tr_b16 v[134:135], v225 offset:22528
  s_add_u32 m0, s61, 16384
  s_add_u32 s58, s62, 256
  s_waitcnt lgkmcnt(10)
  v_mfma_f32_32x32x16_bf16 v[16:31], v[112:115], v[200:203], v[16:31]
  ds_read_b64_tr_b16 v[136:137], v224 offset:5120
  ds_read_b64_tr_b16 v[138:139], v224 offset:7168
  buffer_load_dwordx4 v12, s[8:11], s58 offen lds
  s_waitcnt lgkmcnt(10)
  v_mfma_f32_32x32x16_bf16 v[32:47], v[116:119], v[200:203], v[32:47]
  ds_read_b64_tr_b16 v[140:141], v225 offset:5120
  ds_read_b64_tr_b16 v[142:143], v225 offset:7168
  s_add_u32 m0, s61, 17408
  s_add_u32 s58, s62, 9472
  s_waitcnt lgkmcnt(10)
  v_mfma_f32_32x32x16_bf16 v[48:63], v[120:123], v[200:203], v[48:63]
  ds_read_b64_tr_b16 v[144:145], v224 offset:13312
  ds_read_b64_tr_b16 v[146:147], v224 offset:15360
  buffer_load_dwordx4 v12, s[8:11], s58 offen lds
  s_waitcnt lgkmcnt(10)
  v_mfma_f32_32x32x16_bf16 v[64:79], v[124:127], v[200:203], v[64:79]
  ds_read_b64_tr_b16 v[148:149], v225 offset:13312
  ds_read_b64_tr_b16 v[150:151], v225 offset:15360
  s_add_u32 s62, s62, 73728
  s_add_u32 s61, s61, 24576
  s_waitcnt lgkmcnt(10)
  v_mfma_f32_32x32x16_bf16 v[80:95], v[128:131], v[200:203], v[80:95]
  ds_read_b64_tr_b16 v[152:153], v224 offset:21504
  ds_read_b64_tr_b16 v[154:155], v224 offset:23552
  s_sub_u32 s58, s61, 147456
  s_cselect_b32 s61, s61, s58
  s_waitcnt lgkmcnt(10)
  v_mfma_f32_32x32x16_bf16 v[96:111], v[132:135], v[200:203], v[96:111]
  ds_read_b64_tr_b16 v[156:157], v225 offset:21504
  ds_read_b64_tr_b16 v[158:159], v225 offset:23552
  buffer_load_dwordx4 v[176:179], v3, s[4:7], s64 offen offset:0 sc1
  s_waitcnt lgkmcnt(10)
  v_mfma_f32_32x32x16_bf16 v[16:31], v[136:139], v[204:207], v[16:31]
  s_add_u32 s60, s60, 24576
  s_cmp_eq_u32 s60, 147456
  s_cselect_b32 s60, 0, s60
  v_add_u32 v224, s60, v13
  v_add_u32 v225, s60, v14
  ds_read_b64_tr_b16 v[112:113], v224 offset:0
  ds_read_b64_tr_b16 v[114:115], v224 offset:2048
  buffer_load_dwordx4 v[180:183], v3, s[4:7], s64 offen offset:1024 sc1
  s_waitcnt lgkmcnt(10)
  v_mfma_f32_32x32x16_bf16 v[32:47], v[140:143], v[204:207], v[32:47]
  ds_read_b64_tr_b16 v[116:117], v225 offset:0
  ds_read_b64_tr_b16 v[118:119], v225 offset:2048
  buffer_load_dwordx4 v[184:187], v3, s[4:7], s64 offen offset:2048 sc1
  s_waitcnt lgkmcnt(10)
  v_mfma_f32_32x32x16_bf16 v[48:63], v[144:147], v[204:207], v[48:63]
  ds_read_b64_tr_b16 v[120:121], v224 offset:8192
  ds_read_b64_tr_b16 v[122:123], v224 offset:10240
  buffer_load_dwordx4 v[188:191], v3, s[4:7], s64 offen offset:3072 sc1
  s_waitcnt lgkmcnt(10)
  v_mfma_f32_32x32x16_bf16 v[64:79], v[148:151], v[204:207], v[64:79]
  ds_read_b64_tr_b16 v[124:125], v225 offset:8192
  ds_read_b64_tr_b16 v[126:127], v225 offset:10240
  s_add_u32 s64, s64, 4096
  s_waitcnt lgkmcnt(10)
  v_mfma_f32_32x32x16_bf16 v[80:95], v[152:155], v[204:207], v[80:95]
  ds_read_b64_tr_b16 v[128:129], v224 offset:16384
  ds_read_b64_tr_b16 v[130:131], v224 offset:18432
  s_waitcnt lgkmcnt(10)
  v_mfma_f32_32x32x16_bf16 v[96:111], v[156:159], v[204:207], v[96:111]
  ds_read_b64_tr_b16 v[132:133], v225 offset:16384
  ds_read_b64_tr_b16 v[134:135], v225 offset:18432
  s_waitcnt lgkmcnt(10)
  v_mfma_f32_32x32x16_bf16 v[16:31], v[112:115], v[208:211], v[16:31]
  ds_read_b64_tr_b16 v[136:137], v224 offset:1024
  ds_read_b64_tr_b16 v[138:139], v224 offset:3072
  s_waitcnt lgkmcnt(10)
  v_mfma_f32_32x32x16_bf16 v[32:47], v[116:119], v[208:211], v[32:47]
  ds_read_b64_tr_b16 v[140:141], v225 offset:1024
  ds_read_b64_tr_b16 v[142:143], v225 offset:3072
  s_waitcnt lgkmcnt(10)
  v_mfma_f32_32x32x16_bf16 v[48:63], v[120:123], v[208:211], v[48:63]
  ds_read_b64_tr_b16 v[144:145], v224 offset:9216
  ds_read_b64_tr_b16 v[146:147], v224 offset:11264
  s_waitcnt lgkmcnt(10)
  v_mfma_f32_32x32x16_bf16 v[64:79], v[124:127], v[208:211], v[64:79]
  s_waitcnt vmcnt(10)
  s_barrier
  ds_read_b64_tr_b16 v[148:149], v225 offset:9216
  ds_read_b64_tr_b16 v[150:151], v225 offset:11264
  s_add_u32 m0, s61, 0
  s_add_u32 s58, s62, 0
  s_waitcnt lgkmcnt(10)
  v_mfma_f32_32x32x16_bf16 v[80:95], v[128:131], v[208:211], v[80:95]
  ds_read_b64_tr_b16 v[152:153], v224 offset:17408
  ds_read_b64_tr_b16 v[154:155], v224 offset:19456
  buffer_load_dwordx4 v12, s[8:11], s58 offen lds
  s_waitcnt lgkmcnt(10)
  v_mfma_f32_32x32x16_bf16 v[96:111], v[132:135], v[208:211], v[96:111]
  ds_read_b64_tr_b16 v[156:157], v225 offset:17408
  ds_read_b64_tr_b16 v[158:159], v225 offset:19456
  s_add_u32 m0, s61, 1024
  s_add_u32 s58, s62, 9216
  s_waitcnt lgkmcnt(10)
  v_mfma_f32_32x32x16_bf16 v[16:31], v[136:139], v[212:215], v[16:31]
  ds_read_b64_tr_b16 v[112:113], v224 offset:4096
  ds_read_b64_tr_b16 v[114:115], v224 offset:6144
  buffer_load_dwordx4 v12, s[8:11], s58 offen lds
  s_waitcnt lgkmcnt(10)
  v_mfma_f32_32x32x16_bf16 v[32:47], v[140:143], v[212:215], v[32:47]
  ds_read_b64_tr_b16 v[116:117], v225 offset:4096
  ds_read_b64_tr_b16 v[118:119], v225 offset:6144
  s_add_u32 m0, s61, 8192
  s_add_u32 s58, s62, 128
  s_waitcnt lgkmcnt(10)
  v_mfma_f32_32x32x16_bf16 v[48:63], v[144:147], v[212:215], v[48:63]
  ds_read_b64_tr_b16 v[120:121], v224 offset:12288
  ds_read_b64_tr_b16 v[122:123], v224 offset:14336
  buffer_load_dwordx4 v12, s[8:11], s58 offen lds
  s_waitcnt lgkmcnt(10)
  v_mfma_f32_32x32x16_bf16 v[64:79], v[148:151], v[212:215], v[64:79]
  ds_read_b64_tr_b16 v[124:125], v225 offset:12288
  ds_read_b64_tr_b16 v[126:127], v225 offset:14336
  s_add_u32 m0, s61, 9216
  s_add_u32 s58, s62, 9344
  s_waitcnt lgkmcnt(10)
  v_mfma_f32_32x32x16_bf16 v[80:95], v[152:155], v[212:215], v[80:95]
  ds_read_b64_tr_b16 v[128:129], v224 offset:20480
  ds_read_b64_tr_b16 v[130:131], v224 offset:22528
  buffer_load_dwordx4 v12, s[8:11], s58 offen lds
  s_waitcnt lgkmcnt(10)
  v_mfma_f32_32x32x16_bf16 v[96:111], v[156:159], v[212:215], v[96:111]
  ds_read_b64_tr_b16 v[132:133], v225 offset:20480
  ds_read_b64_tr_b16 v[134:135], v225 offset:22528
  s_add_u32 m0, s61, 16384
  s_add_u32 s58, s62, 256
  s_waitcnt lgkmcnt(10)
  v_mfma_f32_32x32x16_bf16 v[16:31], v[112:115], v[216:219], v[16:31]
  ds_read_b64_tr_b16 v[136:137], v224 offset:5120
  ds_read_b64_tr_b16 v[138:139], v224 offset:7168
  buffer_load_dwordx4 v12, s[8:11], s58 offen lds
  s_waitcnt lgkmcnt(10)
  v_mfma_f32_32x32x16_bf16 v[32:47], v[116:119], v[216:219], v[32:47]
  ds_read_b64_tr_b16 v[140:141], v225 offset:5120
  ds_read_b64_tr_b16 v[142:143], v225 offset:7168
  s_add_u32 m0, s61, 17408
  s_add_u32 s58, s62, 9472
  s_waitcnt lgkmcnt(10)
  v_mfma_f32_32x32x16_bf16 v[48:63], v[120:123], v[216:219], v[48:63]
  ds_read_b64_tr_b16 v[144:145], v224 offset:13312
  ds_read_b64_tr_b16 v[146:147], v224 offset:15360
  buffer_load_dwordx4 v12, s[8:11], s58 offen lds
  s_waitcnt lgkmcnt(10)
  v_mfma_f32_32x32x16_bf16 v[64:79], v[124:127], v[216:219], v[64:79]
  ds_read_b64_tr_b16 v[148:149], v225 offset:13312
  ds_read_b64_tr_b16 v[150:151], v225 offset:15360
  s_add_u32 s62, s62, 73728
  s_add_u32 s61, s61, 24576
  s_waitcnt lgkmcnt(10)
  v_mfma_f32_32x32x16_bf16 v[80:95], v[128:131], v[216:219], v[80:95]
  ds_read_b64_tr_b16 v[152:153], v224 offset:21504
  ds_read_b64_tr_b16 v[154:155], v224 offset:23552
  s_sub_u32 s58, s61, 147456
  s_cselect_b32 s61, s61, s58
  s_waitcnt lgkmcnt(10)
  v_mfma_f32_32x32x16_bf16 v[96:111], v[132:135], v[216:219], v[96:111]
  ds_read_b64_tr_b16 v[156:157], v225 offset:21504
  ds_read_b64_tr_b16 v[158:159], v225 offset:23552
  buffer_load_dwordx4 v[192:195], v3, s[4:7], s64 offen offset:0 sc1
  s_waitcnt lgkmcnt(10)
  v_mfma_f32_32x32x16_bf16 v[16:31], v[136:139], v[220:223], v[16:31]
  s_add_u32 s60, s60, 24576
  s_cmp_eq_u32 s60, 147456
  s_cselect_b32 s60, 0, s60
  v_add_u32 v224, s60, v13
  v_add_u32 v225, s60, v14
  ds_read_b64_tr_b16 v[112:113], v224 offset:0
  ds_read_b64_tr_b16 v[114:115], v224 offset:2048
  buffer_load_dwordx4 v[196:199], v3, s[4:7], s64 offen offset:1024 sc1
  s_waitcnt lgkmcnt(10)
  v_mfma_f32_32x32x16_bf16 v[32:47], v[140:143], v[220:223], v[32:47]
  ds_read_b64_tr_b16 v[116:117], v225 offset:0
  ds_read_b64_tr_b16 v[118:119], v225 offset:2048
  buffer_load_dwordx4 v[200:203], v3, s[4:7], s64 offen offset:2048 sc1
  s_waitcnt lgkmcnt(10)
  v_mfma_f32_32x32x16_bf16 v[48:63], v[144:147], v[220:223], v[48:63]
  ds_read_b64_tr_b16 v[120:121], v224 offset:8192
  ds_read_b64_tr_b16 v[122:123], v224 offset:10240
  buffer_load_dwordx4 v[204:207], v3, s[4:7], s64 offen offset:3072 sc1
  s_waitcnt lgkmcnt(10)
  v_mfma_f32_32x32x16_bf16 v[64:79], v[148:151], v[220:223], v[64:79]
  ds_read_b64_tr_b16 v[124:125], v225 offset:8192
  ds_read_b64_tr_b16 v[126:127], v225 offset:10240
  s_add_u32 s64, s64, 4096
  s_waitcnt lgkmcnt(10)
  v_mfma_f32_32x32x16_bf16 v[80:95], v[152:155], v[220:223], v[80:95]
  ds_read_b64_tr_b16 v[128:129], v224 offset:16384
  ds_read_b64_tr_b16 v[130:131], v224 offset:18432
  s_waitcnt lgkmcnt(10)
  v_mfma_f32_32x32x16_bf16 v[96:111], v[156:159], v[220:223], v[96:111]
  ds_read_b64_tr_b16 v[132:133], v225 offset:16384
  ds_read_b64_tr_b16 v[134:135], v225 offset:18432
  s_add_u32 s65, s65, 1
  s_branch L_dn_loop
L_dn_fin:
  s_lshl_b32 s55, s52, 2
  s_add_u32 s55, s55, s20
  s_mul_i32 s55, s55, 73728
  s_mul_i32 s56, s66, 24576
  s_add_u32 s55, s55, s56
  s_mul_i32 s56, s67, 4718592
  s_add_u32 s55, s55, s56
  s_add_u32 s55, s55, 0xe000000
  buffer_store_dwordx4 v[16:19], v3, s[4:7], s55 offen offset:0 sc1
  buffer_store_dwordx4 v[20:23], v3, s[4:7], s55 offen offset:1024 sc1
  buffer_store_dwordx4 v[24:27], v3, s[4:7], s55 offen offset:2048 sc1
  buffer_store_dwordx4 v[28:31], v3, s[4:7], s55 offen offset:3072 sc1
  s_add_u32 s55, s55, 4096
  buffer_store_dwordx4 v[32:35], v3, s[4:7], s55 offen offset:0 sc1
  buffer_store_dwordx4 v[36:39], v3, s[4:7], s55 offen offset:1024 sc1
  buffer_store_dwordx4 v[40:43], v3, s[4:7], s55 offen offset:2048 sc1
  buffer_store_dwordx4 v[44:47], v3, s[4:7], s55 offen offset:3072 sc1
  s_add_u32 s55, s55, 4096
  buffer_store_dwordx4 v[48:51], v3, s[4:7], s55 offen offset:0 sc1
  buffer_store_dwordx4 v[52:55], v3, s[4:7], s55 offen offset:1024 sc1
  buffer_store_dwordx4 v[56:59], v3, s[4:7], s55 offen offset:2048 sc1
  buffer_store_dwordx4 v[60:63], v3, s[4:7], s55 offen offset:3072 sc1
  s_add_u32 s55, s55, 4096
  buffer_store_dwordx4 v[64:67], v3, s[4:7], s55 offen offset:0 sc1
  buffer_store_dwordx4 v[68:71], v3, s[4:7], s55 offen offset:1024 sc1
  buffer_store_dwordx4 v[72:75], v3, s[4:7], s55 offen offset:2048 sc1
  buffer_store_dwordx4 v[76:79], v3, s[4:7], s55 offen offset:3072 sc1
  s_add_u32 s55, s55, 4096
  buffer_store_dwordx4 v[80:83], v3, s[4:7], s55 offen offset:0 sc1
  buffer_store_dwordx4 v[84:87], v3, s[4:7], s55 offen offset:1024 sc1
  buffer_store_dwordx4 v[88:91], v3, s[4:7], s55 offen offset:2048 sc1
  buffer_store_dwordx4 v[92:95], v3, s[4:7], s55 offen offset:3072 sc1
  s_add_u32 s55, s55, 4096
  buffer_store_dwordx4 v[96:99], v3, s[4:7], s55 offen offset:0 sc1
  buffer_store_dwordx4 v[100:103], v3, s[4:7], s55 offen offset:1024 sc1
  buffer_store_dwordx4 v[104:107], v3, s[4:7], s55 offen offset:2048 sc1
  buffer_store_dwordx4 v[108:111], v3, s[4:7], s55 offen offset:3072 sc1
  s_add_u32 s55, s55, 4096
  s_lshl_b32 s55, s52, 6
  s_lshl_b32 s56, s53, 2
  s_add_u32 s55, s55, s56
  s_add_u32 s55, s55, 0x3208000
  s_waitcnt lgkmcnt(0)
  s_waitcnt vmcnt(0)
  s_barrier
  s_cmp_lg_u32 s20, 0
  s_cbranch_scc1 L_down_done
  s_mov_b64 exec, 1
  buffer_store_dword v6, v3, s[4:7], s55 offen sc1
  s_mov_b64 exec, -1
L_down_done:
  s_and_b32 s60, s21, 31
  s_lshr_b32 s61, s21, 5
  s_waitcnt vmcnt(0) lgkmcnt(0)
  s_barrier
  s_mov_b32 s8, s34
  s_and_b32 s9, s35, 0xffff
  s_mov_b32 s10, 0x480000
  s_mov_b32 s11, 0x20000
  s_mov_b32 s76, s24
  s_and_b32 s77, s25, 0xffff
  s_mov_b32 s78, 0x240000
  s_mov_b32 s79, 0x20000
  s_mov_b32 s80, s46
  s_and_b32 s81, s47, 0xffff
  s_mov_b32 s82, 0x240000
  s_mov_b32 s83, 0x20000
  s_mul_i32 s55, s60, 147456
  s_mul_i32 s56, s20, 36864
  s_add_u32 s55, s55, s56
  s_lshl_b32 s56, s20, 12
  s_add_u32 m0, s56, 0
  s_add_u32 s58, s55, 0
  buffer_load_dwordx4 v12, s[8:11], s58 offen lds
  s_add_u32 m0, s56, 1024
  s_add_u32 s58, s55, 9216
  buffer_load_dwordx4 v12, s[8:11], s58 offen lds
  s_add_u32 m0, s56, 2048
  s_add_u32 s58, s55, 18432
  buffer_load_dwordx4 v12, s[8:11], s58 offen lds
  s_add_u32 m0, s56, 3072
  s_add_u32 s58, s55, 27648
  buffer_load_dwordx4 v12, s[8:11], s58 offen lds
  s_add_u32 m0, s56, 16384
  s_add_u32 s58, s55, 128
  buffer_load_dwordx4 v12, s[8:11], s58 offen lds
  s_add_u32 m0, s56, 17408
  s_add_u32 s58, s55, 9344
  buffer_load_dwordx4 v12, s[8:11], s58 offen lds
  s_add_u32 m0, s56, 18432
  s_add_u32 s58, s55, 18560
  buffer_load_dwordx4 v12, s[8:11], s58 offen lds
  s_add_u32 m0, s56, 19456
  s_add_u32 s58, s55, 27776
  buffer_load_dwordx4 v12, s[8:11], s58 offen lds
  s_add_u32 m0, s56, 32768
  s_add_u32 s58, s55, 256
  buffer_load_dwordx4 v12, s[8:11], s58 offen lds
  s_add_u32 m0, s56, 33792
  s_add_u32 s58, s55, 9472
  buffer_load_dwordx4 v12, s[8:11], s58 offen lds
  s_add_u32 m0, s56, 34816
  s_add_u32 s58, s55, 18688
  buffer_load_dwordx4 v12, s[8:11], s58 offen lds
  s_add_u32 m0, s56, 35840
  s_add_u32 s58, s55, 27904
  buffer_load_dwordx4 v12, s[8:11], s58 offen lds
  s_add_u32 m0, s56, 49152
  s_add_u32 s58, s55, 384
  buffer_load_dwordx4 v12, s[8:11], s58 offen lds
  s_add_u32 m0, s56, 50176
  s_add_u32 s58, s55, 9600
  buffer_load_dwordx4 v12, s[8:11], s58 offen lds
  s_add_u32 m0, s56, 51200
  s_add_u32 s58, s55, 18816
  buffer_load_dwordx4 v12, s[8:11], s58 offen lds
  s_add_u32 m0, s56, 52224
  s_add_u32 s58, s55, 28032
  buffer_load_dwordx4 v12, s[8:11], s58 offen lds
  s_add_u32 m0, s56, 65536
  s_add_u32 s58, s55, 512
  buffer_load_dwordx4 v12, s[8:11], s58 offen lds
  s_add_u32 m0, s56, 66560
  s_add_u32 s58, s55, 9728
  buffer_load_dwordx4 v12, s[8:11], s58 offen lds
  s_add_u32 m0, s56, 67584
  s_add_u32 s58, s55, 18944
  buffer_load_dwordx4 v12, s[8:11], s58 offen lds
  s_add_u32 m0, s56, 68608
  s_add_u32 s58, s55, 28160
  buffer_load_dwordx4 v12, s[8:11], s58 offen lds
  s_add_u32 m0, s56, 81920
  s_add_u32 s58, s55, 640
  buffer_load_dwordx4 v12, s[8:11], s58 offen lds
  s_add_u32 m0, s56, 82944
  s_add_u32 s58, s55, 9856
  buffer_load_dwordx4 v12, s[8:11], s58 offen lds
  s_add_u32 m0, s56, 83968
  s_add_u32 s58, s55, 19072
  buffer_load_dwordx4 v12, s[8:11], s58 offen lds
  s_add_u32 m0, s56, 84992
  s_add_u32 s58, s55, 28288
  buffer_load_dwordx4 v12, s[8:11], s58 offen lds
  s_add_u32 m0, s56, 98304
  s_add_u32 s58, s55, 768
  buffer_load_dwordx4 v12, s[8:11], s58 offen lds
  s_add_u32 m0, s56, 99328
  s_add_u32 s58, s55, 9984
  buffer_load_dwordx4 v12, s[8:11], s58 offen lds
  s_add_u32 m0, s56, 100352
  s_add_u32 s58, s55, 19200
  buffer_load_dwordx4 v12, s[8:11], s58 offen lds
  s_add_u32 m0, s56, 101376
  s_add_u32 s58, s55, 28416
  buffer_load_dwordx4 v12, s[8:11], s58 offen lds
  s_add_u32 m0, s56, 114688
  s_add_u32 s58, s55, 896
  buffer_load_dwordx4 v12, s[8:11], s58 offen lds
  s_add_u32 m0, s56, 115712
  s_add_u32 s58, s55, 10112
  buffer_load_dwordx4 v12, s[8:11], s58 offen lds
  s_add_u32 m0, s56, 116736
  s_add_u32 s58, s55, 19328
  buffer_load_dwordx4 v12, s[8:11], s58 offen lds
  s_add_u32 m0, s56, 117760
  s_add_u32 s58, s55, 28544
  buffer_load_dwordx4 v12, s[8:11], s58 offen lds
  s_add_u32 m0, s56, 131072
  s_add_u32 s58, s55, 1024
  buffer_load_dwordx4 v12, s[8:11], s58 offen lds
  s_add_u32 m0, s56, 132096
  s_add_u32 s58, s55, 10240
  buffer_load_dwordx4 v12, s[8:11], s58 offen lds
  s_add_u32 m0, s56, 133120
  s_add_u32 s58, s55, 19456
  buffer_load_dwordx4 v12, s[8:11], s58 offen lds
  s_add_u32 m0, s56, 134144
  s_add_u32 s58, s55, 28672
  buffer_load_dwordx4 v12, s[8:11], s58 offen lds
  v_and_b32 v20, 31, v0
  v_lshrrev_b32 v21, 5, v0
  v_lshlrev_b32 v22, 4, v20
  v_lshl_add_u32 v22, v21, 7, v22
  v_mov_b32 v23, 0x40000000
  v_cmp_gt_u32 vcc, 8, v20
  s_nop 1
  v_cndmask_b32 v4, v23, v22, vcc
  v_and_b32 v22, 15, v20
  v_lshl_add_u32 v22, v21, 4, v22
  v_lshlrev_b32 v22, 4, v22
  v_lshrrev_b32 v23, 4, v20
  v_lshl_add_u32 v5, v23, 3, v22
  v_lshl_add_u32 v22, v21, 1, v23
  v_lshlrev_b32 v22, 13, v22
  v_and_b32 v23, 15, v20
  v_lshl_add_u32 v7, v23, 4, v22
  v_and_b32 v22, 15, v0
  v_lshrrev_b32 v23, 4, v0
  v_mul_u32_u24 v24, 1152, v22
  v_lshl_add_u32 v24, v23, 3, v24
  v_lshlrev_b32 v25, 9, v23
  v_lshl_add_u32 v25, v22, 4, v25
  v_mov_b32 v26, 0x40000000
  v_cmp_gt_u32 vcc, 32, v0
  s_nop 1
  v_cndmask_b32 v8, v26, v24, vcc
  v_cndmask_b32 v10, v26, v25, vcc
  v_lshlrev_b32 v9, 2, v0
  v_lshlrev_b32 v11, 7, v0
  v_and_b32 v24, 1, v22
  v_lshlrev_b32 v24, 4, v24
  v_mov_b32 v25, 0x3f80
  v_lshlrev_b32 v24, v24, v25
  v_lshrrev_b32 v25, 1, v22
  v_cmp_eq_u32 vcc, 0, v25
  s_nop 1
  v_cndmask_b32 v26, 0, v24, vcc
  v_accvgpr_write_b32 a0, v26
  v_cmp_eq_u32 vcc, 1, v25
  s_nop 1
  v_cndmask_b32 v26, 0, v24, vcc
  v_accvgpr_write_b32 a1, v26
  v_cmp_eq_u32 vcc, 2, v25
  s_nop 1
  v_cndmask_b32 v26, 0, v24, vcc
  v_accvgpr_write_b32 a2, v26
  v_cmp_eq_u32 vcc, 3, v25
  s_nop 1
  v_cndmask_b32 v26, 0, v24, vcc
  v_accvgpr_write_b32 a3, v26
  v_lshlrev_b32 v240, 2, v21
  v_sub_u32 v240, v20, v240
  v_mov_b32 v241, 0xff800000
  v_cmp_gt_i32 vcc, 0, v240
  s_nop 1
  v_cndmask_b32 v16, 0, v241, vcc
  v_cmp_gt_i32 vcc, 1, v240
  s_nop 1
  v_cndmask_b32 v17, 0, v241, vcc
  v_cmp_gt_i32 vcc, 2, v240
  s_nop 1
  v_cndmask_b32 v18, 0, v241, vcc
  v_cmp_gt_i32 vcc, 3, v240
  s_nop 1
  v_cndmask_b32 v19, 0, v241, vcc
  v_cmp_gt_i32 vcc, 8, v240
  s_nop 1
  v_cndmask_b32 v20, 0, v241, vcc
  v_cmp_gt_i32 vcc, 9, v240
  s_nop 1
  v_cndmask_b32 v21, 0, v241, vcc
  v_cmp_gt_i32 vcc, 10, v240
  s_nop 1
  v_cndmask_b32 v22, 0, v241, vcc
  v_cmp_gt_i32 vcc, 11, v240
  s_nop 1
  v_cndmask_b32 v23, 0, v241, vcc
  v_cmp_gt_i32 vcc, 16, v240
  s_nop 1
  v_cndmask_b32 v24, 0, v241, vcc
  v_cmp_gt_i32 vcc, 17, v240
  s_nop 1
  v_cndmask_b32 v25, 0, v241, vcc
  v_cmp_gt_i32 vcc, 18, v240
  s_nop 1
  v_cndmask_b32 v26, 0, v241, vcc
  v_cmp_gt_i32 vcc, 19, v240
  s_nop 1
  v_cndmask_b32 v27, 0, v241, vcc
  v_cmp_gt_i32 vcc, 24, v240
  s_nop 1
  v_cndmask_b32 v28, 0, v241, vcc
  v_cmp_gt_i32 vcc, 25, v240
  s_nop 1
  v_cndmask_b32 v29, 0, v241, vcc
  v_cmp_gt_i32 vcc, 26, v240
  s_nop 1
  v_cndmask_b32 v30, 0, v241, vcc
  v_cmp_gt_i32 vcc, 27, v240
  s_nop 1
  v_cndmask_b32 v31, 0, v241, vcc
  s_mov_b32 s72, 0x3e0293ee
  s_waitcnt vmcnt(0)
  s_barrier
  s_mov_b32 s69, -1
L_x_task:
  s_lshr_b32 s55, s61, 2
  s_lshl_b32 s55, s55, 10
  s_lshl_b32 s56, s60, 2
  s_add_u32 s55, s55, s56
  s_add_u32 s55, s55, 0x3204000
  s_mov_b32 exec_lo, 0x7
  s_mov_b32 exec_hi, 0x0
L_x_pu:
  buffer_load_dword v176, v11, s[4:7], s55 offen sc1
  s_add_u32 s59, s59, 1
  s_cmp_ge_u32 s59, 0x8000
  s_waitcnt vmcnt(0)
  v_cmp_eq_u32 vcc, 0, v176
  s_cbranch_scc1 L_x_pu_x
  s_cbranch_vccz L_x_pu_x
  s_sleep 2
  s_branch L_x_pu
L_x_pu_x:
  s_mov_b64 exec, -1
  s_lshl_b32 s62, s60, 19
  s_lshl_b32 s55, s61, 13
  s_add_u32 s62, s62, s55
  s_lshl_b32 s64, s62, 1
  s_add_u32 s62, s62, 0x4000000
  s_add_u32 s64, s64, 0x400000
  s_add_u32 s55, s62, 0
  buffer_load_dwordx4 v[32:35], v2, s[4:7], s55 offen offset:0 sc1
  buffer_load_dwordx4 v[36:39], v2, s[4:7], s55 offen offset:512 sc1
  buffer_load_dwordx4 v[40:43], v2, s[4:7], s55 offen offset:2048 sc1
  buffer_load_dwordx4 v[44:47], v2, s[4:7], s55 offen offset:2560 sc1
  s_add_u32 s55, s62, 4096
  buffer_load_dwordx4 v[48:51], v2, s[4:7], s55 offen offset:0 sc1
  buffer_load_dwordx4 v[52:55], v2, s[4:7], s55 offen offset:512 sc1
  buffer_load_dwordx4 v[56:59], v2, s[4:7], s55 offen offset:2048 sc1
  buffer_load_dwordx4 v[60:63], v2, s[4:7], s55 offen offset:2560 sc1
  s_add_u32 s55, s64, 0
  buffer_load_dwordx4 v[64:67], v2, s[4:7], s55 offen offset:0 sc1
  buffer_load_dwordx4 v[68:71], v2, s[4:7], s55 offen offset:512 sc1
  buffer_load_dwordx4 v[72:75], v2, s[4:7], s55 offen offset:2048 sc1
  buffer_load_dwordx4 v[76:79], v2, s[4:7], s55 offen offset:2560 sc1
  s_add_u32 s55, s64, 4096
  buffer_load_dwordx4 v[80:83], v2, s[4:7], s55 offen offset:0 sc1
  buffer_load_dwordx4 v[84:87], v2, s[4:7], s55 offen offset:512 sc1
  buffer_load_dwordx4 v[88:91], v2, s[4:7], s55 offen offset:2048 sc1
  buffer_load_dwordx4 v[92:95], v2, s[4:7], s55 offen offset:2560 sc1
  s_add_u32 s55, s64, 8192
  buffer_load_dwordx4 v[96:99], v2, s[4:7], s55 offen offset:0 sc1
  buffer_load_dwordx4 v[100:103], v2, s[4:7], s55 offen offset:512 sc1
  buffer_load_dwordx4 v[104:107], v2, s[4:7], s55 offen offset:2048 sc1
  buffer_load_dwordx4 v[108:111], v2, s[4:7], s55 offen offset:2560 sc1
  s_add_u32 s55, s64, 12288
  buffer_load_dwordx4 v[112:115], v2, s[4:7], s55 offen offset:0 sc1
  buffer_load_dwordx4 v[116:119], v2, s[4:7], s55 offen offset:512 sc1
  buffer_load_dwordx4 v[120:123], v2, s[4:7], s55 offen offset:2048 sc1
  buffer_load_dwordx4 v[124:127], v2, s[4:7], s55 offen offset:2560 sc1
  s_mul_i32 s65, s60, 399360
  s_mul_i32 s55, s61, 6144
  s_add_u32 s65, s65, s55
  s_add_u32 s65, s65, 0x8001800
  s_waitcnt vmcnt(15)
  v_mfma_f32_32x32x16_bf16 v[176:191], v[64:67], v[32:35], v[16:31]
  s_waitcnt vmcnt(14)
  v_mfma_f32_32x32x16_bf16 v[176:191], v[68:71], v[36:39], v[176:191]
  s_waitcnt vmcnt(13)
  v_mfma_f32_32x32x16_bf16 v[176:191], v[72:75], v[40:43], v[176:191]
  s_waitcnt vmcnt(12)
  v_mfma_f32_32x32x16_bf16 v[176:191], v[76:79], v[44:47], v[176:191]
  s_waitcnt vmcnt(11)
  v_mfma_f32_32x32x16_bf16 v[176:191], v[80:83], v[48:51], v[176:191]
  s_waitcnt vmcnt(10)
  v_mfma_f32_32x32x16_bf16 v[176:191], v[84:87], v[52:55], v[176:191]
  s_waitcnt vmcnt(9)
  v_mfma_f32_32x32x16_bf16 v[176:191], v[88:91], v[56:59], v[176:191]
  s_waitcnt vmcnt(8)
  v_mfma_f32_32x32x16_bf16 v[176:191], v[92:95], v[60:63], v[176:191]
  s_cmp_lt_i32 s69, 0
  s_cbranch_scc1 L_x_nofin
  s_lshr_b32 s55, s69, 2
  s_lshl_b32 s55, s55, 6
  s_add_u32 s55, s55, 0x3208000
  s_mov_b32 exec_lo, 0xfff
  s_mov_b32 exec_hi, 0x0
L_x_pg_a:
  buffer_load_dword v200, v9, s[4:7], s55 offen sc1
  s_add_u32 s59, s59, 1
  s_cmp_ge_u32 s59, 0x8000
  s_waitcnt vmcnt(0)
  v_cmp_eq_u32 vcc, 0, v200
  s_cbranch_scc1 L_x_pg_a_x
  s_cbranch_vccz L_x_pg_a_x
  s_sleep 2
  s_branch L_x_pg_a
L_x_pg_a_x:
  s_mov_b64 exec, -1
  s_lshl_b32 s67, s60, 2
  s_add_u32 s67, s67, s20
  s_lshl_b32 s57, s69, 7
  s_add_u32 s57, s57, 0x3209000
L_x_gr_a:
  s_and_b32 s55, s67, 1
  s_lshl_b32 s55, s55, 4
  s_lshl_b32 s56, s69, 5
  s_add_u32 s55, s55, s56
  s_mul_i32 s55, s55, 1152
  s_lshr_b32 s56, s67, 1
  s_lshl_b32 s56, s56, 4
  s_add_u32 s70, s55, s56
  s_mul_i32 s55, s69, 73728
  s_lshl_b32 s56, s56, 6
  s_add_u32 s55, s55, s56
  s_and_b32 s56, s67, 1
  s_lshl_b32 s56, s56, 8
  s_add_u32 s55, s55, s56
  s_add_u32 s55, s55, 0xe000000
  buffer_load_dwordx2 v[200:201], v8, s[76:79], s70 offen
  buffer_load_dwordx4 v[128:131], v10, s[4:7], s55 offen sc1
  s_add_u32 s55, s55, 4718592
  buffer_load_dwordx4 v[132:135], v10, s[4:7], s55 offen sc1
  s_add_u32 s55, s55, 4718592
  buffer_load_dwordx4 v[136:139], v10, s[4:7], s55 offen sc1
  s_add_u32 s55, s55, 4718592
  buffer_load_dwordx4 v[140:143], v10, s[4:7], s55 offen sc1
  s_mov_b32 exec_lo, 0xffffffff
  s_mov_b32 exec_hi, 0x0
L_x_px_a:
  buffer_load_dword v202, v9, s[4:7], s57 offen sc1
  s_add_u32 s59, s59, 1
  s_cmp_ge_u32 s59, 0x8000
  s_waitcnt vmcnt(0)
  v_cmp_eq_u32 vcc, 0, v202
  s_cbranch_scc1 L_x_px_a_x
  s_cbranch_vccz L_x_px_a_x
  s_sleep 2
  s_branch L_x_px_a
L_x_px_a_x:
  s_mov_b64 exec, -1
  s_mul_i32 s55, s69, 1179648
  s_lshl_b32 s56, s67, 13
  s_add_u32 s55, s55, s56
  s_add_u32 s55, s55, 0x9000000
  s_add_u32 s56, s55, 4096
  buffer_load_dwordx4 v[208:211], v3, s[4:7], s55 offen offset:0 sc1
  buffer_load_dwordx4 v[212:215], v3, s[4:7], s55 offen offset:1024 sc1
  buffer_load_dwordx4 v[216:219], v3, s[4:7], s55 offen offset:2048 sc1
  buffer_load_dwordx4 v[220:223], v3, s[4:7], s55 offen offset:3072 sc1
  buffer_load_dwordx4 v[224:227], v3, s[4:7], s56 offen offset:0 sc1
  buffer_load_dwordx4 v[228:231], v3, s[4:7], s56 offen offset:1024 sc1
  buffer_load_dwordx4 v[232:235], v3, s[4:7], s56 offen offset:2048 sc1
  buffer_load_dwordx4 v[236:239], v3, s[4:7], s56 offen offset:3072 sc1
  v_add_f32 v128, v128, v132
  v_add_f32 v136, v136, v140
  v_add_f32 v129, v129, v133
  v_add_f32 v137, v137, v141
  v_add_f32 v130, v130, v134
  v_add_f32 v138, v138, v142
  v_add_f32 v131, v131, v135
  v_add_f32 v139, v139, v143
  v_add_f32 v128, v128, v136
  v_add_f32 v129, v129, v137
  v_add_f32 v130, v130, v138
  v_add_f32 v131, v131, v139
  v_mul_f32 v132, 0xbfb8aa3b, v128
  v_mul_f32 v133, 0xbfb8aa3b, v129
  v_mul_f32 v134, 0xbfb8aa3b, v130
  v_mul_f32 v135, 0xbfb8aa3b, v131
  v_exp_f32 v132, v132
  v_exp_f32 v133, v133
  v_exp_f32 v134, v134
  v_exp_f32 v135, v135
  v_lshlrev_b32 v204, 16, v200
  v_add_f32 v132, 1.0, v132
  v_add_f32 v133, 1.0, v133
  v_add_f32 v134, 1.0, v134
  v_add_f32 v135, 1.0, v135
  v_rcp_f32 v132, v132
  v_rcp_f32 v133, v133
  v_rcp_f32 v134, v134
  v_rcp_f32 v135, v135
  v_and_b32 v205, 0xffff0000, v200
  v_lshlrev_b32 v206, 16, v201
  v_and_b32 v207, 0xffff0000, v201
  v_mul_f32 v128, v128, v132
  v_mul_f32 v129, v129, v133
  v_mul_f32 v130, v130, v134
  v_mul_f32 v131, v131, v135
  s_waitcnt vmcnt(7)
  v_mfma_f32_16x16x32_bf16 v[196:199], a[0:3], v[208:211], 0
  s_waitcnt vmcnt(6)
  v_mfma_f32_16x16x32_bf16 v[196:199], a[0:3], v[212:215], v[196:199]
  s_waitcnt vmcnt(5)
  v_mfma_f32_16x16x32_bf16 v[196:199], a[0:3], v[216:219], v[196:199]
  s_waitcnt vmcnt(4)
  v_mfma_f32_16x16x32_bf16 v[196:199], a[0:3], v[220:223], v[196:199]
  s_waitcnt vmcnt(3)
  v_mfma_f32_16x16x32_bf16 v[196:199], a[0:3], v[224:227], v[196:199]
  s_waitcnt vmcnt(2)
  v_mfma_f32_16x16x32_bf16 v[196:199], a[0:3], v[228:231], v[196:199]
  s_waitcnt vmcnt(1)
  v_mfma_f32_16x16x32_bf16 v[196:199], a[0:3], v[232:235], v[196:199]
  s_waitcnt vmcnt(0)
  v_mfma_f32_16x16x32_bf16 v[196:199], a[0:3], v[236:239], v[196:199]
  s_nop 7
  v_fmac_f32 v204, v196, v128
  v_fmac_f32 v205, v197, v129
  v_fmac_f32 v206, v198, v130
  v_fmac_f32 v207, v199, v131
  v_cvt_pk_bf16_f32 v204, v204, v205
  v_cvt_pk_bf16_f32 v205, v206, v207
  buffer_store_dwordx2 v[204:205], v8, s[80:83], s70 offen
  s_add_u32 s67, s67, 128
  s_cmp_lt_u32 s67, 144
  s_cbranch_scc1 L_x_gr_a
L_x_nofin:
  s_lshl_b32 s55, s61, 7
  s_lshl_b32 s56, s60, 2
  s_add_u32 s55, s55, s56
  s_add_u32 s55, s55, 0x3201000
  s_mov_b32 exec_lo, 0x1
  s_mov_b32 exec_hi, 0x0
L_x_pk:
  buffer_load_dword v192, v9, s[4:7], s55 offen sc1
  s_add_u32 s59, s59, 1
  s_cmp_ge_u32 s59, 0x8000
  s_waitcnt vmcnt(0)
  v_cmp_eq_u32 vcc, 0, v192
  s_cbranch_scc1 L_x_pk_x
  s_cbranch_vccz L_x_pk_x
  s_sleep 2
  s_branch L_x_pk
L_x_pk_x:
  s_mov_b64 exec, -1
  buffer_load_dwordx4 v[128:131], v4, s[4:7], s65 offen offset:0 sc1
  buffer_load_dwordx4 v[132:135], v4, s[4:7], s65 offen offset:256 sc1
  buffer_load_dwordx4 v[136:139], v4, s[4:7], s65 offen offset:512 sc1
  buffer_load_dwordx4 v[140:143], v4, s[4:7], s65 offen offset:768 sc1
  buffer_load_dwordx4 v[144:147], v4, s[4:7], s65 offen offset:1024 sc1
  buffer_load_dwordx4 v[148:151], v4, s[4:7], s65 offen offset:1280 sc1
  buffer_load_dwordx4 v[152:155], v4, s[4:7], s65 offen offset:1536 sc1
  buffer_load_dwordx4 v[156:159], v4, s[4:7], s65 offen offset:1792 sc1
  s_add_u32 s55, s65, 2048
  buffer_load_dwordx2 v[160:161], v5, s[4:7], s55 offen offset:0 sc1
  buffer_load_dwordx2 v[162:163], v5, s[4:7], s55 offen offset:512 sc1
  buffer_load_dwordx2 v[164:165], v5, s[4:7], s55 offen offset:1024 sc1
  buffer_load_dwordx2 v[166:167], v5, s[4:7], s55 offen offset:1536 sc1
  buffer_load_dwordx2 v[168:169], v5, s[4:7], s55 offen offset:2048 sc1
  buffer_load_dwordx2 v[170:171], v5, s[4:7], s55 offen offset:2560 sc1
  buffer_load_dwordx2 v[172:173], v5, s[4:7], s55 offen offset:3072 sc1
  buffer_load_dwordx2 v[174:175], v5, s[4:7], s55 offen offset:3584 sc1
  v_max3_f32 v240, v176, v177, v178
  v_max3_f32 v240, v240, v179, v180
  v_max3_f32 v240, v240, v181, v182
  v_max3_f32 v240, v240, v183, v184
  v_max3_f32 v240, v240, v185, v186
  v_max3_f32 v240, v240, v187, v188
  v_max3_f32 v240, v240, v189, v190
  v_max_f32 v240, v240, v191
  s_waitcnt vmcnt(15)
  v_mfma_f32_32x32x16_bf16 v[192:207], v[128:131], v[32:35], 0
  s_waitcnt vmcnt(14)
  v_mfma_f32_32x32x16_bf16 v[192:207], v[132:135], v[36:39], v[192:207]
  s_waitcnt vmcnt(13)
  v_mfma_f32_32x32x16_bf16 v[192:207], v[136:139], v[40:43], v[192:207]
  s_waitcnt vmcnt(12)
  v_mfma_f32_32x32x16_bf16 v[192:207], v[140:143], v[44:47], v[192:207]
  s_waitcnt vmcnt(11)
  v_mfma_f32_32x32x16_bf16 v[192:207], v[144:147], v[48:51], v[192:207]
  s_waitcnt vmcnt(10)
  v_mfma_f32_32x32x16_bf16 v[192:207], v[148:151], v[52:55], v[192:207]
  s_waitcnt vmcnt(9)
  v_mfma_f32_32x32x16_bf16 v[192:207], v[152:155], v[56:59], v[192:207]
  s_waitcnt vmcnt(8)
  v_mfma_f32_32x32x16_bf16 v[192:207], v[156:159], v[60:63], v[192:207]
  s_nop 11
  v_max3_f32 v240, v240, v192, v193
  v_max3_f32 v240, v240, v194, v195
  v_mov_b32 v241, v240
  s_nop 1
  v_permlane32_swap_b32 v240, v241
  v_max_f32 v240, v240, v241
  v_mul_f32 v240, s72, v240
  v_fma_f32 v176, v176, s72, -v240
  v_fma_f32 v177, v177, s72, -v240
  v_fma_f32 v178, v178, s72, -v240
  v_fma_f32 v179, v179, s72, -v240
  v_fma_f32 v180, v180, s72, -v240
  v_fma_f32 v181, v181, s72, -v240
  v_fma_f32 v182, v182, s72, -v240
  v_fma_f32 v183, v183, s72, -v240
  v_fma_f32 v184, v184, s72, -v240
  v_fma_f32 v185, v185, s72, -v240
  v_fma_f32 v186, v186, s72, -v240
  v_fma_f32 v187, v187, s72, -v240
  v_fma_f32 v188, v188, s72, -v240
  v_fma_f32 v189, v189, s72, -v240
  v_fma_f32 v190, v190, s72, -v240
  v_fma_f32 v191, v191, s72, -v240
  v_fma_f32 v192, v192, s72, -v240
  v_fma_f32 v193, v193, s72, -v240
  v_fma_f32 v194, v194, s72, -v240
  v_fma_f32 v195, v195, s72, -v240
  v_exp_f32 v176, v176
  v_exp_f32 v177, v177
  v_exp_f32 v178, v178
  v_exp_f32 v179, v179
  v_exp_f32 v180, v180
  v_exp_f32 v181, v181
  v_exp_f32 v182, v182
  v_exp_f32 v183, v183
  v_exp_f32 v184, v184
  v_exp_f32 v185, v185
  v_exp_f32 v186, v186
  v_exp_f32 v187, v187
  v_exp_f32 v188, v188
  v_exp_f32 v189, v189
  v_exp_f32 v190, v190
  v_exp_f32 v191, v191
  v_exp_f32 v192, v192
  v_exp_f32 v193, v193
  v_exp_f32 v194, v194
  v_exp_f32 v195, v195
  v_add_f32 v242, v176, v177
  v_add_f32 v243, v178, v179
  v_add_f32 v242, v242, v180
  v_add_f32 v243, v243, v181
  v_add_f32 v242, v242, v182
  v_add_f32 v243, v243, v183
  v_add_f32 v242, v242, v184
  v_add_f32 v243, v243, v185
  v_add_f32 v242, v242, v186
  v_add_f32 v243, v243, v187
  v_add_f32 v242, v242, v188
  v_add_f32 v243, v243, v189
  v_add_f32 v242, v242, v190
  v_add_f32 v243, v243, v191
  v_add_f32 v242, v242, v192
  v_add_f32 v243, v243, v193
  v_add_f32 v242, v242, v194
  v_add_f32 v243, v243, v195
  v_add_f32 v242, v242, v243
  v_mov_b32 v243, v242
  s_nop 1
  v_permlane32_swap_b32 v242, v243
  v_add_f32 v242, v242, v243
  v_rcp_f32 v242, v242
  s_nop 0
  v_mul_f32 v176, v176, v242
  v_mul_f32 v177, v177, v242
  v_mul_f32 v178, v178, v242
  v_mul_f32 v179, v179, v242
  v_mul_f32 v180, v180, v242
  v_mul_f32 v181, v181, v242
  v_mul_f32 v182, v182, v242
  v_mul_f32 v183, v183, v242
  v_mul_f32 v184, v184, v242
  v_mul_f32 v185, v185, v242
  v_mul_f32 v186, v186, v242
  v_mul_f32 v187, v187, v242
  v_mul_f32 v188, v188, v242
  v_mul_f32 v189, v189, v242
  v_mul_f32 v190, v190, v242
  v_mul_f32 v191, v191, v242
  v_mul_f32 v192, v192, v242
  v_mul_f32 v193, v193, v242
  v_mul_f32 v194, v194, v242
  v_mul_f32 v195, v195, v242
  v_cvt_pk_bf16_f32 v244, v176, v177
  v_cvt_pk_bf16_f32 v245, v178, v179
  v_cvt_pk_bf16_f32 v246, v184, v185
  v_cvt_pk_bf16_f32 v247, v186, v187
  v_cvt_pk_bf16_f32 v248, v180, v181
  v_cvt_pk_bf16_f32 v249, v182, v183
  v_cvt_pk_bf16_f32 v250, v188, v189
  v_cvt_pk_bf16_f32 v251, v190, v191
  v_cvt_pk_bf16_f32 v252, v192, v193
  v_cvt_pk_bf16_f32 v253, v194, v195
  v_cvt_pk_bf16_f32 v254, v192, v193
  v_cvt_pk_bf16_f32 v255, v194, v195
  s_waitcnt vmcnt(0)
  v_mfma_f32_32x32x16_bf16 v[32:47], v[96:99], v[244:247], 0
  v_mfma_f32_32x32x16_bf16 v[48:63], v[104:107], v[244:247], 0
  v_mfma_f32_32x32x16_bf16 v[64:79], v[112:115], v[244:247], 0
  v_mfma_f32_32x32x16_bf16 v[80:95], v[120:123], v[244:247], 0
  v_mfma_f32_32x32x16_bf16 v[32:47], v[100:103], v[248:251], v[32:47]
  v_mfma_f32_32x32x16_bf16 v[48:63], v[108:111], v[248:251], v[48:63]
  v_mfma_f32_32x32x16_bf16 v[64:79], v[116:119], v[248:251], v[64:79]
  v_mfma_f32_32x32x16_bf16 v[80:95], v[124:127], v[248:251], v[80:95]
  v_mfma_f32_32x32x16_bf16 v[32:47], v[160:163], v[252:255], v[32:47]
  v_mfma_f32_32x32x16_bf16 v[48:63], v[164:167], v[252:255], v[48:63]
  v_mfma_f32_32x32x16_bf16 v[64:79], v[168:171], v[252:255], v[64:79]
  v_mfma_f32_32x32x16_bf16 v[80:95], v[172:175], v[252:255], v[80:95]
  s_mov_b32 s68, s20
  s_mul_i32 s66, s61, 1179648
  s_lshl_b32 s55, s60, 8
  s_add_u32 s66, s66, s55
  s_add_u32 s66, s66, 0x9000000
  v_cvt_pk_bf16_f32 v128, v32, v33
  v_cvt_pk_bf16_f32 v129, v34, v35
  v_cvt_pk_bf16_f32 v130, v40, v41
  v_cvt_pk_bf16_f32 v131, v42, v43
  v_cvt_pk_bf16_f32 v132, v36, v37
  v_cvt_pk_bf16_f32 v133, v38, v39
  v_cvt_pk_bf16_f32 v134, v44, v45
  v_cvt_pk_bf16_f32 v135, v46, v47
  v_cvt_pk_bf16_f32 v136, v48, v49
  v_cvt_pk_bf16_f32 v137, v50, v51
  v_cvt_pk_bf16_f32 v138, v56, v57
  v_cvt_pk_bf16_f32 v139, v58, v59
  v_cvt_pk_bf16_f32 v140, v52, v53
  v_cvt_pk_bf16_f32 v141, v54, v55
  v_cvt_pk_bf16_f32 v142, v60, v61
  v_cvt_pk_bf16_f32 v143, v62, v63
  v_cvt_pk_bf16_f32 v144, v64, v65
  v_cvt_pk_bf16_f32 v145, v66, v67
  v_cvt_pk_bf16_f32 v146, v72, v73
  v_cvt_pk_bf16_f32 v147, v74, v75
  v_cvt_pk_bf16_f32 v148, v68, v69
  v_cvt_pk_bf16_f32 v149, v70, v71
  v_cvt_pk_bf16_f32 v150, v76, v77
  v_cvt_pk_bf16_f32 v151, v78, v79
  v_cvt_pk_bf16_f32 v152, v80, v81
  v_cvt_pk_bf16_f32 v153, v82, v83
  v_cvt_pk_bf16_f32 v154, v88, v89
  v_cvt_pk_bf16_f32 v155, v90, v91
  v_cvt_pk_bf16_f32 v156, v84, v85
  v_cvt_pk_bf16_f32 v157, v86, v87
  v_cvt_pk_bf16_f32 v158, v92, v93
  v_cvt_pk_bf16_f32 v159, v94, v95
L_x_ct:
  s_lshr_b32 s55, s68, 1
  s_lshl_b32 s55, s55, 14
  s_and_b32 s56, s68, 1
  s_lshl_b32 s56, s56, 6
  v_xor_b32 v242, s56, v13
  v_add_u32 v242, s55, v242
  ds_read_b64_tr_b16 v[96:97], v242 offset:0
  ds_read_b64_tr_b16 v[98:99], v242 offset:2048
  ds_read_b64_tr_b16 v[100:101], v242 offset:1024
  ds_read_b64_tr_b16 v[102:103], v242 offset:3072
  ds_read_b64_tr_b16 v[104:105], v242 offset:4096
  ds_read_b64_tr_b16 v[106:107], v242 offset:6144
  ds_read_b64_tr_b16 v[108:109], v242 offset:5120
  ds_read_b64_tr_b16 v[110:111], v242 offset:7168
  ds_read_b64_tr_b16 v[112:113], v242 offset:8192
  ds_read_b64_tr_b16 v[114:115], v242 offset:10240
  ds_read_b64_tr_b16 v[116:117], v242 offset:9216
  ds_read_b64_tr_b16 v[118:119], v242 offset:11264
  ds_read_b64_tr_b16 v[120:121], v242 offset:12288
  ds_read_b64_tr_b16 v[122:123], v242 offset:14336
  ds_read_b64_tr_b16 v[124:125], v242 offset:13312
  ds_read_b64_tr_b16 v[126:127], v242 offset:15360
  s_lshl_b32 s55, s68, 16
  s_add_u32 s55, s55, s66
  s_add_u32 s56, s55, 32768
  s_waitcnt lgkmcnt(14)
  v_mfma_f32_32x32x16_bf16 v[176:191], v[96:99], v[128:131], 0
  s_waitcnt lgkmcnt(12)
  v_mfma_f32_32x32x16_bf16 v[176:191], v[100:103], v[132:135], v[176:191]
  s_waitcnt lgkmcnt(10)
  v_mfma_f32_32x32x16_bf16 v[176:191], v[104:107], v[136:139], v[176:191]
  s_waitcnt lgkmcnt(8)
  v_mfma_f32_32x32x16_bf16 v[176:191], v[108:111], v[140:143], v[176:191]
  s_waitcnt lgkmcnt(6)
  v_mfma_f32_32x32x16_bf16 v[176:191], v[112:115], v[144:147], v[176:191]
  s_waitcnt lgkmcnt(4)
  v_mfma_f32_32x32x16_bf16 v[176:191], v[116:119], v[148:151], v[176:191]
  s_waitcnt lgkmcnt(2)
  v_mfma_f32_32x32x16_bf16 v[176:191], v[120:123], v[152:155], v[176:191]
  s_waitcnt lgkmcnt(0)
  v_mfma_f32_32x32x16_bf16 v[176:191], v[124:127], v[156:159], v[176:191]
  s_add_u32 s68, s68, 4
  s_nop 10
  v_cvt_pk_bf16_f32 v192, v176, v177
  v_cvt_pk_bf16_f32 v193, v178, v179
  v_cvt_pk_bf16_f32 v194, v180, v181
  v_cvt_pk_bf16_f32 v195, v182, v183
  v_cvt_pk_bf16_f32 v196, v184, v185
  v_cvt_pk_bf16_f32 v197, v186, v187
  v_cvt_pk_bf16_f32 v198, v188, v189
  v_cvt_pk_bf16_f32 v199, v190, v191
  v_permlane32_swap_b32 v192, v194
  v_permlane32_swap_b32 v193, v195
  v_permlane32_swap_b32 v196, v198
  v_permlane32_swap_b32 v197, v199
  buffer_store_dwordx4 v[192:195], v7, s[4:7], s55 offen sc1
  buffer_store_dwordx4 v[196:199], v7, s[4:7], s56 offen sc1
  s_cmp_lt_u32 s68, 18
  s_cbranch_scc1 L_x_ct
  s_lshl_b32 s57, s61, 7
  s_add_u32 s57, s57, 0x3209000
  s_lshl_b32 s55, s60, 2
  s_add_u32 s55, s55, s57
  s_waitcnt vmcnt(0)
  s_barrier
  s_cmp_lg_u32 s20, 0
  s_cbranch_scc1 L_x_fl
  s_mov_b64 exec, 1
  buffer_store_dword v6, v3, s[4:7], s55 offen sc1
  s_mov_b64 exec, -1
L_x_fl:
  s_mov_b32 s69, s61
  s_add_u32 s61, s61, 7
  s_cmp_lt_u32 s61, 64
  s_cbranch_scc1 L_x_task
  s_lshr_b32 s55, s69, 2
  s_lshl_b32 s55, s55, 6
  s_add_u32 s55, s55, 0x3208000
  s_mov_b32 exec_lo, 0xfff
  s_mov_b32 exec_hi, 0x0
L_x_pg_b:
  buffer_load_dword v200, v9, s[4:7], s55 offen sc1
  s_add_u32 s59, s59, 1
  s_cmp_ge_u32 s59, 0x8000
  s_waitcnt vmcnt(0)
  v_cmp_eq_u32 vcc, 0, v200
  s_cbranch_scc1 L_x_pg_b_x
  s_cbranch_vccz L_x_pg_b_x
  s_sleep 2
  s_branch L_x_pg_b
L_x_pg_b_x:
  s_mov_b64 exec, -1
  s_lshl_b32 s67, s60, 2
  s_add_u32 s67, s67, s20
  s_lshl_b32 s57, s69, 7
  s_add_u32 s57, s57, 0x3209000
L_x_gr_b:
  s_and_b32 s55, s67, 1
  s_lshl_b32 s55, s55, 4
  s_lshl_b32 s56, s69, 5
  s_add_u32 s55, s55, s56
  s_mul_i32 s55, s55, 1152
  s_lshr_b32 s56, s67, 1
  s_lshl_b32 s56, s56, 4
  s_add_u32 s70, s55, s56
  s_mul_i32 s55, s69, 73728
  s_lshl_b32 s56, s56, 6
  s_add_u32 s55, s55, s56
  s_and_b32 s56, s67, 1
  s_lshl_b32 s56, s56, 8
  s_add_u32 s55, s55, s56
  s_add_u32 s55, s55, 0xe000000
  buffer_load_dwordx2 v[200:201], v8, s[76:79], s70 offen
  buffer_load_dwordx4 v[128:131], v10, s[4:7], s55 offen sc1
  s_add_u32 s55, s55, 4718592
  buffer_load_dwordx4 v[132:135], v10, s[4:7], s55 offen sc1
  s_add_u32 s55, s55, 4718592
  buffer_load_dwordx4 v[136:139], v10, s[4:7], s55 offen sc1
  s_add_u32 s55, s55, 4718592
  buffer_load_dwordx4 v[140:143], v10, s[4:7], s55 offen sc1
  s_mov_b32 exec_lo, 0xffffffff
  s_mov_b32 exec_hi, 0x0
L_x_px_b:
  buffer_load_dword v202, v9, s[4:7], s57 offen sc1
  s_add_u32 s59, s59, 1
  s_cmp_ge_u32 s59, 0x8000
  s_waitcnt vmcnt(0)
  v_cmp_eq_u32 vcc, 0, v202
  s_cbranch_scc1 L_x_px_b_x
  s_cbranch_vccz L_x_px_b_x
  s_sleep 2
  s_branch L_x_px_b
L_x_px_b_x:
  s_mov_b64 exec, -1
  s_mul_i32 s55, s69, 1179648
  s_lshl_b32 s56, s67, 13
  s_add_u32 s55, s55, s56
  s_add_u32 s55, s55, 0x9000000
  s_add_u32 s56, s55, 4096
  buffer_load_dwordx4 v[208:211], v3, s[4:7], s55 offen offset:0 sc1
  buffer_load_dwordx4 v[212:215], v3, s[4:7], s55 offen offset:1024 sc1
  buffer_load_dwordx4 v[216:219], v3, s[4:7], s55 offen offset:2048 sc1
  buffer_load_dwordx4 v[220:223], v3, s[4:7], s55 offen offset:3072 sc1
  buffer_load_dwordx4 v[224:227], v3, s[4:7], s56 offen offset:0 sc1
  buffer_load_dwordx4 v[228:231], v3, s[4:7], s56 offen offset:1024 sc1
  buffer_load_dwordx4 v[232:235], v3, s[4:7], s56 offen offset:2048 sc1
  buffer_load_dwordx4 v[236:239], v3, s[4:7], s56 offen offset:3072 sc1
  v_add_f32 v128, v128, v132
  v_add_f32 v136, v136, v140
  v_add_f32 v129, v129, v133
  v_add_f32 v137, v137, v141
  v_add_f32 v130, v130, v134
  v_add_f32 v138, v138, v142
  v_add_f32 v131, v131, v135
  v_add_f32 v139, v139, v143
  v_add_f32 v128, v128, v136
  v_add_f32 v129, v129, v137
  v_add_f32 v130, v130, v138
  v_add_f32 v131, v131, v139
  v_mul_f32 v132, 0xbfb8aa3b, v128
  v_mul_f32 v133, 0xbfb8aa3b, v129
  v_mul_f32 v134, 0xbfb8aa3b, v130
  v_mul_f32 v135, 0xbfb8aa3b, v131
  v_exp_f32 v132, v132
  v_exp_f32 v133, v133
  v_exp_f32 v134, v134
  v_exp_f32 v135, v135
  v_lshlrev_b32 v204, 16, v200
  v_add_f32 v132, 1.0, v132
  v_add_f32 v133, 1.0, v133
  v_add_f32 v134, 1.0, v134
  v_add_f32 v135, 1.0, v135
  v_rcp_f32 v132, v132
  v_rcp_f32 v133, v133
  v_rcp_f32 v134, v134
  v_rcp_f32 v135, v135
  v_and_b32 v205, 0xffff0000, v200
  v_lshlrev_b32 v206, 16, v201
  v_and_b32 v207, 0xffff0000, v201
  v_mul_f32 v128, v128, v132
  v_mul_f32 v129, v129, v133
  v_mul_f32 v130, v130, v134
  v_mul_f32 v131, v131, v135
  s_waitcnt vmcnt(7)
  v_mfma_f32_16x16x32_bf16 v[196:199], a[0:3], v[208:211], 0
  s_waitcnt vmcnt(6)
  v_mfma_f32_16x16x32_bf16 v[196:199], a[0:3], v[212:215], v[196:199]
  s_waitcnt vmcnt(5)
  v_mfma_f32_16x16x32_bf16 v[196:199], a[0:3], v[216:219], v[196:199]
  s_waitcnt vmcnt(4)
  v_mfma_f32_16x16x32_bf16 v[196:199], a[0:3], v[220:223], v[196:199]
  s_waitcnt vmcnt(3)
  v_mfma_f32_16x16x32_bf16 v[196:199], a[0:3], v[224:227], v[196:199]
  s_waitcnt vmcnt(2)
  v_mfma_f32_16x16x32_bf16 v[196:199], a[0:3], v[228:231], v[196:199]
  s_waitcnt vmcnt(1)
  v_mfma_f32_16x16x32_bf16 v[196:199], a[0:3], v[232:235], v[196:199]
  s_waitcnt vmcnt(0)
  v_mfma_f32_16x16x32_bf16 v[196:199], a[0:3], v[236:239], v[196:199]
  s_nop 7
  v_fmac_f32 v204, v196, v128
  v_fmac_f32 v205, v197, v129
  v_fmac_f32 v206, v198, v130
  v_fmac_f32 v207, v199, v131
  v_cvt_pk_bf16_f32 v204, v204, v205
  v_cvt_pk_bf16_f32 v205, v206, v207
  buffer_store_dwordx2 v[204:205], v8, s[80:83], s70 offen
  s_add_u32 s67, s67, 128
  s_cmp_lt_u32 s67, 144
  s_cbranch_scc1 L_x_gr_b
L_end:
  s_endpgm
.p2align 5
.type L_sched,@object
L_sched:
.long 0x000e0000, 0x00540046, 0x00700062, 0x008c007e, 0xffff009a, 0xffffffff, 0xffffffff, 0xffffffff
.long 0x010e0100, 0x0146011c, 0x01620154, 0x017e0170, 0x019a018c, 0xffffffff, 0xffffffff, 0xffffffff
.long 0x020e0200, 0x022a021c, 0x02460238, 0x02620254, 0x027e0270, 0x029a028c, 0xffffffff, 0xffffffff
.long 0x030e0300, 0x032a031c, 0x03160338, 0x03540346, 0x03700362, 0x038c037e, 0xffff039a, 0xffffffff
.long 0x040e0400, 0x042a041c, 0x04130438, 0x04540446, 0x04700462, 0x048c047e, 0xffff049a, 0xffffffff
.long 0x012b012a, 0x0546013f, 0x05620554, 0x057e0570, 0x059a058c, 0xffffffff, 0xffffffff, 0xffffffff
.long 0x060e0600, 0x062a061c, 0x061b0638, 0x06540646, 0x06700662, 0x068c067e, 0xffff069a, 0xffffffff
.long 0x070e0700, 0x072a071c, 0x07180738, 0x07540746, 0x07700762, 0x078c077e, 0xffff079a, 0xffffffff
.long 0x080e0800, 0x082a081c, 0x08150838, 0x08540846, 0x08700862, 0x088c087e, 0xffff089a, 0xffffffff
.long 0x090e0900, 0x092a091c, 0x09120938, 0x09540946, 0x09700962, 0x098c097e, 0xffff099a, 0xffffffff
.long 0x0a0e0a00, 0x0a2a0a1c, 0x0a010a38, 0x0a540a46, 0x0a700a62, 0x0a8c0a7e, 0xffff0a9a, 0xffffffff
.long 0x0b0e0b00, 0x0b2a0b1c, 0x0b1a0b38, 0x0b540b46, 0x0b700b62, 0x0b8c0b7e, 0xffff0b9a, 0xffffffff
.long 0x0c0e0c00, 0x0c2a0c1c, 0x0c170c38, 0x0c540c46, 0x0c700c62, 0x0c8c0c7e, 0xffff0c9a, 0xffffffff
.long 0x0d0e0d00, 0x0d2a0d1c, 0x0d140d38, 0x0d540d46, 0x0d700d62, 0x0d8c0d7e, 0xffff0d9a, 0xffffffff
.long 0x0e0e0e00, 0x0e2a0e1c, 0x0e110e38, 0x0e540e46, 0x0e700e62, 0x0e8c0e7e, 0xffff0e9a, 0xffffffff
.long 0x002b001c, 0x0f460f38, 0x0f620f54, 0x0f7e0f70, 0x0f9a0f8c, 0xffffffff, 0xffffffff, 0xffffffff
.long 0x000f0001, 0x00550047, 0x00710063, 0x008d007f, 0xffff009b, 0xffffffff, 0xffffffff, 0xffffffff
.long 0x010f0101, 0x0147011d, 0x01630155, 0x017f0171, 0x019b018d, 0xffffffff, 0xffffffff, 0xffffffff
.long 0x020f0201, 0x022b021d, 0x02470239, 0x02630255, 0x027f0271, 0x029b028d, 0xffffffff, 0xffffffff
.long 0x030f0301, 0x032b031d, 0x03240339, 0x03550347, 0x03710363, 0x038d037f, 0xffff039b, 0xffffffff
.long 0x040f0401, 0x042b041d, 0x04210439, 0x04550447, 0x04710463, 0x048d047f, 0xffff049b, 0xffffffff
.long 0x050f0501, 0x052b051d, 0x05100539, 0x05550547, 0x05710563, 0x058d057f, 0xffff059b, 0xffffffff
.long 0x060f0601, 0x062b061d, 0x06290639, 0x06550647, 0x06710663, 0x068d067f, 0xffff069b, 0xffffffff
.long 0x070f0701, 0x072b071d, 0x07260739, 0x07550747, 0x07710763, 0x078d077f, 0xffff079b, 0xffffffff
.long 0x080f0801, 0x082b081d, 0x08230839, 0x08550847, 0x08710863, 0x088d087f, 0xffff089b, 0xffffffff
.long 0x090f0901, 0x092b091d, 0x09200939, 0x09550947, 0x09710963, 0x098d097f, 0xffff099b, 0xffffffff
.long 0x0038001d, 0x0a470a39, 0x0a630a55, 0x0a7f0a71, 0x0a9b0a8d, 0xffffffff, 0xffffffff, 0xffffffff
.long 0x0b0f0b01, 0x0b2b0b1d, 0x0b280b39, 0x0b550b47, 0x0b710b63, 0x0b8d0b7f, 0xffff0b9b, 0xffffffff
.long 0x0c0f0c01, 0x0c2b0c1d, 0x0c250c39, 0x0c550c47, 0x0c710c63, 0x0c8d0c7f, 0xffff0c9b, 0xffffffff
.long 0x0d0f0d01, 0x0d2b0d1d, 0x0d220d39, 0x0d550d47, 0x0d710d63, 0x0d8d0d7f, 0xffff0d9b, 0xffffffff
.long 0x0039002a, 0x0e470e39, 0x0e630e55, 0x0e7f0e71, 0x0e9b0e8d, 0xffffffff, 0xffffffff, 0xffffffff
.long 0x0f0f0f01, 0x0f2b0f1d, 0x0f000f39, 0x0f550f47, 0x0f710f63, 0x0f8d0f7f, 0xffff0f9b, 0xffffffff
.long 0x00100002, 0x00560048, 0x00720064, 0x008e0080, 0xffff009c, 0xffffffff, 0xffffffff, 0xffffffff
.long 0x01100102, 0x0148011e, 0x01640156, 0x01800172, 0x019c018e, 0xffffffff, 0xffffffff, 0xffffffff
.long 0x02100202, 0x022c021e, 0x0248023a, 0x02640256, 0x02800272, 0x029c028e, 0xffffffff, 0xffffffff
.long 0x03100302, 0x032c031e, 0x0332033a, 0x03560348, 0x03720364, 0x038e0380, 0xffff039c, 0xffffffff
.long 0x04100402, 0x042c041e, 0x042f043a, 0x04560448, 0x04720464, 0x048e0480, 0xffff049c, 0xffffffff
.long 0x003a001f, 0x0548053a, 0x05640556, 0x05800572, 0x059c058e, 0xffffffff, 0xffffffff, 0xffffffff
.long 0x06100602, 0x062c061e, 0x0637063a, 0x06560648, 0x06720664, 0x068e0680, 0xffff069c, 0xffffffff
.long 0x07100702, 0x072c071e, 0x0734073a, 0x07560748, 0x07720764, 0x078e0780, 0xffff079c, 0xffffffff
.long 0x08100802, 0x082c081e, 0x0831083a, 0x08560848, 0x08720864, 0x088e0880, 0xffff089c, 0xffffffff
.long 0x013a012c, 0x09480139, 0x09640956, 0x09800972, 0x099c098e, 0xffffffff, 0xffffffff, 0xffffffff
.long 0x0a100a02, 0x0a2c0a1e, 0x0a0f0a3a, 0x0a560a48, 0x0a720a64, 0x0a8e0a80, 0xffff0a9c, 0xffffffff
.long 0x0b100b02, 0x0b2c0b1e, 0x0b360b3a, 0x0b560b48, 0x0b720b64, 0x0b8e0b80, 0xffff0b9c, 0xffffffff
.long 0x0c100c02, 0x0c2c0c1e, 0x0c330c3a, 0x0c560c48, 0x0c720c64, 0x0c8e0c80, 0xffff0c9c, 0xffffffff
.long 0x0d100d02, 0x0d2c0d1e, 0x0d300d3a, 0x0d560d48, 0x0d720d64, 0x0d8e0d80, 0xffff0d9c, 0xffffffff
.long 0x0e100e02, 0x0e2c0e1e, 0x0e030e3a, 0x0e560e48, 0x0e720e64, 0x0e8e0e80, 0xffff0e9c, 0xffffffff
.long 0x0f100f02, 0x0f2c0f1e, 0x0f0e0f3a, 0x0f560f48, 0x0f720f64, 0x0f8e0f80, 0xffff0f9c, 0xffffffff
.long 0x00110003, 0x00570049, 0x00730065, 0x008f0081, 0xffff009d, 0xffffffff, 0xffffffff, 0xffffffff
.long 0x01110103, 0x0149011f, 0x01650157, 0x01810173, 0x019d018f, 0xffffffff, 0xffffffff, 0xffffffff
.long 0x02110203, 0x022d021f, 0x0249023b, 0x02650257, 0x02810273, 0x029d028f, 0xffffffff, 0xffffffff
.long 0x03110303, 0x032d031f, 0x0314033b, 0x03570349, 0x03730365, 0x038f0381, 0xffff039d, 0xffffffff
.long 0x013b012d, 0x0449043b, 0x04650457, 0x04810473, 0x049d048f, 0xffffffff, 0xffffffff, 0xffffffff
.long 0x05110503, 0x052d051f, 0x0502053b, 0x05570549, 0x05730565, 0x058f0581, 0xffff059d, 0xffffffff
.long 0x06110603, 0x062d061f, 0x0619063b, 0x06570649, 0x06730665, 0x068f0681, 0xffff069d, 0xffffffff
.long 0x07110703, 0x072d071f, 0x0716073b, 0x07570749, 0x07730765, 0x078f0781, 0xffff079d, 0xffffffff
.long 0x08110803, 0x082d081f, 0x0813083b, 0x08570849, 0x08730865, 0x088f0881, 0xffff089d, 0xffffffff
.long 0x09110903, 0x092d091f, 0x092e093b, 0x09570949, 0x09730965, 0x098f0981, 0xffff099d, 0xffffffff
.long 0x0a110a03, 0x0a2d0a1f, 0x0a1d0a3b, 0x0a570a49, 0x0a730a65, 0x0a8f0a81, 0xffff0a9d, 0xffffffff
.long 0x0b110b03, 0x0b2d0b1f, 0x0b180b3b, 0x0b570b49, 0x0b730b65, 0x0b8f0b81, 0xffff0b9d, 0xffffffff
.long 0x0c110c03, 0x0c2d0c1f, 0x0c150c3b, 0x0c570c49, 0x0c730c65, 0x0c8f0c81, 0xffff0c9d, 0xffffffff
.long 0x0d110d03, 0x0d2d0d1f, 0x0d120d3b, 0x0d570d49, 0x0d730d65, 0x0d8f0d81, 0xffff0d9d, 0xffffffff
.long 0x002c001e, 0x0e490e3b, 0x0e650e57, 0x0e810e73, 0x0e9d0e8f, 0xffffffff, 0xffffffff, 0xffffffff
.long 0x0f110f03, 0x0f2d0f1f, 0x0f1c0f3b, 0x0f570f49, 0x0f730f65, 0x0f8f0f81, 0xffff0f9d, 0xffffffff
.long 0x00120004, 0x0058004a, 0x00740066, 0x00900082, 0xffff009e, 0xffffffff, 0xffffffff, 0xffffffff
.long 0x01120104, 0x014a0120, 0x01660158, 0x01820174, 0x019e0190, 0xffffffff, 0xffffffff, 0xffffffff
.long 0x02120204, 0x022e0220, 0x024a023c, 0x02660258, 0x02820274, 0x029e0290, 0xffffffff, 0xffffffff
.long 0x03120304, 0x032e0320, 0x0322033c, 0x0358034a, 0x03740366, 0x03900382, 0xffff039e, 0xffffffff
.long 0x04120404, 0x042e0420, 0x0405043c, 0x0458044a, 0x04740466, 0x04900482, 0xffff049e, 0xffffffff
.long 0x05120504, 0x052e0520, 0x051e053c, 0x0558054a, 0x05740566, 0x05900582, 0xffff059e, 0xffffffff
.long 0x06120604, 0x062e0620, 0x0627063c, 0x0658064a, 0x06740666, 0x06900682, 0xffff069e, 0xffffffff
.long 0x07120704, 0x072e0720, 0x0724073c, 0x0758074a, 0x07740766, 0x07900782, 0xffff079e, 0xffffffff
.long 0x08120804, 0x082e0820, 0x0805083c, 0x0858084a, 0x08740866, 0x08900882, 0xffff089e, 0xffffffff
.long 0x002f0020, 0x094a093c, 0x09660958, 0x09820974, 0x099e0990, 0xffffffff, 0xffffffff, 0xffffffff
.long 0x0a120a04, 0x0a2e0a20, 0x0a2b0a3c, 0x0a580a4a, 0x0a740a66, 0x0a900a82, 0xffff0a9e, 0xffffffff
.long 0x0b120b04, 0x0b2e0b20, 0x0b260b3c, 0x0b580b4a, 0x0b740b66, 0x0b900b82, 0xffff0b9e, 0xffffffff
.long 0x0c120c04, 0x0c2e0c20, 0x0c230c3c, 0x0c580c4a, 0x0c740c66, 0x0c900c82, 0xffff0c9e, 0xffffffff
.long 0x003d002e, 0x0d4a0d3c, 0x0d660d58, 0x0d820d74, 0x0d9e0d90, 0xffffffff, 0xffffffff, 0xffffffff
.long 0x0e120e04, 0x0e2e0e20, 0x0e1f0e3c, 0x0e580e4a, 0x0e740e66, 0x0e900e82, 0xffff0e9e, 0xffffffff
.long 0x0f120f04, 0x0f2e0f20, 0x0f2a0f3c, 0x0f580f4a, 0x0f740f66, 0x0f900f82, 0xffff0f9e, 0xffffffff
.long 0x00130005, 0x0059004b, 0x00750067, 0x00910083, 0xffff009f, 0xffffffff, 0xffffffff, 0xffffffff
.long 0x01130105, 0x014b0121, 0x01670159, 0x01830175, 0x019f0191, 0xffffffff, 0xffffffff, 0xffffffff
.long 0x02130205, 0x022f0221, 0x024b023d, 0x02670259, 0x02830275, 0x029f0291, 0xffffffff, 0xffffffff
.long 0x03130305, 0x032f0321, 0x0330033d, 0x0359034b, 0x03750367, 0x03910383, 0xffff039f, 0xffffffff
.long 0x003c0021, 0x044b043d, 0x04670459, 0x04830475, 0x049f0491, 0xffffffff, 0xffffffff, 0xffffffff
.long 0x05130505, 0x052f0521, 0x052c053d, 0x0559054b, 0x05750567, 0x05910583, 0xffff059f, 0xffffffff
.long 0x06130605, 0x062f0621, 0x0635063d, 0x0659064b, 0x06750667, 0x06910683, 0xffff069f, 0xffffffff
.long 0x07130705, 0x072f0721, 0x0732073d, 0x0759074b, 0x07750767, 0x07910783, 0xffff079f, 0xffffffff
.long 0x012f012e, 0x084b013c, 0x08670859, 0x08830875, 0x089f0891, 0xffffffff, 0xffffffff, 0xffffffff
.long 0x09130905, 0x092f0921, 0x0904093d, 0x0959094b, 0x09750967, 0x09910983, 0xffff099f, 0xffffffff
.long 0x0a130a05, 0x0a2f0a21, 0x0a1b0a3d, 0x0a590a4b, 0x0a750a67, 0x0a910a83, 0xffff0a9f, 0xffffffff
.long 0x0b130b05, 0x0b2f0b21, 0x0b340b3d, 0x0b590b4b, 0x0b750b67, 0x0b910b83, 0xffff0b9f, 0xffffffff
.long 0x0c130c05, 0x0c2f0c21, 0x0c310c3d, 0x0c590c4b, 0x0c750c67, 0x0c910c83, 0xffff0c9f, 0xffffffff
.long 0x0d130d05, 0x0d2f0d21, 0x0d040d3d, 0x0d590d4b, 0x0d750d67, 0x0d910d83, 0xffff0d9f, 0xffffffff
.long 0x0e130e05, 0x0e2f0e21, 0x0e2d0e3d, 0x0e590e4b, 0x0e750e67, 0x0e910e83, 0xffff0e9f, 0xffffffff
.long 0x0f130f05, 0x0f2f0f21, 0x0f1a0f3d, 0x0f590f4b, 0x0f750f67, 0x0f910f83, 0xffff0f9f, 0xffffffff
.long 0x00140006, 0x005a004c, 0x00760068, 0x00920084, 0xffff00a0, 0xffffffff, 0xffffffff, 0xffffffff
.long 0x01140106, 0x014c0122, 0x0168015a, 0x01840176, 0x01a00192, 0xffffffff, 0xffffffff, 0xffffffff
.long 0x02140206, 0x02300222, 0x024c023e, 0x0268025a, 0x02840276, 0x02a00292, 0xffffffff, 0xffffffff
.long 0x01310130, 0x034c033e, 0x0368035a, 0x03840376, 0x03a00392, 0xffffffff, 0xffffffff, 0xffffffff
.long 0x04140406, 0x04300422, 0x0403043e, 0x045a044c, 0x04760468, 0x04920484, 0xffff04a0, 0xffffffff
.long 0x05140506, 0x05300522, 0x0500053e, 0x055a054c, 0x05760568, 0x05920584, 0xffff05a0, 0xffffffff
.long 0x06140606, 0x06300622, 0x064c063e, 0x0668065a, 0x06840676, 0x06920643, 0xffff06a0, 0xffffffff
.long 0x07140706, 0x07300722, 0x074c073e, 0x0768075a, 0x07840776, 0x07920740, 0xffff07a0, 0xffffffff
.long 0x08140806, 0x08300822, 0x0807083e, 0x085a084c, 0x08760868, 0x08920884, 0xffff08a0, 0xffffffff
.long 0x09140906, 0x09300922, 0x0902093e, 0x095a094c, 0x09760968, 0x09920984, 0xffff09a0, 0xffffffff
.long 0x0a140a06, 0x0a300a22, 0x0a290a3e, 0x0a5a0a4c, 0x0a760a68, 0x0a920a84, 0xffff0aa0, 0xffffffff
.long 0x0b140b06, 0x0b300b22, 0x0b4c0b3e, 0x0b680b5a, 0x0b840b76, 0x0ba00b92, 0xffffffff, 0xffffffff
.long 0x0c140c06, 0x0c300c22, 0x0c070c3e, 0x0c5a0c4c, 0x0c760c68, 0x0c920c84, 0xffff0ca0, 0xffffffff
.long 0x00310022, 0x0d4c0d3e, 0x0d680d5a, 0x0d840d76, 0x0da00d92, 0xffffffff, 0xffffffff, 0xffffffff
.long 0x0e140e06, 0x0e300e22, 0x0e010e3e, 0x0e5a0e4c, 0x0e760e68, 0x0e920e84, 0xffff0ea0, 0xffffffff
.long 0x0f140f06, 0x0f300f22, 0x0f280f3e, 0x0f5a0f4c, 0x0f760f68, 0x0f920f84, 0xffff0fa0, 0xffffffff
.long 0x00150007, 0x005b004d, 0x00770069, 0x00930085, 0xffff00a1, 0xffffffff, 0xffffffff, 0xffffffff
.long 0x01150107, 0x014d0123, 0x0169015b, 0x01850177, 0x01a10193, 0xffffffff, 0xffffffff, 0xffffffff
.long 0x02150207, 0x02310223, 0x024d023f, 0x0269025b, 0x02850277, 0x02a10293, 0xffffffff, 0xffffffff
.long 0x03150307, 0x03310323, 0x0306033f, 0x035b034d, 0x03770369, 0x03930385, 0xffff03a1, 0xffffffff
.long 0x04150407, 0x04310423, 0x0411043f, 0x045b044d, 0x04770469, 0x04930485, 0xffff04a1, 0xffffffff
.long 0x05150507, 0x05310523, 0x050e053f, 0x055b054d, 0x05770569, 0x05930585, 0xffff05a1, 0xffffffff
.long 0x06150607, 0x06310623, 0x064d063f, 0x0669065b, 0x06850677, 0x06a10693, 0xffffffff, 0xffffffff
.long 0x07150707, 0x07310723, 0x074d073f, 0x0769075b, 0x07850777, 0x07a10793, 0xffffffff, 0xffffffff
.long 0x003e0023, 0x084d083f, 0x0869085b, 0x08850877, 0x08a10893, 0xffffffff, 0xffffffff, 0xffffffff
.long 0x09150907, 0x09310923, 0x0910093f, 0x095b094d, 0x09770969, 0x09930985, 0xffff09a1, 0xffffffff
.long 0x0a150a07, 0x0a310a23, 0x0a370a3f, 0x0a5b0a4d, 0x0a770a69, 0x0a930a85, 0xffff0aa1, 0xffffffff
.long 0x0b150b07, 0x0b310b23, 0x0b4d0b3f, 0x0b690b5b, 0x0b850b77, 0x0ba10b93, 0xffffffff, 0xffffffff
.long 0x003f0030, 0x0c4d0c3f, 0x0c690c5b, 0x0c850c77, 0x0ca10c93, 0xffffffff, 0xffffffff, 0xffffffff
.long 0x0d150d07, 0x0d310d23, 0x0d060d3f, 0x0d5b0d4d, 0x0d770d69, 0x0d930d85, 0xffff0da1, 0xffffffff
.long 0x0e150e07, 0x0e310e23, 0x0e0f0e3f, 0x0e5b0e4d, 0x0e770e69, 0x0e930e85, 0xffff0ea1, 0xffffffff
.long 0x0f150f07, 0x0f310f23, 0x0f360f3f, 0x0f5b0f4d, 0x0f770f69, 0x0f930f85, 0xffff0fa1, 0xffffffff
.long 0x00160008, 0x004e0040, 0x006a005c, 0x00860078, 0x00a20094, 0xffffffff, 0xffffffff, 0xffffffff
.long 0x01160108, 0x01400124, 0x015c014e, 0x0178016a, 0x01940186, 0xffff01a2, 0xffffffff, 0xffffffff
.long 0x02160208, 0x02320224, 0x024e0240, 0x026a025c, 0x02860278, 0x02a20294, 0xffffffff, 0xffffffff
.long 0x00330025, 0x034e0340, 0x036a035c, 0x03860378, 0x03a20394, 0xffffffff, 0xffffffff, 0xffffffff
.long 0x04160408, 0x04320424, 0x0440041f, 0x045c044e, 0x0478046a, 0x04940486, 0xffff04a2, 0xffffffff
.long 0x05160508, 0x05320524, 0x0540051c, 0x055c054e, 0x0578056a, 0x05940586, 0xffff05a2, 0xffffffff
.long 0x06160608, 0x06320624, 0x064e0640, 0x066a065c, 0x06860678, 0x06a20694, 0xffffffff, 0xffffffff
.long 0x01330132, 0x074e013d, 0x076a075c, 0x07860778, 0x07a20794, 0xffffffff, 0xffffffff, 0xffffffff
.long 0x08160808, 0x08320824, 0x08400821, 0x085c084e, 0x0878086a, 0x08940886, 0xffff08a2, 0xffffffff
.long 0x09160908, 0x09320924, 0x0940091e, 0x095c094e, 0x0978096a, 0x09940986, 0xffff09a2, 0xffffffff
.long 0x0a160a08, 0x0a320a24, 0x0a4e0a40, 0x0a6a0a5c, 0x0a860a78, 0x0a940a45, 0xffff0aa2, 0xffffffff
.long 0x0b160b08, 0x0b320b24, 0x0b4e0b40, 0x0b6a0b5c, 0x0b860b78, 0x0ba20b94, 0xffffffff, 0xffffffff
.long 0x0c160c08, 0x0c320c24, 0x0c400c09, 0x0c5c0c4e, 0x0c780c6a, 0x0c940c86, 0xffff0ca2, 0xffffffff
.long 0x0d160d08, 0x0d320d24, 0x0d400d20, 0x0d5c0d4e, 0x0d780d6a, 0x0d940d86, 0xffff0da2, 0xffffffff
.long 0x0e160e08, 0x0e320e24, 0x0e400e1d, 0x0e5c0e4e, 0x0e780e6a, 0x0e940e86, 0xffff0ea2, 0xffffffff
.long 0x0f160f08, 0x0f320f24, 0x0f4e0f40, 0x0f6a0f5c, 0x0f860f78, 0x0fa20f94, 0xffffffff, 0xffffffff
.long 0x00170009, 0x004f0041, 0x006b005d, 0x00870079, 0x00a30095, 0xffffffff, 0xffffffff, 0xffffffff
.long 0x01170109, 0x01410125, 0x015d014f, 0x0179016b, 0x01950187, 0xffff01a3, 0xffffffff, 0xffffffff
.long 0x02170209, 0x02330225, 0x024f0241, 0x026b025d, 0x02870279, 0x02a30295, 0xffffffff, 0xffffffff
.long 0x03170309, 0x03330325, 0x03410308, 0x035d034f, 0x0379036b, 0x03950387, 0xffff03a3, 0xffffffff
.long 0x04170409, 0x04330425, 0x0441042d, 0x045d044f, 0x0479046b, 0x04950487, 0xffff04a3, 0xffffffff
.long 0x05170509, 0x05330525, 0x0541052a, 0x055d054f, 0x0579056b, 0x05950587, 0xffff05a3, 0xffffffff
.long 0x06170609, 0x06330625, 0x064f0641, 0x066b065d, 0x06870679, 0x06a30695, 0xffffffff, 0xffffffff
.long 0x07170709, 0x07330725, 0x07410708, 0x075d074f, 0x0779076b, 0x07950787, 0xffff07a3, 0xffffffff
.long 0x08170809, 0x08330825, 0x0841082f, 0x085d084f, 0x0879086b, 0x08950887, 0xffff08a3, 0xffffffff
.long 0x09170909, 0x09330925, 0x0941092c, 0x095d094f, 0x0979096b, 0x09950987, 0xffff09a3, 0xffffffff
.long 0x0a170a09, 0x0a330a25, 0x0a4f0a41, 0x0a6b0a5d, 0x0a870a79, 0x0aa30a95, 0xffffffff, 0xffffffff
.long 0x0b170b09, 0x0b330b25, 0x0b4f0b41, 0x0b6b0b5d, 0x0b870b79, 0x0ba30b95, 0xffffffff, 0xffffffff
.long 0x00320024, 0x0c4f0c41, 0x0c6b0c5d, 0x0c870c79, 0x0ca30c95, 0xffffffff, 0xffffffff, 0xffffffff
.long 0x0d170d09, 0x0d330d25, 0x0d410d2e, 0x0d5d0d4f, 0x0d790d6b, 0x0d950d87, 0xffff0da3, 0xffffffff
.long 0x0e170e09, 0x0e330e25, 0x0e410e2b, 0x0e5d0e4f, 0x0e790e6b, 0x0e950e87, 0xffff0ea3, 0xffffffff
.long 0x0f170f09, 0x0f330f25, 0x0f4f0f41, 0x0f6b0f5d, 0x0f870f79, 0x0fa30f95, 0xffffffff, 0xffffffff
.long 0x0018000a, 0x00500042, 0x006c005e, 0x0088007a, 0x00a40096, 0xffffffff, 0xffffffff, 0xffffffff
.long 0x0118010a, 0x01420126, 0x015e0150, 0x017a016c, 0x01960188, 0xffff01a4, 0xffffffff, 0xffffffff
.long 0x0218020a, 0x02340226, 0x02500242, 0x026c025e, 0x0288027a, 0x02a40296, 0xffffffff, 0xffffffff
.long 0x0318030a, 0x03340326, 0x03500342, 0x036c035e, 0x0388037a, 0x03a40396, 0xffffffff, 0xffffffff
.long 0x0418040a, 0x04340426, 0x04500442, 0x046c045e, 0x0488047a, 0x04a40496, 0xffffffff, 0xffffffff
.long 0x0518050a, 0x05340526, 0x05420538, 0x055e0550, 0x057a056c, 0x05960588, 0xffff05a4, 0xffffffff
.long 0x0618060a, 0x06340626, 0x0642060b, 0x065e0650, 0x067a066c, 0x06960688, 0xffff06a4, 0xffffffff
.long 0x00340026, 0x07500742, 0x076c075e, 0x0788077a, 0x07a40796, 0xffffffff, 0xffffffff, 0xffffffff
.long 0x0818080a, 0x08340826, 0x0842083d, 0x085e0850, 0x087a086c, 0x08960888, 0xffff08a4, 0xffffffff
.long 0x0918090a, 0x09340926, 0x0942093a, 0x095e0950, 0x097a096c, 0x09960988, 0xffff09a4, 0xffffffff
.long 0x0a180a0a, 0x0a340a26, 0x0a500a42, 0x0a6c0a5e, 0x0a880a7a, 0x0aa40a96, 0xffffffff, 0xffffffff
.long 0x003b0027, 0x0b500b42, 0x0b6c0b5e, 0x0b880b7a, 0x0ba40b96, 0xffffffff, 0xffffffff, 0xffffffff
.long 0x0c180c0a, 0x0c340c26, 0x0c500c42, 0x0c6c0c5e, 0x0c880c7a, 0x0ca40c96, 0xffffffff, 0xffffffff
.long 0x0d180d0a, 0x0d340d26, 0x0d500d42, 0x0d6c0d5e, 0x0d880d7a, 0x0da40d96, 0xffffffff, 0xffffffff
.long 0x0e180e0a, 0x0e340e26, 0x0e500e42, 0x0e6c0e5e, 0x0e880e7a, 0x0ea40e96, 0xffffffff, 0xffffffff
.long 0x0f180f0a, 0x0f340f26, 0x0f500f42, 0x0f6c0f5e, 0x0f880f7a, 0x0fa40f96, 0xffffffff, 0xffffffff
.long 0x0019000b, 0x00510043, 0x006d005f, 0x0089007b, 0x00a50097, 0xffffffff, 0xffffffff, 0xffffffff
.long 0x0119010b, 0x01430127, 0x015f0151, 0x017b016d, 0x01970189, 0xffff01a5, 0xffffffff, 0xffffffff
.long 0x0219020b, 0x02350227, 0x02510243, 0x026d025f, 0x0289027b, 0x02a50297, 0xffffffff, 0xffffffff
.long 0x0319030b, 0x03350327, 0x03510343, 0x036d035f, 0x0389037b, 0x03a50397, 0xffffffff, 0xffffffff
.long 0x0419040b, 0x04350427, 0x04510443, 0x046d045f, 0x0489047b, 0x04a50497, 0xffffffff, 0xffffffff
.long 0x0519050b, 0x05350527, 0x05510543, 0x056d055f, 0x0589057b, 0x05a50597, 0xffffffff, 0xffffffff
.long 0x01350134, 0x0651013e, 0x066d065f, 0x0689067b, 0x06a50697, 0xffffffff, 0xffffffff, 0xffffffff
.long 0x0719070b, 0x07350727, 0x0743070a, 0x075f0751, 0x077b076d, 0x07970789, 0xffff07a5, 0xffffffff
.long 0x0819080b, 0x08350827, 0x08510843, 0x086d085f, 0x0889087b, 0x08a50897, 0xffffffff, 0xffffffff
.long 0x0919090b, 0x09350927, 0x09510943, 0x096d095f, 0x0989097b, 0x09a50997, 0xffffffff, 0xffffffff
.long 0x0a190a0b, 0x0a350a27, 0x0a510a43, 0x0a6d0a5f, 0x0a890a7b, 0x0aa50a97, 0xffffffff, 0xffffffff
.long 0x0b190b0b, 0x0b350b27, 0x0b430b0a, 0x0b5f0b51, 0x0b7b0b6d, 0x0b970b89, 0xffff0ba5, 0xffffffff
.long 0x0c190c0b, 0x0c350c27, 0x0c510c43, 0x0c6d0c5f, 0x0c890c7b, 0x0ca50c97, 0xffffffff, 0xffffffff
.long 0x0d190d0b, 0x0d350d27, 0x0d510d43, 0x0d6d0d5f, 0x0d890d7b, 0x0da50d97, 0xffffffff, 0xffffffff
.long 0x0e190e0b, 0x0e350e27, 0x0e510e43, 0x0e6d0e5f, 0x0e890e7b, 0x0ea50e97, 0xffffffff, 0xffffffff
.long 0x0f190f0b, 0x0f350f27, 0x0f510f43, 0x0f6d0f5f, 0x0f890f7b, 0x0fa50f97, 0xffffffff, 0xffffffff
.long 0x001a000c, 0x00520044, 0x006e0060, 0x008a007c, 0x00a60098, 0xffffffff, 0xffffffff, 0xffffffff
.long 0x011a010c, 0x01440128, 0x01600152, 0x017c016e, 0x0198018a, 0xffff01a6, 0xffffffff, 0xffffffff
.long 0x021a020c, 0x02360228, 0x02520244, 0x026e0260, 0x028a027c, 0x02a60298, 0xffffffff, 0xffffffff
.long 0x031a030c, 0x03360328, 0x03520344, 0x036e0360, 0x038a037c, 0x03a60398, 0xffffffff, 0xffffffff
.long 0x041a040c, 0x04360428, 0x04520444, 0x046e0460, 0x048a047c, 0x04a60498, 0xffffffff, 0xffffffff
.long 0x051a050c, 0x05360528, 0x05520544, 0x056e0560, 0x058a057c, 0x05a60598, 0xffffffff, 0xffffffff
.long 0x061a060c, 0x06360628, 0x0644060d, 0x06600652, 0x067c066e, 0x0698068a, 0xffff06a6, 0xffffffff
.long 0x071a070c, 0x07360728, 0x07520744, 0x076e0760, 0x078a077c, 0x07a60798, 0xffffffff, 0xffffffff
.long 0x081a080c, 0x08360828, 0x08520844, 0x086e0860, 0x088a087c, 0x08a60898, 0xffffffff, 0xffffffff
.long 0x091a090c, 0x09360928, 0x09520944, 0x096e0960, 0x098a097c, 0x09a60998, 0xffffffff, 0xffffffff
.long 0x0a1a0a0c, 0x0a360a28, 0x0a440a0d, 0x0a600a52, 0x0a7c0a6e, 0x0a980a8a, 0xffff0aa6, 0xffffffff
.long 0x00370028, 0x0b520b44, 0x0b6e0b60, 0x0b8a0b7c, 0x0ba60b98, 0xffffffff, 0xffffffff, 0xffffffff
.long 0x0c1a0c0c, 0x0c360c28, 0x0c520c44, 0x0c6e0c60, 0x0c8a0c7c, 0x0ca60c98, 0xffffffff, 0xffffffff
.long 0x0d1a0d0c, 0x0d360d28, 0x0d520d44, 0x0d6e0d60, 0x0d8a0d7c, 0x0da60d98, 0xffffffff, 0xffffffff
.long 0x0e1a0e0c, 0x0e360e28, 0x0e520e44, 0x0e6e0e60, 0x0e8a0e7c, 0x0ea60e98, 0xffffffff, 0xffffffff
.long 0x00350036, 0x0f520f44, 0x0f6e0f60, 0x0f8a0f7c, 0x0fa60f98, 0xffffffff, 0xffffffff, 0xffffffff
.long 0x001b000d, 0x00530045, 0x006f0061, 0x008b007d, 0x00a70099, 0xffffffff, 0xffffffff, 0xffffffff
.long 0x011b010d, 0x01450129, 0x01610153, 0x017d016f, 0x0199018b, 0xffff01a7, 0xffffffff, 0xffffffff
.long 0x021b020d, 0x02370229, 0x02530245, 0x026f0261, 0x028b027d, 0x02a70299, 0xffffffff, 0xffffffff
.long 0x031b030d, 0x03370329, 0x03530345, 0x036f0361, 0x038b037d, 0x03a70399, 0xffffffff, 0xffffffff
.long 0x041b040d, 0x04370429, 0x04530445, 0x046f0461, 0x048b047d, 0x04a70499, 0xffffffff, 0xffffffff
.long 0x051b050d, 0x05370529, 0x05530545, 0x056f0561, 0x058b057d, 0x05a70599, 0xffffffff, 0xffffffff
.long 0x002d0029, 0x06530645, 0x066f0661, 0x068b067d, 0x06a70699, 0xffffffff, 0xffffffff, 0xffffffff
.long 0x071b070d, 0x07370729, 0x07530745, 0x076f0761, 0x078b077d, 0x07a70799, 0xffffffff, 0xffffffff
.long 0x081b080d, 0x08370829, 0x08530845, 0x086f0861, 0x088b087d, 0x08a70899, 0xffffffff, 0xffffffff
.long 0x091b090d, 0x09370929, 0x09530945, 0x096f0961, 0x098b097d, 0x09a70999, 0xffffffff, 0xffffffff
.long 0x01370136, 0x0a530138, 0x0a6f0a61, 0x0a8b0a7d, 0x0aa70a99, 0xffffffff, 0xffffffff, 0xffffffff
.long 0x0b1b0b0d, 0x0b370b29, 0x0b450b0c, 0x0b610b53, 0x0b7d0b6f, 0x0b990b8b, 0xffff0ba7, 0xffffffff
.long 0x0c1b0c0d, 0x0c370c29, 0x0c530c45, 0x0c6f0c61, 0x0c8b0c7d, 0x0ca70c99, 0xffffffff, 0xffffffff
.long 0x0d1b0d0d, 0x0d370d29, 0x0d530d45, 0x0d6f0d61, 0x0d8b0d7d, 0x0da70d99, 0xffffffff, 0xffffffff
.long 0x0e1b0e0d, 0x0e370e29, 0x0e530e45, 0x0e6f0e61, 0x0e8b0e7d, 0x0ea70e99, 0xffffffff, 0xffffffff
.long 0x0f1b0f0d, 0x0f370f29, 0x0f450f0c, 0x0f610f53, 0x0f7d0f6f, 0x0f990f8b, 0xffff0fa7, 0xffffffff
.size L_sched, 7168
.section .rodata,"a"
.p2align 6
.amdhsa_kernel recurrent_scan__memory_aug_recurrent_mem_tr__geglu_ffn__prompt_kernel
  .amdhsa_next_free_vgpr 512
  .amdhsa_next_free_sgpr 102
  .amdhsa_accum_offset 256
  .amdhsa_group_segment_fixed_size 0
  .amdhsa_kernarg_size 112
  .amdhsa_user_sgpr_count 2
  .amdhsa_user_sgpr_kernarg_segment_ptr 1
  .amdhsa_system_sgpr_workgroup_id_x 1
  .amdhsa_float_denorm_mode_32 3
  .amdhsa_float_denorm_mode_16_64 3
.end_amdhsa_kernel
```
